```python
import torch

def _softmax(x, axis=-1):
    return torch.softmax(x, dim=axis)
def _gelu(x):
    return torch.nn.functional.gelu(x, approximate="tanh")
def _silu(x):
    return torch.nn.functional.silu(x)
def _sigmoid(x):
    return torch.sigmoid(x)
def _layernorm(x, axis=-1, eps=1e-5):
    m = x.mean(dim=axis, keepdim=True)
    v = x.var(dim=axis, keepdim=True, unbiased=False)
    return (x - m) / torch.sqrt(v + eps)
def _scatter_add(tgt, idx, src, axis=0):
    return tgt.clone().index_add_(axis, idx, src)
def _segment_sum(src, seg, n):
    out = torch.zeros((n,) + src.shape[1:], dtype=src.dtype)
    return out.index_add_(0, seg, src)
def _pad(x, pw):
    flat = tuple(v for pair in reversed(pw) for v in pair)
    return torch.nn.functional.pad(x, flat)

kernel_name = 'standalone__gqa_softmax__prompt'

def setup_inputs():

    _w = (lambda a: (lambda t: t.to(torch.bfloat16) if t.is_floating_point() else t)(torch.as_tensor(a)))
    B, Hq, Hkv, Sq, Sk, D = 1, 32, 32, 2048, 2048, 192
    return {
        "q": _w((lambda *s: torch.randn(*s, dtype=torch.bfloat16) * 0.8)(B, Hq, Sq, D)),
        "k": _w((lambda *s: torch.randn(*s, dtype=torch.bfloat16) * 0.8)(B, Hkv, Sk, D)),
        "v": _w((lambda *s: torch.randn(*s, dtype=torch.bfloat16) * 0.05)(B, Hkv, Sk, D)),
    }

def reference(q, k, v):
    B, Hq, Sq, D = q.shape
    Hkv = k.shape[1]
    rep = Hq // Hkv
    k = (lambda x, n, axis: torch.repeat_interleave(x, n, dim=axis))(k, rep, axis=1)
    v = (lambda x, n, axis: torch.repeat_interleave(x, n, dim=axis))(v, rep, axis=1)
    scale = D ** -0.5
    scores = torch.einsum("bhqd,bhkd->bhqk", q, k) * scale
    p = _softmax(scores, axis=-1)
    return torch.einsum("bhqk,bhkd->bhqd", p, v)
```

```asm
; @launch grid=(256,1,1) block=(256,1,1) lds=149568
.amdgcn_target "amdgcn-amd-amdhsa--gfx950"
.text
.globl standalone__gqa_softmax__prompt_kernel
.p2align 8
.type standalone__gqa_softmax__prompt_kernel,@function
standalone__gqa_softmax__prompt_kernel:
    s_cmp_ge_u32 s2, 256
    s_cbranch_scc1 L_end
    s_load_dwordx4 s[4:7], s[0:1], 0
    s_load_dwordx4 s[56:59], s[0:1], 16
    s_getpc_b64 s[46:47]
    v_lshlrev_b32 v23, 7, v0
    v_min_u32 v23, L_end-standalone__gqa_softmax__prompt_kernel-16, v23
    global_load_dword v255, v23, s[46:47]
    v_and_b32 v4, 63, v0
    v_lshrrev_b32 v22, 6, v0
    v_and_b32 v19, 15, v0
    v_readfirstlane_b32 s24, v22
    v_lshrrev_b32 v20, 4, v4
    s_and_b32 s40, s2, 7
    s_lshl_b32 s40, s40, 2
    s_lshr_b32 s41, s2, 6
    s_add_u32 s40, s40, s41
    s_lshr_b32 s41, s2, 3
    s_and_b32 s41, s41, 7
    s_mul_i32 s42, s40, 786432
    s_mul_i32 s43, s41, 98304
    s_mul_i32 s41, s24, 24576
    s_add_u32 s43, s43, s41
    s_add_u32 s43, s43, s42
    s_mul_i32 s41, s24, 192
    v_add_u32 v22, s41, v4
    v_mul_u32_u24 v23, 2731, v22
    v_lshrrev_b32 v23, 16, v23
    v_mul_u32_u24 v21, 24, v23
    v_sub_u32 v22, v22, v21
    v_and_b32 v21, 6, v23
    v_xor_b32 v22, v22, v21
    v_lshlrev_b32 v22, 4, v22
    v_mul_u32_u24 v23, 384, v23
    v_add_u32 v14, v22, v23
    v_add_u32 v22, s41, v4
    v_add_u32 v22, 64, v22
    v_mul_u32_u24 v23, 2731, v22
    v_lshrrev_b32 v23, 16, v23
    v_mul_u32_u24 v21, 24, v23
    v_sub_u32 v22, v22, v21
    v_and_b32 v21, 6, v23
    v_xor_b32 v22, v22, v21
    v_lshlrev_b32 v22, 4, v22
    v_mul_u32_u24 v23, 384, v23
    v_add_u32 v15, v22, v23
    v_subrev_u32 v15, 1024, v15
    v_add_u32 v22, s41, v4
    v_add_u32 v22, 128, v22
    v_mul_u32_u24 v23, 2731, v22
    v_lshrrev_b32 v23, 16, v23
    v_mul_u32_u24 v21, 24, v23
    v_sub_u32 v22, v22, v21
    v_and_b32 v21, 6, v23
    v_xor_b32 v22, v22, v21
    v_lshlrev_b32 v22, 4, v22
    v_mul_u32_u24 v23, 384, v23
    v_add_u32 v16, v22, v23
    v_subrev_u32 v16, 2048, v16
    s_mul_i32 s41, s24, 3072
    v_subrev_u32 v1, s41, v14
    v_subrev_u32 v2, s41, v15
    v_subrev_u32 v3, s41, v16
    s_mul_i32 s38, s24, 12800
    s_add_u32 s38, s38, 98304
    s_mul_i32 s39, s24, 6144
    s_add_u32 s39, s39, 73728
    s_add_u32 s35, s41, 0
    s_add_u32 s36, s41, 49152
    s_mov_b32 s27, 12288
    s_waitcnt lgkmcnt(0)
    s_add_u32 s8, s6, s42
    s_addc_u32 s9, s7, 0
    s_mov_b32 s10, 786432
    s_mov_b32 s11, 0x20000
    s_mov_b32 s41, 0
    s_add_u32 m0, s35, 0
    s_nop 0
    buffer_load_dwordx4 v14, s[8:11], s41 offen lds
    buffer_load_dwordx4 v15, s[8:11], s41 offen offset:1024 lds
    buffer_load_dwordx4 v16, s[8:11], s41 offen offset:2048 lds
    s_add_u32 s20, s4, s43
    s_addc_u32 s21, s5, 0
    s_mov_b32 s22, 24576
    s_mov_b32 s23, 0x20000
    s_mov_b32 s40, 0
    s_add_u32 m0, s38, 0
    s_nop 0
    buffer_load_dwordx4 v1, s[20:23], s40 offen sc1 nt lds
    buffer_load_dwordx4 v2, s[20:23], s40 offen offset:1024 sc1 nt lds
    buffer_load_dwordx4 v3, s[20:23], s40 offen offset:2048 sc1 nt lds
    s_mov_b32 s40, 3072
    s_add_u32 m0, s38, 3072
    s_nop 0
    buffer_load_dwordx4 v1, s[20:23], s40 offen sc1 nt lds
    buffer_load_dwordx4 v2, s[20:23], s40 offen offset:1024 sc1 nt lds
    buffer_load_dwordx4 v3, s[20:23], s40 offen offset:2048 sc1 nt lds
    s_add_u32 s12, s56, s42
    s_addc_u32 s13, s57, 0
    s_mov_b32 s14, 786432
    s_mov_b32 s15, 0x20000
    s_add_u32 s16, s58, s43
    s_addc_u32 s17, s59, 0
    s_mov_b32 s18, 24576
    s_mov_b32 s19, 0x20000
    v_and_b32 v22, 6, v19
    v_xor_b32 v22, v22, v20
    v_lshlrev_b32 v22, 4, v22
    v_mul_u32_u24 v23, 384, v19
    v_add_u32 v8, v22, v23
    v_xor_b32 v9, 64, v8
    v_lshrrev_b32 v22, 2, v19
    v_lshl_add_u32 v22, v20, 2, v22
    v_and_b32 v23, 6, v22
    v_bfe_u32 v21, v19, 1, 1
    v_or_b32 v23, v23, v21
    v_lshlrev_b32 v23, 4, v23
    v_and_b32 v21, 1, v19
    v_lshl_add_u32 v23, v21, 3, v23
    v_mul_u32_u24 v22, 384, v22
    v_add_u32 v10, v22, v23
    v_add_u32 v10, 49152, v10
    v_xor_b32 v11, 32, v10
    v_xor_b32 v12, 64, v10
    v_xor_b32 v13, 96, v10
    v_add_u32 v17, s38, v8
    v_add_u32 v18, s38, v9
    v_mov_b32 v22, 149504
    v_mov_b32 v23, 0
    ds_write_b32 v22, v23
    v_mov_b32 v4, 0
    v_mov_b32 v5, 0
    v_mov_b32 v6, 0
    v_mov_b32 v7, 0
    s_nop 1
    v_mfma_f32_32x32x16_bf16 a[0:15], v[4:7], v[4:7], 0
    v_mfma_f32_32x32x16_bf16 a[16:31], v[4:7], v[4:7], 0
    v_mfma_f32_32x32x16_bf16 a[32:47], v[4:7], v[4:7], 0
    v_mfma_f32_32x32x16_bf16 a[48:63], v[4:7], v[4:7], 0
    v_mfma_f32_32x32x16_bf16 a[64:79], v[4:7], v[4:7], 0
    v_mfma_f32_32x32x16_bf16 a[80:95], v[4:7], v[4:7], 0
    v_mfma_f32_32x32x16_bf16 a[96:111], v[4:7], v[4:7], 0
    v_mfma_f32_32x32x16_bf16 a[112:127], v[4:7], v[4:7], 0
    v_mfma_f32_32x32x16_bf16 a[128:143], v[4:7], v[4:7], 0
    v_mfma_f32_32x32x16_bf16 a[144:159], v[4:7], v[4:7], 0
    v_mfma_f32_32x32x16_bf16 a[160:175], v[4:7], v[4:7], 0
    v_mfma_f32_32x32x16_bf16 a[176:191], v[4:7], v[4:7], 0
    s_mov_b32 s44, 0x3dd53b95
    s_mov_b32 s45, 0xffff0000
    s_mov_b32 s32, 0x3b800000
    s_mov_b32 s33, 0x4b800000
    s_mov_b32 s25, 61440
    s_mov_b32 s26, 24576
    s_mov_b32 s31, 0
    s_mov_b32 s41, 12288
    s_add_u32 m0, s35, 12288
    s_nop 0
    buffer_load_dwordx4 v14, s[8:11], s41 offen lds
    buffer_load_dwordx4 v15, s[8:11], s41 offen offset:1024 lds
    buffer_load_dwordx4 v16, s[8:11], s41 offen offset:2048 lds
    s_mov_b32 s40, 6144
    s_add_u32 m0, s38, 6400
    s_nop 0
    buffer_load_dwordx4 v1, s[20:23], s40 offen sc1 nt lds
    buffer_load_dwordx4 v2, s[20:23], s40 offen offset:1024 sc1 nt lds
    buffer_load_dwordx4 v3, s[20:23], s40 offen offset:2048 sc1 nt lds
    s_mov_b32 s40, 9216
    s_add_u32 m0, s38, 9472
    s_nop 0
    buffer_load_dwordx4 v1, s[20:23], s40 offen sc1 nt lds
    buffer_load_dwordx4 v2, s[20:23], s40 offen offset:1024 sc1 nt lds
    buffer_load_dwordx4 v3, s[20:23], s40 offen offset:2048 sc1 nt lds
    s_waitcnt vmcnt(15)
    s_waitcnt lgkmcnt(0)
    s_barrier
    ds_read_b128 v[152:155], v8 offset:0
    ds_read_b128 v[156:159], v9 offset:0
    ds_read_b128 v[160:163], v8 offset:128
    ds_read_b128 v[164:167], v9 offset:128
    ds_read_b128 v[168:171], v8 offset:256
    ds_read_b128 v[172:175], v9 offset:256
    ds_read_b128 v[176:179], v8 offset:6144
    ds_read_b128 v[180:183], v9 offset:6144
    ds_read_b128 v[184:187], v8 offset:6272
    ds_read_b128 v[188:191], v9 offset:6272
    ds_read_b128 v[192:195], v8 offset:6400
    ds_read_b128 v[196:199], v9 offset:6400
    s_waitcnt vmcnt(9)
    ds_read_b128 v[136:139], v17 offset:0
    ds_read_b128 v[140:143], v18 offset:0
    ds_read_b128 v[144:147], v17 offset:128
    ds_read_b128 v[148:151], v18 offset:128
    ds_read_b128 v[68:71], v17 offset:256
    ds_read_b128 v[84:87], v18 offset:256
    s_waitcnt lgkmcnt(0)
    s_mov_b32 s40, 12288
    s_add_u32 m0, s38, 0
    s_nop 0
    buffer_load_dwordx4 v1, s[20:23], s40 offen sc1 nt lds
    buffer_load_dwordx4 v2, s[20:23], s40 offen offset:1024 sc1 nt lds
    s_waitcnt vmcnt(8)
    s_waitcnt lgkmcnt(0)
    s_barrier
    ds_read_b128 v[200:203], v8 offset:12288
    ds_read_b128 v[204:207], v9 offset:12288
    ds_read_b128 v[208:211], v8 offset:12416
    ds_read_b128 v[212:215], v9 offset:12416
    ds_read_b128 v[216:219], v8 offset:12544
    ds_read_b128 v[220:223], v9 offset:12544
    ds_read_b128 v[104:107], v8 offset:18432
    ds_read_b128 v[108:111], v9 offset:18432
    ds_read_b128 v[112:115], v8 offset:18560
    ds_read_b128 v[116:119], v9 offset:18560
    ds_read_b128 v[128:131], v8 offset:18688
    ds_read_b128 v[132:135], v9 offset:18688
    s_waitcnt lgkmcnt(12)
    v_and_b32 v19, s45, v136
    v_lshlrev_b32 v20, 16, v136
    v_mul_f32 v19, s44, v19
    v_mul_f32 v20, s44, v20
    v_cvt_pk_bf16_f32 v136, v20, v19
    v_accvgpr_write_b32 a192, v136
    v_and_b32 v21, s45, v137
    v_lshlrev_b32 v22, 16, v137
    v_mul_f32 v21, s44, v21
    v_mul_f32 v22, s44, v22
    v_cvt_pk_bf16_f32 v137, v22, v21
    v_accvgpr_write_b32 a193, v137
    v_and_b32 v19, s45, v138
    v_lshlrev_b32 v20, 16, v138
    v_mul_f32 v19, s44, v19
    v_mul_f32 v20, s44, v20
    v_cvt_pk_bf16_f32 v138, v20, v19
    v_accvgpr_write_b32 a194, v138
    v_and_b32 v21, s45, v139
    v_lshlrev_b32 v22, 16, v139
    v_mul_f32 v21, s44, v21
    v_mul_f32 v22, s44, v22
    v_cvt_pk_bf16_f32 v139, v22, v21
    v_accvgpr_write_b32 a195, v139
    v_and_b32 v19, s45, v140
    v_lshlrev_b32 v20, 16, v140
    v_mul_f32 v19, s44, v19
    v_mul_f32 v20, s44, v20
    v_cvt_pk_bf16_f32 v140, v20, v19
    v_accvgpr_write_b32 a196, v140
    v_and_b32 v21, s45, v141
    v_lshlrev_b32 v22, 16, v141
    v_mul_f32 v21, s44, v21
    v_mul_f32 v22, s44, v22
    v_cvt_pk_bf16_f32 v141, v22, v21
    v_accvgpr_write_b32 a197, v141
    s_waitcnt lgkmcnt(0)
    v_mfma_f32_16x16x32_bf16 v[24:27], v[152:155], a[192:195], -4.0
    v_mfma_f32_16x16x32_bf16 v[40:43], v[176:179], a[192:195], -4.0
    v_mfma_f32_16x16x32_bf16 v[56:59], v[200:203], a[192:195], -4.0
    v_mfma_f32_16x16x32_bf16 v[72:75], v[104:107], a[192:195], -4.0
    v_and_b32 v19, s45, v142
    v_lshlrev_b32 v20, 16, v142
    v_mul_f32 v19, s44, v19
    v_mul_f32 v20, s44, v20
    v_cvt_pk_bf16_f32 v142, v20, v19
    v_accvgpr_write_b32 a198, v142
    v_and_b32 v21, s45, v143
    v_lshlrev_b32 v22, 16, v143
    v_mul_f32 v21, s44, v21
    v_mul_f32 v22, s44, v22
    v_cvt_pk_bf16_f32 v143, v22, v21
    v_accvgpr_write_b32 a199, v143
    buffer_load_dwordx4 v3, s[20:23], s40 offen offset:2048 sc1 nt lds
    v_and_b32 v19, s45, v144
    v_lshlrev_b32 v20, 16, v144
    v_mul_f32 v19, s44, v19
    v_mul_f32 v20, s44, v20
    v_cvt_pk_bf16_f32 v144, v20, v19
    v_accvgpr_write_b32 a200, v144
    v_and_b32 v21, s45, v145
    v_lshlrev_b32 v22, 16, v145
    v_mul_f32 v21, s44, v21
    v_mul_f32 v22, s44, v22
    v_cvt_pk_bf16_f32 v145, v22, v21
    v_accvgpr_write_b32 a201, v145
    v_mfma_f32_16x16x32_bf16 v[24:27], v[156:159], a[196:199], v[24:27]
    v_mfma_f32_16x16x32_bf16 v[40:43], v[180:183], a[196:199], v[40:43]
    v_mfma_f32_16x16x32_bf16 v[56:59], v[204:207], a[196:199], v[56:59]
    v_mfma_f32_16x16x32_bf16 v[72:75], v[108:111], a[196:199], v[72:75]
    v_and_b32 v19, s45, v146
    v_lshlrev_b32 v20, 16, v146
    v_mul_f32 v19, s44, v19
    v_mul_f32 v20, s44, v20
    v_cvt_pk_bf16_f32 v146, v20, v19
    v_accvgpr_write_b32 a202, v146
    v_and_b32 v21, s45, v147
    v_lshlrev_b32 v22, 16, v147
    v_mul_f32 v21, s44, v21
    v_mul_f32 v22, s44, v22
    v_cvt_pk_bf16_f32 v147, v22, v21
    v_accvgpr_write_b32 a203, v147
    s_mov_b32 s40, 15360
    s_add_u32 m0, s38, 3072
    s_nop 0
    buffer_load_dwordx4 v1, s[20:23], s40 offen sc1 nt lds
    v_and_b32 v19, s45, v148
    v_lshlrev_b32 v20, 16, v148
    v_mul_f32 v19, s44, v19
    v_mul_f32 v20, s44, v20
    v_cvt_pk_bf16_f32 v148, v20, v19
    v_accvgpr_write_b32 a204, v148
    v_and_b32 v21, s45, v149
    v_lshlrev_b32 v22, 16, v149
    v_mul_f32 v21, s44, v21
    v_mul_f32 v22, s44, v22
    v_cvt_pk_bf16_f32 v149, v22, v21
    v_accvgpr_write_b32 a205, v149
    v_mfma_f32_16x16x32_bf16 v[24:27], v[160:163], a[200:203], v[24:27]
    v_mfma_f32_16x16x32_bf16 v[40:43], v[184:187], a[200:203], v[40:43]
    v_mfma_f32_16x16x32_bf16 v[56:59], v[208:211], a[200:203], v[56:59]
    v_mfma_f32_16x16x32_bf16 v[72:75], v[112:115], a[200:203], v[72:75]
    v_and_b32 v19, s45, v150
    v_lshlrev_b32 v20, 16, v150
    v_mul_f32 v19, s44, v19
    v_mul_f32 v20, s44, v20
    v_cvt_pk_bf16_f32 v150, v20, v19
    v_accvgpr_write_b32 a206, v150
    v_and_b32 v21, s45, v151
    v_lshlrev_b32 v22, 16, v151
    v_mul_f32 v21, s44, v21
    v_mul_f32 v22, s44, v22
    v_cvt_pk_bf16_f32 v151, v22, v21
    v_accvgpr_write_b32 a207, v151
    buffer_load_dwordx4 v2, s[20:23], s40 offen offset:1024 sc1 nt lds
    v_and_b32 v19, s45, v68
    v_lshlrev_b32 v20, 16, v68
    v_mul_f32 v19, s44, v19
    v_mul_f32 v20, s44, v20
    v_cvt_pk_bf16_f32 v68, v20, v19
    v_accvgpr_write_b32 a208, v68
    v_and_b32 v21, s45, v69
    v_lshlrev_b32 v22, 16, v69
    v_mul_f32 v21, s44, v21
    v_mul_f32 v22, s44, v22
    v_cvt_pk_bf16_f32 v69, v22, v21
    v_accvgpr_write_b32 a209, v69
    v_mfma_f32_16x16x32_bf16 v[24:27], v[164:167], a[204:207], v[24:27]
    v_mfma_f32_16x16x32_bf16 v[40:43], v[188:191], a[204:207], v[40:43]
    v_mfma_f32_16x16x32_bf16 v[56:59], v[212:215], a[204:207], v[56:59]
    v_mfma_f32_16x16x32_bf16 v[72:75], v[116:119], a[204:207], v[72:75]
    v_and_b32 v19, s45, v70
    v_lshlrev_b32 v20, 16, v70
    v_mul_f32 v19, s44, v19
    v_mul_f32 v20, s44, v20
    v_cvt_pk_bf16_f32 v70, v20, v19
    v_accvgpr_write_b32 a210, v70
    v_and_b32 v21, s45, v71
    v_lshlrev_b32 v22, 16, v71
    v_mul_f32 v21, s44, v21
    v_mul_f32 v22, s44, v22
    v_cvt_pk_bf16_f32 v71, v22, v21
    v_accvgpr_write_b32 a211, v71
    buffer_load_dwordx4 v3, s[20:23], s40 offen offset:2048 sc1 nt lds
    v_and_b32 v19, s45, v84
    v_lshlrev_b32 v20, 16, v84
    v_mul_f32 v19, s44, v19
    v_mul_f32 v20, s44, v20
    v_cvt_pk_bf16_f32 v84, v20, v19
    v_accvgpr_write_b32 a212, v84
    v_and_b32 v21, s45, v85
    v_lshlrev_b32 v22, 16, v85
    v_mul_f32 v21, s44, v21
    v_mul_f32 v22, s44, v22
    v_cvt_pk_bf16_f32 v85, v22, v21
    v_accvgpr_write_b32 a213, v85
    v_mfma_f32_16x16x32_bf16 v[24:27], v[168:171], a[208:211], v[24:27]
    v_mfma_f32_16x16x32_bf16 v[40:43], v[192:195], a[208:211], v[40:43]
    v_mfma_f32_16x16x32_bf16 v[56:59], v[216:219], a[208:211], v[56:59]
    v_mfma_f32_16x16x32_bf16 v[72:75], v[128:131], a[208:211], v[72:75]
    v_and_b32 v19, s45, v86
    v_lshlrev_b32 v20, 16, v86
    v_mul_f32 v19, s44, v19
    v_mul_f32 v20, s44, v20
    v_cvt_pk_bf16_f32 v86, v20, v19
    v_accvgpr_write_b32 a214, v86
    v_and_b32 v21, s45, v87
    v_lshlrev_b32 v22, 16, v87
    v_mul_f32 v21, s44, v21
    v_mul_f32 v22, s44, v22
    v_cvt_pk_bf16_f32 v87, v22, v21
    v_accvgpr_write_b32 a215, v87
    s_nop 1
    v_mfma_f32_16x16x32_bf16 v[24:27], v[172:175], a[212:215], v[24:27]
    v_mfma_f32_16x16x32_bf16 v[40:43], v[196:199], a[212:215], v[40:43]
    v_mfma_f32_16x16x32_bf16 v[56:59], v[220:223], a[212:215], v[56:59]
    v_mfma_f32_16x16x32_bf16 v[72:75], v[132:135], a[212:215], v[72:75]
    s_nop 7
    s_nop 1
    v_exp_f32 v24, v24
    v_exp_f32 v25, v25
    v_exp_f32 v26, v26
    v_exp_f32 v27, v27
    v_exp_f32 v40, v40
    v_exp_f32 v41, v41
    v_exp_f32 v42, v42
    v_exp_f32 v43, v43
    s_nop 0
    v_add_f32 v4, v4, v24
    v_add_f32 v4, v4, v25
    v_add_f32 v4, v4, v26
    v_add_f32 v4, v4, v27
    v_add_f32 v4, v4, v40
    v_add_f32 v4, v4, v41
    v_add_f32 v4, v4, v42
    v_add_f32 v4, v4, v43
    v_cvt_pk_bf16_f32 v88, v24, v25
    v_cvt_pk_bf16_f32 v89, v26, v27
    v_cvt_pk_bf16_f32 v90, v40, v41
    v_cvt_pk_bf16_f32 v91, v42, v43
    v_exp_f32 v56, v56
    v_exp_f32 v57, v57
    v_exp_f32 v58, v58
    v_exp_f32 v59, v59
    v_exp_f32 v72, v72
    v_exp_f32 v73, v73
    v_exp_f32 v74, v74
    v_exp_f32 v75, v75
    s_nop 0
    v_add_f32 v4, v4, v56
    v_add_f32 v4, v4, v57
    v_add_f32 v4, v4, v58
    v_add_f32 v4, v4, v59
    v_add_f32 v4, v4, v72
    v_add_f32 v4, v4, v73
    v_add_f32 v4, v4, v74
    v_add_f32 v4, v4, v75
    v_cvt_pk_bf16_f32 v120, v56, v57
    v_cvt_pk_bf16_f32 v121, v58, v59
    v_cvt_pk_bf16_f32 v122, v72, v73
    v_cvt_pk_bf16_f32 v123, v74, v75
    s_waitcnt vmcnt(6)
    ds_read_b128 v[136:139], v17 offset:6400
    ds_read_b128 v[140:143], v18 offset:6400
    ds_read_b128 v[144:147], v17 offset:6528
    ds_read_b128 v[148:151], v18 offset:6528
    ds_read_b128 v[68:71], v17 offset:6656
    ds_read_b128 v[84:87], v18 offset:6656
    s_waitcnt lgkmcnt(0)
    s_mov_b32 s40, 18432
    s_add_u32 m0, s38, 6400
    s_nop 0
    buffer_load_dwordx4 v1, s[20:23], s40 offen sc1 nt lds
    v_and_b32 v19, s45, v136
    v_lshlrev_b32 v20, 16, v136
    v_mul_f32 v19, s44, v19
    v_mul_f32 v20, s44, v20
    v_cvt_pk_bf16_f32 v136, v20, v19
    v_accvgpr_write_b32 a216, v136
    v_and_b32 v21, s45, v137
    v_lshlrev_b32 v22, 16, v137
    v_mul_f32 v21, s44, v21
    v_mul_f32 v22, s44, v22
    v_cvt_pk_bf16_f32 v137, v22, v21
    v_accvgpr_write_b32 a217, v137
    v_and_b32 v19, s45, v138
    v_lshlrev_b32 v20, 16, v138
    v_mul_f32 v19, s44, v19
    v_mul_f32 v20, s44, v20
    v_cvt_pk_bf16_f32 v138, v20, v19
    v_accvgpr_write_b32 a218, v138
    v_and_b32 v21, s45, v139
    v_lshlrev_b32 v22, 16, v139
    v_mul_f32 v21, s44, v21
    v_mul_f32 v22, s44, v22
    v_cvt_pk_bf16_f32 v139, v22, v21
    v_accvgpr_write_b32 a219, v139
    buffer_load_dwordx4 v2, s[20:23], s40 offen offset:1024 sc1 nt lds
    v_and_b32 v19, s45, v140
    v_lshlrev_b32 v20, 16, v140
    v_mul_f32 v19, s44, v19
    v_mul_f32 v20, s44, v20
    v_cvt_pk_bf16_f32 v140, v20, v19
    v_accvgpr_write_b32 a220, v140
    v_and_b32 v21, s45, v141
    v_lshlrev_b32 v22, 16, v141
    v_mul_f32 v21, s44, v21
    v_mul_f32 v22, s44, v22
    v_cvt_pk_bf16_f32 v141, v22, v21
    v_accvgpr_write_b32 a221, v141
    v_mfma_f32_16x16x32_bf16 v[28:31], v[152:155], a[216:219], -4.0
    v_mfma_f32_16x16x32_bf16 v[44:47], v[176:179], a[216:219], -4.0
    v_mfma_f32_16x16x32_bf16 v[60:63], v[200:203], a[216:219], -4.0
    v_mfma_f32_16x16x32_bf16 v[76:79], v[104:107], a[216:219], -4.0
    v_and_b32 v19, s45, v142
    v_lshlrev_b32 v20, 16, v142
    v_mul_f32 v19, s44, v19
    v_mul_f32 v20, s44, v20
    v_cvt_pk_bf16_f32 v142, v20, v19
    v_accvgpr_write_b32 a222, v142
    v_and_b32 v21, s45, v143
    v_lshlrev_b32 v22, 16, v143
    v_mul_f32 v21, s44, v21
    v_mul_f32 v22, s44, v22
    v_cvt_pk_bf16_f32 v143, v22, v21
    v_accvgpr_write_b32 a223, v143
    buffer_load_dwordx4 v3, s[20:23], s40 offen offset:2048 sc1 nt lds
    v_and_b32 v19, s45, v144
    v_lshlrev_b32 v20, 16, v144
    v_mul_f32 v19, s44, v19
    v_mul_f32 v20, s44, v20
    v_cvt_pk_bf16_f32 v144, v20, v19
    v_accvgpr_write_b32 a224, v144
    v_and_b32 v21, s45, v145
    v_lshlrev_b32 v22, 16, v145
    v_mul_f32 v21, s44, v21
    v_mul_f32 v22, s44, v22
    v_cvt_pk_bf16_f32 v145, v22, v21
    v_accvgpr_write_b32 a225, v145
    v_mfma_f32_16x16x32_bf16 v[28:31], v[156:159], a[220:223], v[28:31]
    v_mfma_f32_16x16x32_bf16 v[44:47], v[180:183], a[220:223], v[44:47]
    v_mfma_f32_16x16x32_bf16 v[60:63], v[204:207], a[220:223], v[60:63]
    v_mfma_f32_16x16x32_bf16 v[76:79], v[108:111], a[220:223], v[76:79]
    v_and_b32 v19, s45, v146
    v_lshlrev_b32 v20, 16, v146
    v_mul_f32 v19, s44, v19
    v_mul_f32 v20, s44, v20
    v_cvt_pk_bf16_f32 v146, v20, v19
    v_accvgpr_write_b32 a226, v146
    v_and_b32 v21, s45, v147
    v_lshlrev_b32 v22, 16, v147
    v_mul_f32 v21, s44, v21
    v_mul_f32 v22, s44, v22
    v_cvt_pk_bf16_f32 v147, v22, v21
    v_accvgpr_write_b32 a227, v147
    s_mov_b32 s40, 21504
    s_add_u32 m0, s38, 9472
    s_nop 0
    buffer_load_dwordx4 v1, s[20:23], s40 offen sc1 nt lds
    v_and_b32 v19, s45, v148
    v_lshlrev_b32 v20, 16, v148
    v_mul_f32 v19, s44, v19
    v_mul_f32 v20, s44, v20
    v_cvt_pk_bf16_f32 v148, v20, v19
    v_accvgpr_write_b32 a228, v148
    v_and_b32 v21, s45, v149
    v_lshlrev_b32 v22, 16, v149
    v_mul_f32 v21, s44, v21
    v_mul_f32 v22, s44, v22
    v_cvt_pk_bf16_f32 v149, v22, v21
    v_accvgpr_write_b32 a229, v149
    v_mfma_f32_16x16x32_bf16 v[28:31], v[160:163], a[224:227], v[28:31]
    v_mfma_f32_16x16x32_bf16 v[44:47], v[184:187], a[224:227], v[44:47]
    v_mfma_f32_16x16x32_bf16 v[60:63], v[208:211], a[224:227], v[60:63]
    v_mfma_f32_16x16x32_bf16 v[76:79], v[112:115], a[224:227], v[76:79]
    v_and_b32 v19, s45, v150
    v_lshlrev_b32 v20, 16, v150
    v_mul_f32 v19, s44, v19
    v_mul_f32 v20, s44, v20
    v_cvt_pk_bf16_f32 v150, v20, v19
    v_accvgpr_write_b32 a230, v150
    v_and_b32 v21, s45, v151
    v_lshlrev_b32 v22, 16, v151
    v_mul_f32 v21, s44, v21
    v_mul_f32 v22, s44, v22
    v_cvt_pk_bf16_f32 v151, v22, v21
    v_accvgpr_write_b32 a231, v151
    buffer_load_dwordx4 v2, s[20:23], s40 offen offset:1024 sc1 nt lds
    v_and_b32 v19, s45, v68
    v_lshlrev_b32 v20, 16, v68
    v_mul_f32 v19, s44, v19
    v_mul_f32 v20, s44, v20
    v_cvt_pk_bf16_f32 v68, v20, v19
    v_accvgpr_write_b32 a232, v68
    v_and_b32 v21, s45, v69
    v_lshlrev_b32 v22, 16, v69
    v_mul_f32 v21, s44, v21
    v_mul_f32 v22, s44, v22
    v_cvt_pk_bf16_f32 v69, v22, v21
    v_accvgpr_write_b32 a233, v69
    v_mfma_f32_16x16x32_bf16 v[28:31], v[164:167], a[228:231], v[28:31]
    v_mfma_f32_16x16x32_bf16 v[44:47], v[188:191], a[228:231], v[44:47]
    v_mfma_f32_16x16x32_bf16 v[60:63], v[212:215], a[228:231], v[60:63]
    v_mfma_f32_16x16x32_bf16 v[76:79], v[116:119], a[228:231], v[76:79]
    v_and_b32 v19, s45, v70
    v_lshlrev_b32 v20, 16, v70
    v_mul_f32 v19, s44, v19
    v_mul_f32 v20, s44, v20
    v_cvt_pk_bf16_f32 v70, v20, v19
    v_accvgpr_write_b32 a234, v70
    v_and_b32 v21, s45, v71
    v_lshlrev_b32 v22, 16, v71
    v_mul_f32 v21, s44, v21
    v_mul_f32 v22, s44, v22
    v_cvt_pk_bf16_f32 v71, v22, v21
    v_accvgpr_write_b32 a235, v71
    buffer_load_dwordx4 v3, s[20:23], s40 offen offset:2048 sc1 nt lds
    v_and_b32 v19, s45, v84
    v_lshlrev_b32 v20, 16, v84
    v_mul_f32 v19, s44, v19
    v_mul_f32 v20, s44, v20
    v_cvt_pk_bf16_f32 v84, v20, v19
    v_accvgpr_write_b32 a236, v84
    v_and_b32 v21, s45, v85
    v_lshlrev_b32 v22, 16, v85
    v_mul_f32 v21, s44, v21
    v_mul_f32 v22, s44, v22
    v_cvt_pk_bf16_f32 v85, v22, v21
    v_accvgpr_write_b32 a237, v85
    v_mfma_f32_16x16x32_bf16 v[28:31], v[168:171], a[232:235], v[28:31]
    v_mfma_f32_16x16x32_bf16 v[44:47], v[192:195], a[232:235], v[44:47]
    v_mfma_f32_16x16x32_bf16 v[60:63], v[216:219], a[232:235], v[60:63]
    v_mfma_f32_16x16x32_bf16 v[76:79], v[128:131], a[232:235], v[76:79]
    v_and_b32 v19, s45, v86
    v_lshlrev_b32 v20, 16, v86
    v_mul_f32 v19, s44, v19
    v_mul_f32 v20, s44, v20
    v_cvt_pk_bf16_f32 v86, v20, v19
    v_accvgpr_write_b32 a238, v86
    v_and_b32 v21, s45, v87
    v_lshlrev_b32 v22, 16, v87
    v_mul_f32 v21, s44, v21
    v_mul_f32 v22, s44, v22
    v_cvt_pk_bf16_f32 v87, v22, v21
    v_accvgpr_write_b32 a239, v87
    s_nop 1
    v_mfma_f32_16x16x32_bf16 v[28:31], v[172:175], a[236:239], v[28:31]
    v_mfma_f32_16x16x32_bf16 v[44:47], v[196:199], a[236:239], v[44:47]
    v_mfma_f32_16x16x32_bf16 v[60:63], v[220:223], a[236:239], v[60:63]
    v_mfma_f32_16x16x32_bf16 v[76:79], v[132:135], a[236:239], v[76:79]
    s_nop 7
    s_nop 1
    v_exp_f32 v28, v28
    v_exp_f32 v29, v29
    v_exp_f32 v30, v30
    v_exp_f32 v31, v31
    v_exp_f32 v44, v44
    v_exp_f32 v45, v45
    v_exp_f32 v46, v46
    v_exp_f32 v47, v47
    s_nop 0
    v_add_f32 v5, v5, v28
    v_add_f32 v5, v5, v29
    v_add_f32 v5, v5, v30
    v_add_f32 v5, v5, v31
    v_add_f32 v5, v5, v44
    v_add_f32 v5, v5, v45
    v_add_f32 v5, v5, v46
    v_add_f32 v5, v5, v47
    v_cvt_pk_bf16_f32 v92, v28, v29
    v_cvt_pk_bf16_f32 v93, v30, v31
    v_cvt_pk_bf16_f32 v94, v44, v45
    v_cvt_pk_bf16_f32 v95, v46, v47
    v_exp_f32 v60, v60
    v_exp_f32 v61, v61
    v_exp_f32 v62, v62
    v_exp_f32 v63, v63
    v_exp_f32 v76, v76
    v_exp_f32 v77, v77
    v_exp_f32 v78, v78
    v_exp_f32 v79, v79
    s_nop 0
    v_add_f32 v5, v5, v60
    v_add_f32 v5, v5, v61
    v_add_f32 v5, v5, v62
    v_add_f32 v5, v5, v63
    v_add_f32 v5, v5, v76
    v_add_f32 v5, v5, v77
    v_add_f32 v5, v5, v78
    v_add_f32 v5, v5, v79
    v_cvt_pk_bf16_f32 v124, v60, v61
    v_cvt_pk_bf16_f32 v125, v62, v63
    v_cvt_pk_bf16_f32 v126, v76, v77
    v_cvt_pk_bf16_f32 v127, v78, v79
    s_waitcnt vmcnt(6)
    ds_read_b128 v[136:139], v17 offset:0
    ds_read_b128 v[140:143], v18 offset:0
    ds_read_b128 v[144:147], v17 offset:128
    ds_read_b128 v[148:151], v18 offset:128
    ds_read_b128 v[224:227], v17 offset:256
    ds_read_b128 v[228:231], v18 offset:256
    s_waitcnt lgkmcnt(0)
    s_mov_b32 s41, 24576
    s_add_u32 m0, s35, 24576
    s_nop 0
    buffer_load_dwordx4 v14, s[8:11], s41 offen lds
    buffer_load_dwordx4 v15, s[8:11], s41 offen offset:1024 lds
    buffer_load_dwordx4 v16, s[8:11], s41 offen offset:2048 lds
    v_and_b32 v19, s45, v136
    v_lshlrev_b32 v20, 16, v136
    v_mul_f32 v19, s44, v19
    v_mul_f32 v20, s44, v20
    v_cvt_pk_bf16_f32 v136, v20, v19
    v_accvgpr_write_b32 a240, v136
    v_and_b32 v21, s45, v137
    v_lshlrev_b32 v22, 16, v137
    v_mul_f32 v21, s44, v21
    v_mul_f32 v22, s44, v22
    v_cvt_pk_bf16_f32 v137, v22, v21
    v_accvgpr_write_b32 a241, v137
    v_and_b32 v19, s45, v138
    v_lshlrev_b32 v20, 16, v138
    v_mul_f32 v19, s44, v19
    v_mul_f32 v20, s44, v20
    v_cvt_pk_bf16_f32 v138, v20, v19
    v_accvgpr_write_b32 a242, v138
    v_and_b32 v21, s45, v139
    v_lshlrev_b32 v22, 16, v139
    v_mul_f32 v21, s44, v21
    v_mul_f32 v22, s44, v22
    v_cvt_pk_bf16_f32 v139, v22, v21
    v_accvgpr_write_b32 a243, v139
    v_and_b32 v19, s45, v140
    v_lshlrev_b32 v20, 16, v140
    v_mul_f32 v19, s44, v19
    v_mul_f32 v20, s44, v20
    v_cvt_pk_bf16_f32 v140, v20, v19
    v_accvgpr_write_b32 a244, v140
    v_and_b32 v21, s45, v141
    v_lshlrev_b32 v22, 16, v141
    v_mul_f32 v21, s44, v21
    v_mul_f32 v22, s44, v22
    v_cvt_pk_bf16_f32 v141, v22, v21
    v_accvgpr_write_b32 a245, v141
    v_mfma_f32_16x16x32_bf16 v[32:35], v[152:155], a[240:243], -4.0
    v_mfma_f32_16x16x32_bf16 v[48:51], v[176:179], a[240:243], -4.0
    v_mfma_f32_16x16x32_bf16 v[64:67], v[200:203], a[240:243], -4.0
    v_mfma_f32_16x16x32_bf16 v[80:83], v[104:107], a[240:243], -4.0
    v_and_b32 v19, s45, v142
    v_lshlrev_b32 v20, 16, v142
    v_mul_f32 v19, s44, v19
    v_mul_f32 v20, s44, v20
    v_cvt_pk_bf16_f32 v142, v20, v19
    v_accvgpr_write_b32 a246, v142
    v_and_b32 v21, s45, v143
    v_lshlrev_b32 v22, 16, v143
    v_mul_f32 v21, s44, v21
    v_mul_f32 v22, s44, v22
    v_cvt_pk_bf16_f32 v143, v22, v21
    v_accvgpr_write_b32 a247, v143
    v_and_b32 v19, s45, v144
    v_lshlrev_b32 v20, 16, v144
    v_mul_f32 v19, s44, v19
    v_mul_f32 v20, s44, v20
    v_cvt_pk_bf16_f32 v144, v20, v19
    v_accvgpr_write_b32 a248, v144
    v_and_b32 v21, s45, v145
    v_lshlrev_b32 v22, 16, v145
    v_mul_f32 v21, s44, v21
    v_mul_f32 v22, s44, v22
    v_cvt_pk_bf16_f32 v145, v22, v21
    v_accvgpr_write_b32 a249, v145
    v_mfma_f32_16x16x32_bf16 v[32:35], v[156:159], a[244:247], v[32:35]
    v_mfma_f32_16x16x32_bf16 v[48:51], v[180:183], a[244:247], v[48:51]
    v_mfma_f32_16x16x32_bf16 v[64:67], v[204:207], a[244:247], v[64:67]
    v_mfma_f32_16x16x32_bf16 v[80:83], v[108:111], a[244:247], v[80:83]
    v_and_b32 v19, s45, v146
    v_lshlrev_b32 v20, 16, v146
    v_mul_f32 v19, s44, v19
    v_mul_f32 v20, s44, v20
    v_cvt_pk_bf16_f32 v146, v20, v19
    v_accvgpr_write_b32 a250, v146
    v_and_b32 v21, s45, v147
    v_lshlrev_b32 v22, 16, v147
    v_mul_f32 v21, s44, v21
    v_mul_f32 v22, s44, v22
    v_cvt_pk_bf16_f32 v147, v22, v21
    v_accvgpr_write_b32 a251, v147
    s_mov_b32 s41, 36864
    s_add_u32 m0, s35, 36864
    s_nop 0
    buffer_load_dwordx4 v14, s[8:11], s41 offen lds
    buffer_load_dwordx4 v15, s[8:11], s41 offen offset:1024 lds
    buffer_load_dwordx4 v16, s[8:11], s41 offen offset:2048 lds
    v_and_b32 v19, s45, v148
    v_lshlrev_b32 v20, 16, v148
    v_mul_f32 v19, s44, v19
    v_mul_f32 v20, s44, v20
    v_cvt_pk_bf16_f32 v148, v20, v19
    v_accvgpr_write_b32 a252, v148
    v_and_b32 v21, s45, v149
    v_lshlrev_b32 v22, 16, v149
    v_mul_f32 v21, s44, v21
    v_mul_f32 v22, s44, v22
    v_cvt_pk_bf16_f32 v149, v22, v21
    v_accvgpr_write_b32 a253, v149
    v_mfma_f32_16x16x32_bf16 v[32:35], v[160:163], a[248:251], v[32:35]
    v_mfma_f32_16x16x32_bf16 v[48:51], v[184:187], a[248:251], v[48:51]
    v_mfma_f32_16x16x32_bf16 v[64:67], v[208:211], a[248:251], v[64:67]
    v_mfma_f32_16x16x32_bf16 v[80:83], v[112:115], a[248:251], v[80:83]
    v_and_b32 v19, s45, v150
    v_lshlrev_b32 v20, 16, v150
    v_mul_f32 v19, s44, v19
    v_mul_f32 v20, s44, v20
    v_cvt_pk_bf16_f32 v150, v20, v19
    v_accvgpr_write_b32 a254, v150
    v_and_b32 v21, s45, v151
    v_lshlrev_b32 v22, 16, v151
    v_mul_f32 v21, s44, v21
    v_mul_f32 v22, s44, v22
    v_cvt_pk_bf16_f32 v151, v22, v21
    v_accvgpr_write_b32 a255, v151
    v_and_b32 v19, s45, v224
    v_lshlrev_b32 v20, 16, v224
    v_mul_f32 v19, s44, v19
    v_mul_f32 v20, s44, v20
    v_cvt_pk_bf16_f32 v224, v20, v19
    v_and_b32 v21, s45, v225
    v_lshlrev_b32 v22, 16, v225
    v_mul_f32 v21, s44, v21
    v_mul_f32 v22, s44, v22
    v_cvt_pk_bf16_f32 v225, v22, v21
    v_mfma_f32_16x16x32_bf16 v[32:35], v[164:167], a[252:255], v[32:35]
    v_mfma_f32_16x16x32_bf16 v[48:51], v[188:191], a[252:255], v[48:51]
    v_mfma_f32_16x16x32_bf16 v[64:67], v[212:215], a[252:255], v[64:67]
    v_mfma_f32_16x16x32_bf16 v[80:83], v[116:119], a[252:255], v[80:83]
    v_and_b32 v19, s45, v226
    v_lshlrev_b32 v20, 16, v226
    v_mul_f32 v19, s44, v19
    v_mul_f32 v20, s44, v20
    v_cvt_pk_bf16_f32 v226, v20, v19
    v_and_b32 v21, s45, v227
    v_lshlrev_b32 v22, 16, v227
    v_mul_f32 v21, s44, v21
    v_mul_f32 v22, s44, v22
    v_cvt_pk_bf16_f32 v227, v22, v21
    v_and_b32 v19, s45, v228
    v_lshlrev_b32 v20, 16, v228
    v_mul_f32 v19, s44, v19
    v_mul_f32 v20, s44, v20
    v_cvt_pk_bf16_f32 v228, v20, v19
    v_and_b32 v21, s45, v229
    v_lshlrev_b32 v22, 16, v229
    v_mul_f32 v21, s44, v21
    v_mul_f32 v22, s44, v22
    v_cvt_pk_bf16_f32 v229, v22, v21
    v_mfma_f32_16x16x32_bf16 v[32:35], v[168:171], v[224:227], v[32:35]
    v_mfma_f32_16x16x32_bf16 v[48:51], v[192:195], v[224:227], v[48:51]
    v_mfma_f32_16x16x32_bf16 v[64:67], v[216:219], v[224:227], v[64:67]
    v_mfma_f32_16x16x32_bf16 v[80:83], v[128:131], v[224:227], v[80:83]
    v_and_b32 v19, s45, v230
    v_lshlrev_b32 v20, 16, v230
    v_mul_f32 v19, s44, v19
    v_mul_f32 v20, s44, v20
    v_cvt_pk_bf16_f32 v230, v20, v19
    v_and_b32 v21, s45, v231
    v_lshlrev_b32 v22, 16, v231
    v_mul_f32 v21, s44, v21
    v_mul_f32 v22, s44, v22
    v_cvt_pk_bf16_f32 v231, v22, v21
    s_nop 1
    v_mfma_f32_16x16x32_bf16 v[32:35], v[172:175], v[228:231], v[32:35]
    v_mfma_f32_16x16x32_bf16 v[48:51], v[196:199], v[228:231], v[48:51]
    v_mfma_f32_16x16x32_bf16 v[64:67], v[220:223], v[228:231], v[64:67]
    v_mfma_f32_16x16x32_bf16 v[80:83], v[132:135], v[228:231], v[80:83]
    s_nop 7
    s_nop 1
    v_exp_f32 v32, v32
    v_exp_f32 v33, v33
    v_exp_f32 v34, v34
    v_exp_f32 v35, v35
    v_exp_f32 v48, v48
    v_exp_f32 v49, v49
    v_exp_f32 v50, v50
    v_exp_f32 v51, v51
    s_nop 0
    v_add_f32 v6, v6, v32
    v_add_f32 v6, v6, v33
    v_add_f32 v6, v6, v34
    v_add_f32 v6, v6, v35
    v_add_f32 v6, v6, v48
    v_add_f32 v6, v6, v49
    v_add_f32 v6, v6, v50
    v_add_f32 v6, v6, v51
    v_cvt_pk_bf16_f32 v96, v32, v33
    v_cvt_pk_bf16_f32 v97, v34, v35
    v_cvt_pk_bf16_f32 v98, v48, v49
    v_cvt_pk_bf16_f32 v99, v50, v51
    s_waitcnt vmcnt(3)
    s_barrier
    s_waitcnt vmcnt(6)
    ds_read_b128 v[232:235], v17 offset:6400
    ds_read_b128 v[236:239], v18 offset:6400
    ds_read_b128 v[240:243], v17 offset:6528
    ds_read_b128 v[244:247], v18 offset:6528
    ds_read_b128 v[248:251], v17 offset:6656
    ds_read_b128 v[252:255], v18 offset:6656
    s_waitcnt lgkmcnt(0)
    s_mov_b32 s41, 49152
    s_add_u32 m0, s35, 0
    s_nop 0
    buffer_load_dwordx4 v14, s[8:11], s41 offen lds
    buffer_load_dwordx4 v15, s[8:11], s41 offen offset:1024 lds
    buffer_load_dwordx4 v16, s[8:11], s41 offen offset:2048 lds
    v_and_b32 v19, s45, v232
    v_lshlrev_b32 v20, 16, v232
    v_mul_f32 v19, s44, v19
    v_mul_f32 v20, s44, v20
    v_cvt_pk_bf16_f32 v232, v20, v19
    v_and_b32 v21, s45, v233
    v_lshlrev_b32 v22, 16, v233
    v_mul_f32 v21, s44, v21
    v_mul_f32 v22, s44, v22
    v_cvt_pk_bf16_f32 v233, v22, v21
    v_and_b32 v19, s45, v234
    v_lshlrev_b32 v20, 16, v234
    v_mul_f32 v19, s44, v19
    v_mul_f32 v20, s44, v20
    v_cvt_pk_bf16_f32 v234, v20, v19
    v_and_b32 v21, s45, v235
    v_lshlrev_b32 v22, 16, v235
    v_mul_f32 v21, s44, v21
    v_mul_f32 v22, s44, v22
    v_cvt_pk_bf16_f32 v235, v22, v21
    v_and_b32 v19, s45, v236
    v_lshlrev_b32 v20, 16, v236
    v_mul_f32 v19, s44, v19
    v_mul_f32 v20, s44, v20
    v_cvt_pk_bf16_f32 v236, v20, v19
    v_and_b32 v21, s45, v237
    v_lshlrev_b32 v22, 16, v237
    v_mul_f32 v21, s44, v21
    v_mul_f32 v22, s44, v22
    v_cvt_pk_bf16_f32 v237, v22, v21
    v_mfma_f32_16x16x32_bf16 v[36:39], v[152:155], v[232:235], -4.0
    v_mfma_f32_16x16x32_bf16 v[52:55], v[176:179], v[232:235], -4.0
    v_mfma_f32_16x16x32_bf16 v[68:71], v[200:203], v[232:235], -4.0
    v_mfma_f32_16x16x32_bf16 v[84:87], v[104:107], v[232:235], -4.0
    v_and_b32 v19, s45, v238
    v_lshlrev_b32 v20, 16, v238
    v_mul_f32 v19, s44, v19
    v_mul_f32 v20, s44, v20
    v_cvt_pk_bf16_f32 v238, v20, v19
    v_and_b32 v21, s45, v239
    v_lshlrev_b32 v22, 16, v239
    v_mul_f32 v21, s44, v21
    v_mul_f32 v22, s44, v22
    v_cvt_pk_bf16_f32 v239, v22, v21
    s_mov_b32 s41, 0
    s_add_u32 m0, s36, 0
    s_nop 0
    buffer_load_dwordx4 v14, s[12:15], s41 offen lds
    buffer_load_dwordx4 v15, s[12:15], s41 offen offset:1024 lds
    buffer_load_dwordx4 v16, s[12:15], s41 offen offset:2048 lds
    v_and_b32 v19, s45, v240
    v_lshlrev_b32 v20, 16, v240
    v_mul_f32 v19, s44, v19
    v_mul_f32 v20, s44, v20
    v_cvt_pk_bf16_f32 v240, v20, v19
    v_and_b32 v21, s45, v241
    v_lshlrev_b32 v22, 16, v241
    v_mul_f32 v21, s44, v21
    v_mul_f32 v22, s44, v22
    v_cvt_pk_bf16_f32 v241, v22, v21
    v_mfma_f32_16x16x32_bf16 v[36:39], v[156:159], v[236:239], v[36:39]
    v_mfma_f32_16x16x32_bf16 v[52:55], v[180:183], v[236:239], v[52:55]
    v_mfma_f32_16x16x32_bf16 v[68:71], v[204:207], v[236:239], v[68:71]
    v_mfma_f32_16x16x32_bf16 v[84:87], v[108:111], v[236:239], v[84:87]
    v_and_b32 v19, s45, v242
    v_lshlrev_b32 v20, 16, v242
    v_mul_f32 v19, s44, v19
    v_mul_f32 v20, s44, v20
    v_cvt_pk_bf16_f32 v242, v20, v19
    v_and_b32 v21, s45, v243
    v_lshlrev_b32 v22, 16, v243
    v_mul_f32 v21, s44, v21
    v_mul_f32 v22, s44, v22
    v_cvt_pk_bf16_f32 v243, v22, v21
    v_and_b32 v19, s45, v244
    v_lshlrev_b32 v20, 16, v244
    v_mul_f32 v19, s44, v19
    v_mul_f32 v20, s44, v20
    v_cvt_pk_bf16_f32 v244, v20, v19
    v_and_b32 v21, s45, v245
    v_lshlrev_b32 v22, 16, v245
    v_mul_f32 v21, s44, v21
    v_mul_f32 v22, s44, v22
    v_cvt_pk_bf16_f32 v245, v22, v21
    v_mfma_f32_16x16x32_bf16 v[36:39], v[160:163], v[240:243], v[36:39]
    v_mfma_f32_16x16x32_bf16 v[52:55], v[184:187], v[240:243], v[52:55]
    v_mfma_f32_16x16x32_bf16 v[68:71], v[208:211], v[240:243], v[68:71]
    v_mfma_f32_16x16x32_bf16 v[84:87], v[112:115], v[240:243], v[84:87]
    v_and_b32 v19, s45, v246
    v_lshlrev_b32 v20, 16, v246
    v_mul_f32 v19, s44, v19
    v_mul_f32 v20, s44, v20
    v_cvt_pk_bf16_f32 v246, v20, v19
    v_and_b32 v21, s45, v247
    v_lshlrev_b32 v22, 16, v247
    v_mul_f32 v21, s44, v21
    v_mul_f32 v22, s44, v22
    v_cvt_pk_bf16_f32 v247, v22, v21
    s_mov_b32 s41, 12288
    s_add_u32 m0, s36, 12288
    s_nop 0
    buffer_load_dwordx4 v14, s[12:15], s41 offen lds
    buffer_load_dwordx4 v15, s[12:15], s41 offen offset:1024 lds
    buffer_load_dwordx4 v16, s[12:15], s41 offen offset:2048 lds
    v_and_b32 v19, s45, v248
    v_lshlrev_b32 v20, 16, v248
    v_mul_f32 v19, s44, v19
    v_mul_f32 v20, s44, v20
    v_cvt_pk_bf16_f32 v248, v20, v19
    v_and_b32 v21, s45, v249
    v_lshlrev_b32 v22, 16, v249
    v_mul_f32 v21, s44, v21
    v_mul_f32 v22, s44, v22
    v_cvt_pk_bf16_f32 v249, v22, v21
    v_mfma_f32_16x16x32_bf16 v[36:39], v[164:167], v[244:247], v[36:39]
    v_mfma_f32_16x16x32_bf16 v[52:55], v[188:191], v[244:247], v[52:55]
    v_mfma_f32_16x16x32_bf16 v[68:71], v[212:215], v[244:247], v[68:71]
    v_mfma_f32_16x16x32_bf16 v[84:87], v[116:119], v[244:247], v[84:87]
    v_and_b32 v19, s45, v250
    v_lshlrev_b32 v20, 16, v250
    v_mul_f32 v19, s44, v19
    v_mul_f32 v20, s44, v20
    v_cvt_pk_bf16_f32 v250, v20, v19
    v_and_b32 v21, s45, v251
    v_lshlrev_b32 v22, 16, v251
    v_mul_f32 v21, s44, v21
    v_mul_f32 v22, s44, v22
    v_cvt_pk_bf16_f32 v251, v22, v21
    v_and_b32 v19, s45, v252
    v_lshlrev_b32 v20, 16, v252
    v_mul_f32 v19, s44, v19
    v_mul_f32 v20, s44, v20
    v_cvt_pk_bf16_f32 v252, v20, v19
    v_and_b32 v21, s45, v253
    v_lshlrev_b32 v22, 16, v253
    v_mul_f32 v21, s44, v21
    v_mul_f32 v22, s44, v22
    v_cvt_pk_bf16_f32 v253, v22, v21
    v_mfma_f32_16x16x32_bf16 v[36:39], v[168:171], v[248:251], v[36:39]
    v_mfma_f32_16x16x32_bf16 v[52:55], v[192:195], v[248:251], v[52:55]
    v_mfma_f32_16x16x32_bf16 v[68:71], v[216:219], v[248:251], v[68:71]
    v_mfma_f32_16x16x32_bf16 v[84:87], v[128:131], v[248:251], v[84:87]
    v_and_b32 v19, s45, v254
    v_lshlrev_b32 v20, 16, v254
    v_mul_f32 v19, s44, v19
    v_mul_f32 v20, s44, v20
    v_cvt_pk_bf16_f32 v254, v20, v19
    v_and_b32 v21, s45, v255
    v_lshlrev_b32 v22, 16, v255
    v_mul_f32 v21, s44, v21
    v_mul_f32 v22, s44, v22
    v_cvt_pk_bf16_f32 v255, v22, v21
    s_nop 1
    v_mfma_f32_16x16x32_bf16 v[36:39], v[172:175], v[252:255], v[36:39]
    v_mfma_f32_16x16x32_bf16 v[52:55], v[196:199], v[252:255], v[52:55]
    v_mfma_f32_16x16x32_bf16 v[68:71], v[220:223], v[252:255], v[68:71]
    v_mfma_f32_16x16x32_bf16 v[84:87], v[132:135], v[252:255], v[84:87]
    ds_read_b128 v[152:155], v8 offset:24576
    ds_read_b128 v[156:159], v9 offset:24576
    ds_read_b128 v[160:163], v8 offset:24704
    ds_read_b128 v[164:167], v9 offset:24704
    ds_read_b128 v[168:171], v8 offset:24832
    ds_read_b128 v[172:175], v9 offset:24832
    s_nop 7
    s_nop 1
    v_exp_f32 v36, v36
    v_exp_f32 v37, v37
    v_exp_f32 v38, v38
    v_exp_f32 v39, v39
    v_exp_f32 v52, v52
    v_exp_f32 v53, v53
    v_exp_f32 v54, v54
    v_exp_f32 v55, v55
    s_nop 0
    v_add_f32 v7, v7, v36
    v_add_f32 v7, v7, v37
    v_add_f32 v7, v7, v38
    v_add_f32 v7, v7, v39
    v_add_f32 v7, v7, v52
    v_add_f32 v7, v7, v53
    v_add_f32 v7, v7, v54
    v_add_f32 v7, v7, v55
    v_cvt_pk_bf16_f32 v100, v36, v37
    v_cvt_pk_bf16_f32 v101, v38, v39
    v_cvt_pk_bf16_f32 v102, v52, v53
    v_cvt_pk_bf16_f32 v103, v54, v55
    s_waitcnt lgkmcnt(0)
    .p2align 6
L_loop0:
    v_mfma_f32_16x16x32_bf16 v[24:27], v[152:155], a[192:195], -4.0
    s_waitcnt vmcnt(9)
    ds_read_b128 v[176:179], v8 offset:30720
    v_mfma_f32_16x16x32_bf16 v[24:27], v[156:159], a[196:199], v[24:27]
    s_barrier
    v_exp_f32 v64, v64
    v_mfma_f32_16x16x32_bf16 v[24:27], v[160:163], a[200:203], v[24:27]
    s_add_u32 m0, s35, 12288
    ds_read_b128 v[180:183], v9 offset:30720
    v_add_f32 v6, v6, v64
    v_mfma_f32_16x16x32_bf16 v[24:27], v[164:167], a[204:207], v[24:27]
    buffer_load_dwordx4 v14, s[8:11], s25 offen lds
    v_mfma_f32_16x16x32_bf16 v[24:27], v[168:171], a[208:211], v[24:27]
    ds_read_b128 v[184:187], v8 offset:30848
    v_mfma_f32_16x16x32_bf16 v[24:27], v[172:175], a[212:215], v[24:27]
    v_exp_f32 v65, v65
    v_mfma_f32_16x16x32_bf16 v[28:31], v[172:175], a[236:239], -4.0
    ds_read_b128 v[188:191], v9 offset:30848
    v_add_f32 v6, v6, v65
    v_mfma_f32_16x16x32_bf16 v[28:31], v[168:171], a[232:235], v[28:31]
    buffer_load_dwordx4 v15, s[8:11], s25 offen offset:1024 lds
    v_mfma_f32_16x16x32_bf16 v[28:31], v[164:167], a[228:231], v[28:31]
    ds_read_b128 v[192:195], v8 offset:30976
    v_cvt_pk_bf16_f32 v128, v64, v65
    v_mfma_f32_16x16x32_bf16 v[28:31], v[160:163], a[224:227], v[28:31]
    v_exp_f32 v66, v66
    v_mfma_f32_16x16x32_bf16 v[28:31], v[156:159], a[220:223], v[28:31]
    ds_read_b128 v[196:199], v9 offset:30976
    v_add_f32 v6, v6, v66
    v_mfma_f32_16x16x32_bf16 v[28:31], v[152:155], a[216:219], v[28:31]
    buffer_load_dwordx4 v16, s[8:11], s25 offen offset:2048 lds
    v_mfma_f32_16x16x32_bf16 v[32:35], v[152:155], a[240:243], -4.0
    s_add_u32 s25, s25, 12288
    v_exp_f32 v67, v67
    v_mfma_f32_16x16x32_bf16 v[32:35], v[156:159], a[244:247], v[32:35]
    s_min_u32 s25, s25, 774144
    v_add_f32 v6, v6, v67
    v_cvt_pk_bf16_f32 v129, v66, v67
    v_mfma_f32_16x16x32_bf16 v[32:35], v[160:163], a[248:251], v[32:35]
    v_exp_f32 v80, v80
    v_mfma_f32_16x16x32_bf16 v[32:35], v[164:167], a[252:255], v[32:35]
    v_exp_f32 v81, v81
    v_mfma_f32_16x16x32_bf16 v[32:35], v[168:171], v[224:227], v[32:35]
    v_add_f32 v6, v6, v80
    v_add_f32 v6, v6, v81
    v_mfma_f32_16x16x32_bf16 v[32:35], v[172:175], v[228:231], v[32:35]
    v_cvt_pk_bf16_f32 v130, v80, v81
    v_mfma_f32_16x16x32_bf16 v[36:39], v[172:175], v[252:255], -4.0
    v_exp_f32 v82, v82
    v_mfma_f32_16x16x32_bf16 v[36:39], v[168:171], v[248:251], v[36:39]
    v_exp_f32 v83, v83
    v_mfma_f32_16x16x32_bf16 v[36:39], v[164:167], v[244:247], v[36:39]
    v_add_f32 v6, v6, v82
    v_add_f32 v6, v6, v83
    v_mfma_f32_16x16x32_bf16 v[36:39], v[160:163], v[240:243], v[36:39]
    v_cvt_pk_bf16_f32 v131, v82, v83
    v_mfma_f32_16x16x32_bf16 v[36:39], v[156:159], v[236:239], v[36:39]
    s_waitcnt lgkmcnt(0)
    v_exp_f32 v68, v68
    v_mfma_f32_16x16x32_bf16 v[36:39], v[152:155], v[232:235], v[36:39]
    v_exp_f32 v69, v69
    v_mfma_f32_16x16x32_bf16 v[40:43], v[176:179], a[192:195], -4.0
    v_add_f32 v7, v7, v68
    v_add_f32 v7, v7, v69
    v_mfma_f32_16x16x32_bf16 v[40:43], v[180:183], a[196:199], v[40:43]
    v_cvt_pk_bf16_f32 v132, v68, v69
    v_mfma_f32_16x16x32_bf16 v[40:43], v[184:187], a[200:203], v[40:43]
    ds_read_b128 v[152:155], v8 offset:36864
    v_mfma_f32_16x16x32_bf16 v[40:43], v[188:191], a[204:207], v[40:43]
    v_exp_f32 v70, v70
    v_mfma_f32_16x16x32_bf16 v[40:43], v[192:195], a[208:211], v[40:43]
    ds_read_b128 v[156:159], v9 offset:36864
    v_mfma_f32_16x16x32_bf16 v[40:43], v[196:199], a[212:215], v[40:43]
    v_exp_f32 v71, v71
    v_mfma_f32_16x16x32_bf16 v[44:47], v[196:199], a[236:239], -4.0
    ds_read_b128 v[160:163], v8 offset:36992
    v_add_f32 v7, v7, v70
    v_mfma_f32_16x16x32_bf16 v[44:47], v[192:195], a[232:235], v[44:47]
    v_add_f32 v7, v7, v71
    v_cvt_pk_bf16_f32 v133, v70, v71
    v_mfma_f32_16x16x32_bf16 v[44:47], v[188:191], a[228:231], v[44:47]
    ds_read_b128 v[164:167], v9 offset:36992
    v_mfma_f32_16x16x32_bf16 v[44:47], v[184:187], a[224:227], v[44:47]
    v_exp_f32 v84, v84
    v_mfma_f32_16x16x32_bf16 v[44:47], v[180:183], a[220:223], v[44:47]
    ds_read_b128 v[168:171], v8 offset:37120
    v_mfma_f32_16x16x32_bf16 v[44:47], v[176:179], a[216:219], v[44:47]
    v_exp_f32 v85, v85
    v_mfma_f32_16x16x32_bf16 v[48:51], v[176:179], a[240:243], -4.0
    ds_read_b128 v[172:175], v9 offset:37120
    v_add_f32 v7, v7, v84
    v_mfma_f32_16x16x32_bf16 v[48:51], v[180:183], a[244:247], v[48:51]
    v_add_f32 v7, v7, v85
    v_cvt_pk_bf16_f32 v134, v84, v85
    v_mfma_f32_16x16x32_bf16 v[48:51], v[184:187], a[248:251], v[48:51]
    v_exp_f32 v86, v86
    v_mfma_f32_16x16x32_bf16 v[48:51], v[188:191], a[252:255], v[48:51]
    v_exp_f32 v87, v87
    v_mfma_f32_16x16x32_bf16 v[48:51], v[192:195], v[224:227], v[48:51]
    v_add_f32 v7, v7, v86
    v_mfma_f32_16x16x32_bf16 v[48:51], v[196:199], v[228:231], v[48:51]
    v_add_f32 v7, v7, v87
    v_mfma_f32_16x16x32_bf16 v[52:55], v[196:199], v[252:255], -4.0
    v_cvt_pk_bf16_f32 v135, v86, v87
    v_mfma_f32_16x16x32_bf16 v[52:55], v[192:195], v[248:251], v[52:55]
    v_mfma_f32_16x16x32_bf16 v[52:55], v[188:191], v[244:247], v[52:55]
    v_mfma_f32_16x16x32_bf16 v[52:55], v[184:187], v[240:243], v[52:55]
    v_mfma_f32_16x16x32_bf16 v[52:55], v[180:183], v[236:239], v[52:55]
    v_mfma_f32_16x16x32_bf16 v[52:55], v[176:179], v[232:235], v[52:55]
    s_waitcnt lgkmcnt(0)
    v_mfma_f32_16x16x32_bf16 v[56:59], v[152:155], a[192:195], -4.0
    s_waitcnt vmcnt(3)
    ds_read_b128 v[176:179], v8 offset:43008
    v_mfma_f32_16x16x32_bf16 v[56:59], v[156:159], a[196:199], v[56:59]
    s_barrier
    v_exp_f32 v24, v24
    v_mfma_f32_16x16x32_bf16 v[56:59], v[160:163], a[200:203], v[56:59]
    s_add_u32 m0, s35, 24576
    ds_read_b128 v[180:183], v9 offset:43008
    v_add_f32 v4, v4, v24
    v_mfma_f32_16x16x32_bf16 v[56:59], v[164:167], a[204:207], v[56:59]
    buffer_load_dwordx4 v14, s[8:11], s25 offen lds
    v_mfma_f32_16x16x32_bf16 v[56:59], v[168:171], a[208:211], v[56:59]
    ds_read_b128 v[184:187], v8 offset:43136
    v_mfma_f32_16x16x32_bf16 v[56:59], v[172:175], a[212:215], v[56:59]
    v_exp_f32 v25, v25
    v_mfma_f32_16x16x32_bf16 v[60:63], v[172:175], a[236:239], -4.0
    ds_read_b128 v[188:191], v9 offset:43136
    v_add_f32 v4, v4, v25
    v_mfma_f32_16x16x32_bf16 v[60:63], v[168:171], a[232:235], v[60:63]
    buffer_load_dwordx4 v15, s[8:11], s25 offen offset:1024 lds
    v_mfma_f32_16x16x32_bf16 v[60:63], v[164:167], a[228:231], v[60:63]
    ds_read_b128 v[192:195], v8 offset:43264
    v_cvt_pk_bf16_f32 v104, v24, v25
    v_mfma_f32_16x16x32_bf16 v[60:63], v[160:163], a[224:227], v[60:63]
    v_exp_f32 v26, v26
    v_mfma_f32_16x16x32_bf16 v[60:63], v[156:159], a[220:223], v[60:63]
    ds_read_b128 v[196:199], v9 offset:43264
    v_add_f32 v4, v4, v26
    v_mfma_f32_16x16x32_bf16 v[60:63], v[152:155], a[216:219], v[60:63]
    buffer_load_dwordx4 v16, s[8:11], s25 offen offset:2048 lds
    v_mfma_f32_16x16x32_bf16 v[64:67], v[152:155], a[240:243], -4.0
    s_add_u32 s25, s25, 12288
    v_exp_f32 v27, v27
    v_mfma_f32_16x16x32_bf16 v[64:67], v[156:159], a[244:247], v[64:67]
    s_min_u32 s25, s25, 774144
    v_add_f32 v4, v4, v27
    v_cvt_pk_bf16_f32 v105, v26, v27
    v_mfma_f32_16x16x32_bf16 v[64:67], v[160:163], a[248:251], v[64:67]
    v_exp_f32 v40, v40
    v_mfma_f32_16x16x32_bf16 v[64:67], v[164:167], a[252:255], v[64:67]
    v_exp_f32 v41, v41
    v_mfma_f32_16x16x32_bf16 v[64:67], v[168:171], v[224:227], v[64:67]
    v_add_f32 v4, v4, v40
    v_add_f32 v4, v4, v41
    v_mfma_f32_16x16x32_bf16 v[64:67], v[172:175], v[228:231], v[64:67]
    v_cvt_pk_bf16_f32 v106, v40, v41
    v_mfma_f32_16x16x32_bf16 v[68:71], v[172:175], v[252:255], -4.0
    v_exp_f32 v42, v42
    v_mfma_f32_16x16x32_bf16 v[68:71], v[168:171], v[248:251], v[68:71]
    v_exp_f32 v43, v43
    v_mfma_f32_16x16x32_bf16 v[68:71], v[164:167], v[244:247], v[68:71]
    v_add_f32 v4, v4, v42
    v_add_f32 v4, v4, v43
    v_mfma_f32_16x16x32_bf16 v[68:71], v[160:163], v[240:243], v[68:71]
    v_cvt_pk_bf16_f32 v107, v42, v43
    v_mfma_f32_16x16x32_bf16 v[68:71], v[156:159], v[236:239], v[68:71]
    s_waitcnt lgkmcnt(0)
    v_exp_f32 v28, v28
    v_mfma_f32_16x16x32_bf16 v[68:71], v[152:155], v[232:235], v[68:71]
    v_exp_f32 v29, v29
    v_mfma_f32_16x16x32_bf16 v[72:75], v[176:179], a[192:195], -4.0
    ds_read_b64_tr_b16 v[200:201], v10 offset:0
    ds_read_b64_tr_b16 v[202:203], v10 offset:6144
    v_mfma_f32_16x16x32_bf16 v[72:75], v[180:183], a[196:199], v[72:75]
    v_add_f32 v5, v5, v28
    v_add_f32 v5, v5, v29
    v_mfma_f32_16x16x32_bf16 v[72:75], v[184:187], a[200:203], v[72:75]
    v_cvt_pk_bf16_f32 v108, v28, v29
    v_mfma_f32_16x16x32_bf16 v[72:75], v[188:191], a[204:207], v[72:75]
    ds_read_b64_tr_b16 v[204:205], v10 offset:12288
    ds_read_b64_tr_b16 v[206:207], v10 offset:18432
    v_mfma_f32_16x16x32_bf16 v[72:75], v[192:195], a[208:211], v[72:75]
    v_exp_f32 v30, v30
    v_mfma_f32_16x16x32_bf16 v[72:75], v[196:199], a[212:215], v[72:75]
    v_exp_f32 v31, v31
    v_mfma_f32_16x16x32_bf16 v[76:79], v[196:199], a[236:239], -4.0
    ds_read_b64_tr_b16 v[208:209], v11 offset:0
    ds_read_b64_tr_b16 v[210:211], v11 offset:6144
    v_mfma_f32_16x16x32_bf16 v[76:79], v[192:195], a[232:235], v[76:79]
    v_add_f32 v5, v5, v30
    v_add_f32 v5, v5, v31
    v_mfma_f32_16x16x32_bf16 v[76:79], v[188:191], a[228:231], v[76:79]
    v_cvt_pk_bf16_f32 v109, v30, v31
    v_mfma_f32_16x16x32_bf16 v[76:79], v[184:187], a[224:227], v[76:79]
    ds_read_b64_tr_b16 v[212:213], v11 offset:12288
    ds_read_b64_tr_b16 v[214:215], v11 offset:18432
    v_mfma_f32_16x16x32_bf16 v[76:79], v[180:183], a[220:223], v[76:79]
    v_exp_f32 v44, v44
    v_mfma_f32_16x16x32_bf16 v[76:79], v[176:179], a[216:219], v[76:79]
    v_exp_f32 v45, v45
    v_mfma_f32_16x16x32_bf16 v[80:83], v[176:179], a[240:243], -4.0
    ds_read_b64_tr_b16 v[216:217], v12 offset:0
    ds_read_b64_tr_b16 v[218:219], v12 offset:6144
    v_mfma_f32_16x16x32_bf16 v[80:83], v[180:183], a[244:247], v[80:83]
    v_add_f32 v5, v5, v44
    v_add_f32 v5, v5, v45
    v_mfma_f32_16x16x32_bf16 v[80:83], v[184:187], a[248:251], v[80:83]
    v_cvt_pk_bf16_f32 v110, v44, v45
    v_mfma_f32_16x16x32_bf16 v[80:83], v[188:191], a[252:255], v[80:83]
    ds_read_b64_tr_b16 v[220:221], v12 offset:12288
    ds_read_b64_tr_b16 v[222:223], v12 offset:18432
    v_mfma_f32_16x16x32_bf16 v[80:83], v[192:195], v[224:227], v[80:83]
    v_exp_f32 v46, v46
    v_mfma_f32_16x16x32_bf16 v[80:83], v[196:199], v[228:231], v[80:83]
    v_exp_f32 v47, v47
    v_mfma_f32_16x16x32_bf16 v[84:87], v[196:199], v[252:255], -4.0
    v_add_f32 v5, v5, v46
    v_add_f32 v5, v5, v47
    v_mfma_f32_16x16x32_bf16 v[84:87], v[192:195], v[248:251], v[84:87]
    v_cvt_pk_bf16_f32 v111, v46, v47
    v_mfma_f32_16x16x32_bf16 v[84:87], v[188:191], v[244:247], v[84:87]
    v_mfma_f32_16x16x32_bf16 v[84:87], v[184:187], v[240:243], v[84:87]
    v_mfma_f32_16x16x32_bf16 v[84:87], v[180:183], v[236:239], v[84:87]
    v_mfma_f32_16x16x32_bf16 v[84:87], v[176:179], v[232:235], v[84:87]
    s_waitcnt lgkmcnt(0)
    v_mfma_f32_16x16x32_bf16 a[0:3], v[88:91], v[200:203], a[0:3]
    v_exp_f32 v32, v32
    v_mfma_f32_16x16x32_bf16 a[0:3], v[120:123], v[204:207], a[0:3]
    v_exp_f32 v33, v33
    v_mfma_f32_16x16x32_bf16 a[48:51], v[92:95], v[200:203], a[48:51]
    s_add_u32 m0, s36, 24576
    v_add_f32 v6, v6, v32
    v_mfma_f32_16x16x32_bf16 a[48:51], v[124:127], v[204:207], a[48:51]
    buffer_load_dwordx4 v14, s[12:15], s26 offen lds
    v_mfma_f32_16x16x32_bf16 a[96:99], v[96:99], v[200:203], a[96:99]
    v_add_f32 v6, v6, v33
    v_cvt_pk_bf16_f32 v112, v32, v33
    v_mfma_f32_16x16x32_bf16 a[96:99], v[128:131], v[204:207], a[96:99]
    v_exp_f32 v34, v34
    v_mfma_f32_16x16x32_bf16 a[144:147], v[100:103], v[200:203], a[144:147]
    v_exp_f32 v35, v35
    v_mfma_f32_16x16x32_bf16 a[144:147], v[132:135], v[204:207], a[144:147]
    v_mfma_f32_16x16x32_bf16 a[148:151], v[132:135], v[212:215], a[148:151]
    ds_read_b64_tr_b16 v[200:201], v13 offset:0
    ds_read_b64_tr_b16 v[202:203], v13 offset:6144
    v_mfma_f32_16x16x32_bf16 a[148:151], v[100:103], v[208:211], a[148:151]
    buffer_load_dwordx4 v15, s[12:15], s26 offen offset:1024 lds
    v_mfma_f32_16x16x32_bf16 a[100:103], v[128:131], v[212:215], a[100:103]
    ds_read_b64_tr_b16 v[204:205], v13 offset:12288
    ds_read_b64_tr_b16 v[206:207], v13 offset:18432
    v_mfma_f32_16x16x32_bf16 a[100:103], v[96:99], v[208:211], a[100:103]
    v_add_f32 v6, v6, v34
    v_add_f32 v6, v6, v35
    v_mfma_f32_16x16x32_bf16 a[52:55], v[124:127], v[212:215], a[52:55]
    v_cvt_pk_bf16_f32 v113, v34, v35
    v_mfma_f32_16x16x32_bf16 a[52:55], v[92:95], v[208:211], a[52:55]
    v_exp_f32 v48, v48
    v_mfma_f32_16x16x32_bf16 a[4:7], v[120:123], v[212:215], a[4:7]
    v_exp_f32 v49, v49
    v_mfma_f32_16x16x32_bf16 a[4:7], v[88:91], v[208:211], a[4:7]
    buffer_load_dwordx4 v16, s[12:15], s26 offen offset:2048 lds
    v_mfma_f32_16x16x32_bf16 a[8:11], v[88:91], v[216:219], a[8:11]
    s_add_u32 s26, s26, 12288
    ds_read_b64_tr_b16 v[208:209], v10 offset:128
    ds_read_b64_tr_b16 v[210:211], v10 offset:6272
    v_mfma_f32_16x16x32_bf16 a[8:11], v[120:123], v[220:223], a[8:11]
    v_add_f32 v6, v6, v48
    v_add_f32 v6, v6, v49
    v_mfma_f32_16x16x32_bf16 a[56:59], v[92:95], v[216:219], a[56:59]
    ds_read_b64_tr_b16 v[212:213], v10 offset:12416
    ds_read_b64_tr_b16 v[214:215], v10 offset:18560
    v_mfma_f32_16x16x32_bf16 a[56:59], v[124:127], v[220:223], a[56:59]
    v_cvt_pk_bf16_f32 v114, v48, v49
    v_mfma_f32_16x16x32_bf16 a[104:107], v[96:99], v[216:219], a[104:107]
    s_add_u32 m0, s36, 36864
    v_exp_f32 v50, v50
    v_mfma_f32_16x16x32_bf16 a[104:107], v[128:131], v[220:223], a[104:107]
    buffer_load_dwordx4 v14, s[12:15], s26 offen lds
    v_mfma_f32_16x16x32_bf16 a[152:155], v[100:103], v[216:219], a[152:155]
    v_exp_f32 v51, v51
    v_mfma_f32_16x16x32_bf16 a[152:155], v[132:135], v[220:223], a[152:155]
    s_waitcnt lgkmcnt(4)
    v_add_f32 v6, v6, v50
    v_add_f32 v6, v6, v51
    v_mfma_f32_16x16x32_bf16 a[156:159], v[132:135], v[204:207], a[156:159]
    ds_read_b64_tr_b16 v[216:217], v11 offset:128
    ds_read_b64_tr_b16 v[218:219], v11 offset:6272
    v_mfma_f32_16x16x32_bf16 a[156:159], v[100:103], v[200:203], a[156:159]
    v_cvt_pk_bf16_f32 v115, v50, v51
    v_mfma_f32_16x16x32_bf16 a[108:111], v[128:131], v[204:207], a[108:111]
    ds_read_b64_tr_b16 v[220:221], v11 offset:12416
    ds_read_b64_tr_b16 v[222:223], v11 offset:18560
    v_mfma_f32_16x16x32_bf16 a[108:111], v[96:99], v[200:203], a[108:111]
    buffer_load_dwordx4 v15, s[12:15], s26 offen offset:1024 lds
    v_mfma_f32_16x16x32_bf16 a[60:63], v[124:127], v[204:207], a[60:63]
    v_exp_f32 v36, v36
    v_mfma_f32_16x16x32_bf16 a[60:63], v[92:95], v[200:203], a[60:63]
    v_exp_f32 v37, v37
    v_mfma_f32_16x16x32_bf16 a[12:15], v[120:123], v[204:207], a[12:15]
    v_add_f32 v7, v7, v36
    v_add_f32 v7, v7, v37
    v_mfma_f32_16x16x32_bf16 a[12:15], v[88:91], v[200:203], a[12:15]
    s_waitcnt lgkmcnt(4)
    v_cvt_pk_bf16_f32 v116, v36, v37
    v_mfma_f32_16x16x32_bf16 a[16:19], v[88:91], v[208:211], a[16:19]
    ds_read_b64_tr_b16 v[200:201], v12 offset:128
    ds_read_b64_tr_b16 v[202:203], v12 offset:6272
    v_mfma_f32_16x16x32_bf16 a[16:19], v[120:123], v[212:215], a[16:19]
    buffer_load_dwordx4 v16, s[12:15], s26 offen offset:2048 lds
    v_mfma_f32_16x16x32_bf16 a[64:67], v[92:95], v[208:211], a[64:67]
    s_add_u32 s26, s26, 12288
    ds_read_b64_tr_b16 v[204:205], v12 offset:12416
    ds_read_b64_tr_b16 v[206:207], v12 offset:18560
    v_mfma_f32_16x16x32_bf16 a[64:67], v[124:127], v[212:215], a[64:67]
    v_exp_f32 v38, v38
    v_mfma_f32_16x16x32_bf16 a[112:115], v[96:99], v[208:211], a[112:115]
    v_exp_f32 v39, v39
    v_mfma_f32_16x16x32_bf16 a[112:115], v[128:131], v[212:215], a[112:115]
    v_add_f32 v7, v7, v38
    v_add_f32 v7, v7, v39
    v_mfma_f32_16x16x32_bf16 a[160:163], v[100:103], v[208:211], a[160:163]
    v_cvt_pk_bf16_f32 v117, v38, v39
    v_mfma_f32_16x16x32_bf16 a[160:163], v[132:135], v[212:215], a[160:163]
    s_waitcnt lgkmcnt(4)
    v_exp_f32 v52, v52
    v_mfma_f32_16x16x32_bf16 a[164:167], v[132:135], v[220:223], a[164:167]
    ds_read_b64_tr_b16 v[208:209], v13 offset:128
    ds_read_b64_tr_b16 v[210:211], v13 offset:6272
    v_mfma_f32_16x16x32_bf16 a[164:167], v[100:103], v[216:219], a[164:167]
    v_exp_f32 v53, v53
    v_mfma_f32_16x16x32_bf16 a[116:119], v[128:131], v[220:223], a[116:119]
    ds_read_b64_tr_b16 v[212:213], v13 offset:12416
    ds_read_b64_tr_b16 v[214:215], v13 offset:18560
    v_mfma_f32_16x16x32_bf16 a[116:119], v[96:99], v[216:219], a[116:119]
    v_add_f32 v7, v7, v52
    v_add_f32 v7, v7, v53
    v_mfma_f32_16x16x32_bf16 a[68:71], v[124:127], v[220:223], a[68:71]
    v_cvt_pk_bf16_f32 v118, v52, v53
    v_mfma_f32_16x16x32_bf16 a[68:71], v[92:95], v[216:219], a[68:71]
    v_exp_f32 v54, v54
    v_mfma_f32_16x16x32_bf16 a[20:23], v[120:123], v[220:223], a[20:23]
    v_exp_f32 v55, v55
    v_mfma_f32_16x16x32_bf16 a[20:23], v[88:91], v[216:219], a[20:23]
    s_waitcnt lgkmcnt(4)
    v_add_f32 v7, v7, v54
    v_add_f32 v7, v7, v55
    v_mfma_f32_16x16x32_bf16 a[24:27], v[88:91], v[200:203], a[24:27]
    ds_read_b64_tr_b16 v[216:217], v10 offset:256
    ds_read_b64_tr_b16 v[218:219], v10 offset:6400
    v_mfma_f32_16x16x32_bf16 a[24:27], v[120:123], v[204:207], a[24:27]
    v_cvt_pk_bf16_f32 v119, v54, v55
    v_mfma_f32_16x16x32_bf16 a[72:75], v[92:95], v[200:203], a[72:75]
    ds_read_b64_tr_b16 v[220:221], v10 offset:12544
    ds_read_b64_tr_b16 v[222:223], v10 offset:18688
    v_mfma_f32_16x16x32_bf16 a[72:75], v[124:127], v[204:207], a[72:75]
    v_exp_f32 v56, v56
    v_mfma_f32_16x16x32_bf16 a[120:123], v[96:99], v[200:203], a[120:123]
    v_exp_f32 v57, v57
    v_mfma_f32_16x16x32_bf16 a[120:123], v[128:131], v[204:207], a[120:123]
    v_add_f32 v4, v4, v56
    v_add_f32 v4, v4, v57
    v_mfma_f32_16x16x32_bf16 a[168:171], v[100:103], v[200:203], a[168:171]
    v_cvt_pk_bf16_f32 v136, v56, v57
    v_mfma_f32_16x16x32_bf16 a[168:171], v[132:135], v[204:207], a[168:171]
    s_waitcnt lgkmcnt(4)
    v_exp_f32 v58, v58
    v_mfma_f32_16x16x32_bf16 a[172:175], v[132:135], v[212:215], a[172:175]
    ds_read_b64_tr_b16 v[200:201], v11 offset:256
    ds_read_b64_tr_b16 v[202:203], v11 offset:6400
    v_mfma_f32_16x16x32_bf16 a[172:175], v[100:103], v[208:211], a[172:175]
    v_exp_f32 v59, v59
    v_mfma_f32_16x16x32_bf16 a[124:127], v[128:131], v[212:215], a[124:127]
    ds_read_b64_tr_b16 v[204:205], v11 offset:12544
    ds_read_b64_tr_b16 v[206:207], v11 offset:18688
    v_mfma_f32_16x16x32_bf16 a[124:127], v[96:99], v[208:211], a[124:127]
    v_add_f32 v4, v4, v58
    v_add_f32 v4, v4, v59
    v_mfma_f32_16x16x32_bf16 a[76:79], v[124:127], v[212:215], a[76:79]
    v_cvt_pk_bf16_f32 v137, v58, v59
    v_mfma_f32_16x16x32_bf16 a[76:79], v[92:95], v[208:211], a[76:79]
    v_exp_f32 v72, v72
    v_mfma_f32_16x16x32_bf16 a[28:31], v[120:123], v[212:215], a[28:31]
    v_exp_f32 v73, v73
    v_mfma_f32_16x16x32_bf16 a[28:31], v[88:91], v[208:211], a[28:31]
    s_waitcnt lgkmcnt(4)
    v_add_f32 v4, v4, v72
    v_add_f32 v4, v4, v73
    v_mfma_f32_16x16x32_bf16 a[32:35], v[88:91], v[216:219], a[32:35]
    ds_read_b64_tr_b16 v[208:209], v12 offset:256
    ds_read_b64_tr_b16 v[210:211], v12 offset:6400
    v_mfma_f32_16x16x32_bf16 a[32:35], v[120:123], v[220:223], a[32:35]
    v_cvt_pk_bf16_f32 v138, v72, v73
    v_mfma_f32_16x16x32_bf16 a[80:83], v[92:95], v[216:219], a[80:83]
    ds_read_b64_tr_b16 v[212:213], v12 offset:12544
    ds_read_b64_tr_b16 v[214:215], v12 offset:18688
    v_mfma_f32_16x16x32_bf16 a[80:83], v[124:127], v[220:223], a[80:83]
    v_exp_f32 v74, v74
    v_mfma_f32_16x16x32_bf16 a[128:131], v[96:99], v[216:219], a[128:131]
    v_exp_f32 v75, v75
    v_mfma_f32_16x16x32_bf16 a[128:131], v[128:131], v[220:223], a[128:131]
    v_add_f32 v4, v4, v74
    v_add_f32 v4, v4, v75
    v_mfma_f32_16x16x32_bf16 a[176:179], v[100:103], v[216:219], a[176:179]
    v_cvt_pk_bf16_f32 v139, v74, v75
    v_mfma_f32_16x16x32_bf16 a[176:179], v[132:135], v[220:223], a[176:179]
    s_waitcnt lgkmcnt(4)
    v_exp_f32 v60, v60
    v_mfma_f32_16x16x32_bf16 a[180:183], v[132:135], v[204:207], a[180:183]
    ds_read_b64_tr_b16 v[216:217], v13 offset:256
    ds_read_b64_tr_b16 v[218:219], v13 offset:6400
    v_mfma_f32_16x16x32_bf16 a[180:183], v[100:103], v[200:203], a[180:183]
    v_exp_f32 v61, v61
    v_mfma_f32_16x16x32_bf16 a[132:135], v[128:131], v[204:207], a[132:135]
    ds_read_b64_tr_b16 v[220:221], v13 offset:12544
    ds_read_b64_tr_b16 v[222:223], v13 offset:18688
    v_mfma_f32_16x16x32_bf16 a[132:135], v[96:99], v[200:203], a[132:135]
    v_add_f32 v5, v5, v60
    v_add_f32 v5, v5, v61
    v_mfma_f32_16x16x32_bf16 a[84:87], v[124:127], v[204:207], a[84:87]
    v_cvt_pk_bf16_f32 v140, v60, v61
    v_mfma_f32_16x16x32_bf16 a[84:87], v[92:95], v[200:203], a[84:87]
    ds_read_b128 v[152:155], v8 offset:0
    v_mfma_f32_16x16x32_bf16 a[36:39], v[120:123], v[204:207], a[36:39]
    v_exp_f32 v62, v62
    v_mfma_f32_16x16x32_bf16 a[36:39], v[88:91], v[200:203], a[36:39]
    s_waitcnt lgkmcnt(5)
    ds_read_b128 v[156:159], v9 offset:0
    v_add_f32 v5, v5, v62
    v_mfma_f32_16x16x32_bf16 a[40:43], v[88:91], v[208:211], a[40:43]
    v_exp_f32 v63, v63
    v_mfma_f32_16x16x32_bf16 a[40:43], v[120:123], v[212:215], a[40:43]
    ds_read_b128 v[160:163], v8 offset:128
    v_add_f32 v5, v5, v63
    v_mfma_f32_16x16x32_bf16 a[88:91], v[92:95], v[208:211], a[88:91]
    v_cvt_pk_bf16_f32 v141, v62, v63
    v_mfma_f32_16x16x32_bf16 a[88:91], v[124:127], v[212:215], a[88:91]
    ds_read_b128 v[164:167], v9 offset:128
    v_mfma_f32_16x16x32_bf16 a[136:139], v[96:99], v[208:211], a[136:139]
    v_exp_f32 v76, v76
    v_mfma_f32_16x16x32_bf16 a[136:139], v[128:131], v[212:215], a[136:139]
    ds_read_b128 v[168:171], v8 offset:256
    v_add_f32 v5, v5, v76
    v_mfma_f32_16x16x32_bf16 a[184:187], v[100:103], v[208:211], a[184:187]
    v_exp_f32 v77, v77
    v_mfma_f32_16x16x32_bf16 a[184:187], v[132:135], v[212:215], a[184:187]
    s_waitcnt lgkmcnt(5)
    ds_read_b128 v[172:175], v9 offset:256
    v_add_f32 v5, v5, v77
    v_mfma_f32_16x16x32_bf16 a[188:191], v[132:135], v[220:223], a[188:191]
    v_cvt_pk_bf16_f32 v142, v76, v77
    v_mfma_f32_16x16x32_bf16 a[188:191], v[100:103], v[216:219], a[188:191]
    v_exp_f32 v78, v78
    v_mfma_f32_16x16x32_bf16 a[140:143], v[128:131], v[220:223], a[140:143]
    v_exp_f32 v79, v79
    v_mfma_f32_16x16x32_bf16 a[140:143], v[96:99], v[216:219], a[140:143]
    s_add_u32 s31, s31, 1
    v_add_f32 v5, v5, v78
    v_add_f32 v5, v5, v79
    v_mfma_f32_16x16x32_bf16 a[92:95], v[124:127], v[220:223], a[92:95]
    s_cmp_eq_u32 s31, 16
    v_cvt_pk_bf16_f32 v143, v78, v79
    v_mfma_f32_16x16x32_bf16 a[92:95], v[92:95], v[216:219], a[92:95]
    v_mfma_f32_16x16x32_bf16 a[44:47], v[120:123], v[220:223], a[44:47]
    s_waitcnt lgkmcnt(0)
    v_mfma_f32_16x16x32_bf16 a[44:47], v[88:91], v[216:219], a[44:47]
    s_cbranch_scc1 L_tail
    v_mfma_f32_16x16x32_bf16 v[24:27], v[152:155], a[192:195], -4.0
    s_waitcnt vmcnt(9)
    ds_read_b128 v[176:179], v8 offset:6144
    v_mfma_f32_16x16x32_bf16 v[24:27], v[156:159], a[196:199], v[24:27]
    s_barrier
    v_exp_f32 v64, v64
    v_mfma_f32_16x16x32_bf16 v[24:27], v[160:163], a[200:203], v[24:27]
    s_add_u32 m0, s35, 36864
    ds_read_b128 v[180:183], v9 offset:6144
    v_add_f32 v6, v6, v64
    v_mfma_f32_16x16x32_bf16 v[24:27], v[164:167], a[204:207], v[24:27]
    buffer_load_dwordx4 v14, s[8:11], s25 offen lds
    v_mfma_f32_16x16x32_bf16 v[24:27], v[168:171], a[208:211], v[24:27]
    ds_read_b128 v[184:187], v8 offset:6272
    v_mfma_f32_16x16x32_bf16 v[24:27], v[172:175], a[212:215], v[24:27]
    v_exp_f32 v65, v65
    v_mfma_f32_16x16x32_bf16 v[28:31], v[172:175], a[236:239], -4.0
    ds_read_b128 v[188:191], v9 offset:6272
    v_add_f32 v6, v6, v65
    v_mfma_f32_16x16x32_bf16 v[28:31], v[168:171], a[232:235], v[28:31]
    buffer_load_dwordx4 v15, s[8:11], s25 offen offset:1024 lds
    v_mfma_f32_16x16x32_bf16 v[28:31], v[164:167], a[228:231], v[28:31]
    ds_read_b128 v[192:195], v8 offset:6400
    v_cvt_pk_bf16_f32 v144, v64, v65
    v_mfma_f32_16x16x32_bf16 v[28:31], v[160:163], a[224:227], v[28:31]
    v_exp_f32 v66, v66
    v_mfma_f32_16x16x32_bf16 v[28:31], v[156:159], a[220:223], v[28:31]
    ds_read_b128 v[196:199], v9 offset:6400
    v_add_f32 v6, v6, v66
    v_mfma_f32_16x16x32_bf16 v[28:31], v[152:155], a[216:219], v[28:31]
    buffer_load_dwordx4 v16, s[8:11], s25 offen offset:2048 lds
    v_mfma_f32_16x16x32_bf16 v[32:35], v[152:155], a[240:243], -4.0
    s_add_u32 s25, s25, 12288
    v_exp_f32 v67, v67
    v_mfma_f32_16x16x32_bf16 v[32:35], v[156:159], a[244:247], v[32:35]
    s_min_u32 s25, s25, 774144
    v_add_f32 v6, v6, v67
    v_cvt_pk_bf16_f32 v145, v66, v67
    v_mfma_f32_16x16x32_bf16 v[32:35], v[160:163], a[248:251], v[32:35]
    v_exp_f32 v80, v80
    v_mfma_f32_16x16x32_bf16 v[32:35], v[164:167], a[252:255], v[32:35]
    v_exp_f32 v81, v81
    v_mfma_f32_16x16x32_bf16 v[32:35], v[168:171], v[224:227], v[32:35]
    v_add_f32 v6, v6, v80
    v_add_f32 v6, v6, v81
    v_mfma_f32_16x16x32_bf16 v[32:35], v[172:175], v[228:231], v[32:35]
    v_cvt_pk_bf16_f32 v146, v80, v81
    v_mfma_f32_16x16x32_bf16 v[36:39], v[172:175], v[252:255], -4.0
    v_exp_f32 v82, v82
    v_mfma_f32_16x16x32_bf16 v[36:39], v[168:171], v[248:251], v[36:39]
    v_exp_f32 v83, v83
    v_mfma_f32_16x16x32_bf16 v[36:39], v[164:167], v[244:247], v[36:39]
    v_add_f32 v6, v6, v82
    v_add_f32 v6, v6, v83
    v_mfma_f32_16x16x32_bf16 v[36:39], v[160:163], v[240:243], v[36:39]
    v_cvt_pk_bf16_f32 v147, v82, v83
    v_mfma_f32_16x16x32_bf16 v[36:39], v[156:159], v[236:239], v[36:39]
    s_waitcnt lgkmcnt(0)
    v_exp_f32 v68, v68
    v_mfma_f32_16x16x32_bf16 v[36:39], v[152:155], v[232:235], v[36:39]
    v_exp_f32 v69, v69
    v_mfma_f32_16x16x32_bf16 v[40:43], v[176:179], a[192:195], -4.0
    v_add_f32 v7, v7, v68
    v_add_f32 v7, v7, v69
    v_mfma_f32_16x16x32_bf16 v[40:43], v[180:183], a[196:199], v[40:43]
    v_cvt_pk_bf16_f32 v148, v68, v69
    v_mfma_f32_16x16x32_bf16 v[40:43], v[184:187], a[200:203], v[40:43]
    ds_read_b128 v[152:155], v8 offset:12288
    v_mfma_f32_16x16x32_bf16 v[40:43], v[188:191], a[204:207], v[40:43]
    v_exp_f32 v70, v70
    v_mfma_f32_16x16x32_bf16 v[40:43], v[192:195], a[208:211], v[40:43]
    ds_read_b128 v[156:159], v9 offset:12288
    v_mfma_f32_16x16x32_bf16 v[40:43], v[196:199], a[212:215], v[40:43]
    v_exp_f32 v71, v71
    v_mfma_f32_16x16x32_bf16 v[44:47], v[196:199], a[236:239], -4.0
    ds_read_b128 v[160:163], v8 offset:12416
    v_add_f32 v7, v7, v70
    v_mfma_f32_16x16x32_bf16 v[44:47], v[192:195], a[232:235], v[44:47]
    v_add_f32 v7, v7, v71
    v_cvt_pk_bf16_f32 v149, v70, v71
    v_mfma_f32_16x16x32_bf16 v[44:47], v[188:191], a[228:231], v[44:47]
    ds_read_b128 v[164:167], v9 offset:12416
    v_mfma_f32_16x16x32_bf16 v[44:47], v[184:187], a[224:227], v[44:47]
    v_exp_f32 v84, v84
    v_mfma_f32_16x16x32_bf16 v[44:47], v[180:183], a[220:223], v[44:47]
    ds_read_b128 v[168:171], v8 offset:12544
    v_mfma_f32_16x16x32_bf16 v[44:47], v[176:179], a[216:219], v[44:47]
    v_exp_f32 v85, v85
    v_mfma_f32_16x16x32_bf16 v[48:51], v[176:179], a[240:243], -4.0
    ds_read_b128 v[172:175], v9 offset:12544
    v_add_f32 v7, v7, v84
    v_mfma_f32_16x16x32_bf16 v[48:51], v[180:183], a[244:247], v[48:51]
    v_add_f32 v7, v7, v85
    v_cvt_pk_bf16_f32 v150, v84, v85
    v_mfma_f32_16x16x32_bf16 v[48:51], v[184:187], a[248:251], v[48:51]
    v_exp_f32 v86, v86
    v_mfma_f32_16x16x32_bf16 v[48:51], v[188:191], a[252:255], v[48:51]
    v_exp_f32 v87, v87
    v_mfma_f32_16x16x32_bf16 v[48:51], v[192:195], v[224:227], v[48:51]
    v_add_f32 v7, v7, v86
    v_mfma_f32_16x16x32_bf16 v[48:51], v[196:199], v[228:231], v[48:51]
    v_add_f32 v7, v7, v87
    v_mfma_f32_16x16x32_bf16 v[52:55], v[196:199], v[252:255], -4.0
    v_cvt_pk_bf16_f32 v151, v86, v87
    v_mfma_f32_16x16x32_bf16 v[52:55], v[192:195], v[248:251], v[52:55]
    v_mfma_f32_16x16x32_bf16 v[52:55], v[188:191], v[244:247], v[52:55]
    v_mfma_f32_16x16x32_bf16 v[52:55], v[184:187], v[240:243], v[52:55]
    v_mfma_f32_16x16x32_bf16 v[52:55], v[180:183], v[236:239], v[52:55]
    v_mfma_f32_16x16x32_bf16 v[52:55], v[176:179], v[232:235], v[52:55]
    s_waitcnt lgkmcnt(0)
    v_mfma_f32_16x16x32_bf16 v[56:59], v[152:155], a[192:195], -4.0
    s_waitcnt vmcnt(3)
    ds_read_b128 v[176:179], v8 offset:18432
    v_mfma_f32_16x16x32_bf16 v[56:59], v[156:159], a[196:199], v[56:59]
    s_barrier
    v_exp_f32 v24, v24
    v_mfma_f32_16x16x32_bf16 v[56:59], v[160:163], a[200:203], v[56:59]
    s_add_u32 m0, s35, 0
    ds_read_b128 v[180:183], v9 offset:18432
    v_add_f32 v4, v4, v24
    v_mfma_f32_16x16x32_bf16 v[56:59], v[164:167], a[204:207], v[56:59]
    buffer_load_dwordx4 v14, s[8:11], s25 offen lds
    v_mfma_f32_16x16x32_bf16 v[56:59], v[168:171], a[208:211], v[56:59]
    ds_read_b128 v[184:187], v8 offset:18560
    v_mfma_f32_16x16x32_bf16 v[56:59], v[172:175], a[212:215], v[56:59]
    v_exp_f32 v25, v25
    v_mfma_f32_16x16x32_bf16 v[60:63], v[172:175], a[236:239], -4.0
    ds_read_b128 v[188:191], v9 offset:18560
    v_add_f32 v4, v4, v25
    v_mfma_f32_16x16x32_bf16 v[60:63], v[168:171], a[232:235], v[60:63]
    buffer_load_dwordx4 v15, s[8:11], s25 offen offset:1024 lds
    v_mfma_f32_16x16x32_bf16 v[60:63], v[164:167], a[228:231], v[60:63]
    ds_read_b128 v[192:195], v8 offset:18688
    v_cvt_pk_bf16_f32 v88, v24, v25
    v_mfma_f32_16x16x32_bf16 v[60:63], v[160:163], a[224:227], v[60:63]
    v_exp_f32 v26, v26
    v_mfma_f32_16x16x32_bf16 v[60:63], v[156:159], a[220:223], v[60:63]
    ds_read_b128 v[196:199], v9 offset:18688
    v_add_f32 v4, v4, v26
    v_mfma_f32_16x16x32_bf16 v[60:63], v[152:155], a[216:219], v[60:63]
    buffer_load_dwordx4 v16, s[8:11], s25 offen offset:2048 lds
    v_mfma_f32_16x16x32_bf16 v[64:67], v[152:155], a[240:243], -4.0
    s_add_u32 s25, s25, 12288
    v_exp_f32 v27, v27
    v_mfma_f32_16x16x32_bf16 v[64:67], v[156:159], a[244:247], v[64:67]
    s_min_u32 s25, s25, 774144
    v_add_f32 v4, v4, v27
    v_cvt_pk_bf16_f32 v89, v26, v27
    v_mfma_f32_16x16x32_bf16 v[64:67], v[160:163], a[248:251], v[64:67]
    v_exp_f32 v40, v40
    v_mfma_f32_16x16x32_bf16 v[64:67], v[164:167], a[252:255], v[64:67]
    v_exp_f32 v41, v41
    v_mfma_f32_16x16x32_bf16 v[64:67], v[168:171], v[224:227], v[64:67]
    v_add_f32 v4, v4, v40
    v_add_f32 v4, v4, v41
    v_mfma_f32_16x16x32_bf16 v[64:67], v[172:175], v[228:231], v[64:67]
    v_cvt_pk_bf16_f32 v90, v40, v41
    v_mfma_f32_16x16x32_bf16 v[68:71], v[172:175], v[252:255], -4.0
    v_exp_f32 v42, v42
    v_mfma_f32_16x16x32_bf16 v[68:71], v[168:171], v[248:251], v[68:71]
    v_exp_f32 v43, v43
    v_mfma_f32_16x16x32_bf16 v[68:71], v[164:167], v[244:247], v[68:71]
    v_add_f32 v4, v4, v42
    v_add_f32 v4, v4, v43
    v_mfma_f32_16x16x32_bf16 v[68:71], v[160:163], v[240:243], v[68:71]
    v_cvt_pk_bf16_f32 v91, v42, v43
    v_mfma_f32_16x16x32_bf16 v[68:71], v[156:159], v[236:239], v[68:71]
    s_waitcnt lgkmcnt(0)
    v_exp_f32 v28, v28
    v_mfma_f32_16x16x32_bf16 v[68:71], v[152:155], v[232:235], v[68:71]
    v_exp_f32 v29, v29
    v_mfma_f32_16x16x32_bf16 v[72:75], v[176:179], a[192:195], -4.0
    ds_read_b64_tr_b16 v[200:201], v10 offset:24576
    ds_read_b64_tr_b16 v[202:203], v10 offset:30720
    v_mfma_f32_16x16x32_bf16 v[72:75], v[180:183], a[196:199], v[72:75]
    v_add_f32 v5, v5, v28
    v_add_f32 v5, v5, v29
    v_mfma_f32_16x16x32_bf16 v[72:75], v[184:187], a[200:203], v[72:75]
    v_cvt_pk_bf16_f32 v92, v28, v29
    v_mfma_f32_16x16x32_bf16 v[72:75], v[188:191], a[204:207], v[72:75]
    ds_read_b64_tr_b16 v[204:205], v10 offset:36864
    ds_read_b64_tr_b16 v[206:207], v10 offset:43008
    v_mfma_f32_16x16x32_bf16 v[72:75], v[192:195], a[208:211], v[72:75]
    v_exp_f32 v30, v30
    v_mfma_f32_16x16x32_bf16 v[72:75], v[196:199], a[212:215], v[72:75]
    v_exp_f32 v31, v31
    v_mfma_f32_16x16x32_bf16 v[76:79], v[196:199], a[236:239], -4.0
    ds_read_b64_tr_b16 v[208:209], v11 offset:24576
    ds_read_b64_tr_b16 v[210:211], v11 offset:30720
    v_mfma_f32_16x16x32_bf16 v[76:79], v[192:195], a[232:235], v[76:79]
    v_add_f32 v5, v5, v30
    v_add_f32 v5, v5, v31
    v_mfma_f32_16x16x32_bf16 v[76:79], v[188:191], a[228:231], v[76:79]
    v_cvt_pk_bf16_f32 v93, v30, v31
    v_mfma_f32_16x16x32_bf16 v[76:79], v[184:187], a[224:227], v[76:79]
    ds_read_b64_tr_b16 v[212:213], v11 offset:36864
    ds_read_b64_tr_b16 v[214:215], v11 offset:43008
    v_mfma_f32_16x16x32_bf16 v[76:79], v[180:183], a[220:223], v[76:79]
    v_exp_f32 v44, v44
    v_mfma_f32_16x16x32_bf16 v[76:79], v[176:179], a[216:219], v[76:79]
    v_exp_f32 v45, v45
    v_mfma_f32_16x16x32_bf16 v[80:83], v[176:179], a[240:243], -4.0
    ds_read_b64_tr_b16 v[216:217], v12 offset:24576
    ds_read_b64_tr_b16 v[218:219], v12 offset:30720
    v_mfma_f32_16x16x32_bf16 v[80:83], v[180:183], a[244:247], v[80:83]
    v_add_f32 v5, v5, v44
    v_add_f32 v5, v5, v45
    v_mfma_f32_16x16x32_bf16 v[80:83], v[184:187], a[248:251], v[80:83]
    v_cvt_pk_bf16_f32 v94, v44, v45
    v_mfma_f32_16x16x32_bf16 v[80:83], v[188:191], a[252:255], v[80:83]
    ds_read_b64_tr_b16 v[220:221], v12 offset:36864
    ds_read_b64_tr_b16 v[222:223], v12 offset:43008
    v_mfma_f32_16x16x32_bf16 v[80:83], v[192:195], v[224:227], v[80:83]
    v_exp_f32 v46, v46
    v_mfma_f32_16x16x32_bf16 v[80:83], v[196:199], v[228:231], v[80:83]
    v_exp_f32 v47, v47
    v_mfma_f32_16x16x32_bf16 v[84:87], v[196:199], v[252:255], -4.0
    v_add_f32 v5, v5, v46
    v_add_f32 v5, v5, v47
    v_mfma_f32_16x16x32_bf16 v[84:87], v[192:195], v[248:251], v[84:87]
    v_cvt_pk_bf16_f32 v95, v46, v47
    v_mfma_f32_16x16x32_bf16 v[84:87], v[188:191], v[244:247], v[84:87]
    v_mfma_f32_16x16x32_bf16 v[84:87], v[184:187], v[240:243], v[84:87]
    v_mfma_f32_16x16x32_bf16 v[84:87], v[180:183], v[236:239], v[84:87]
    v_mfma_f32_16x16x32_bf16 v[84:87], v[176:179], v[232:235], v[84:87]
    s_waitcnt lgkmcnt(0)
    v_mfma_f32_16x16x32_bf16 a[0:3], v[104:107], v[200:203], a[0:3]
    v_exp_f32 v32, v32
    v_mfma_f32_16x16x32_bf16 a[0:3], v[136:139], v[204:207], a[0:3]
    v_exp_f32 v33, v33
    v_mfma_f32_16x16x32_bf16 a[48:51], v[108:111], v[200:203], a[48:51]
    s_add_u32 m0, s36, 0
    v_add_f32 v6, v6, v32
    v_mfma_f32_16x16x32_bf16 a[48:51], v[140:143], v[204:207], a[48:51]
    buffer_load_dwordx4 v14, s[12:15], s26 offen lds
    v_mfma_f32_16x16x32_bf16 a[96:99], v[112:115], v[200:203], a[96:99]
    v_add_f32 v6, v6, v33
    v_cvt_pk_bf16_f32 v96, v32, v33
    v_mfma_f32_16x16x32_bf16 a[96:99], v[144:147], v[204:207], a[96:99]
    v_exp_f32 v34, v34
    v_mfma_f32_16x16x32_bf16 a[144:147], v[116:119], v[200:203], a[144:147]
    v_exp_f32 v35, v35
    v_mfma_f32_16x16x32_bf16 a[144:147], v[148:151], v[204:207], a[144:147]
    v_mfma_f32_16x16x32_bf16 a[148:151], v[148:151], v[212:215], a[148:151]
    ds_read_b64_tr_b16 v[200:201], v13 offset:24576
    ds_read_b64_tr_b16 v[202:203], v13 offset:30720
    v_mfma_f32_16x16x32_bf16 a[148:151], v[116:119], v[208:211], a[148:151]
    buffer_load_dwordx4 v15, s[12:15], s26 offen offset:1024 lds
    v_mfma_f32_16x16x32_bf16 a[100:103], v[144:147], v[212:215], a[100:103]
    ds_read_b64_tr_b16 v[204:205], v13 offset:36864
    ds_read_b64_tr_b16 v[206:207], v13 offset:43008
    v_mfma_f32_16x16x32_bf16 a[100:103], v[112:115], v[208:211], a[100:103]
    v_add_f32 v6, v6, v34
    v_add_f32 v6, v6, v35
    v_mfma_f32_16x16x32_bf16 a[52:55], v[140:143], v[212:215], a[52:55]
    v_cvt_pk_bf16_f32 v97, v34, v35
    v_mfma_f32_16x16x32_bf16 a[52:55], v[108:111], v[208:211], a[52:55]
    v_exp_f32 v48, v48
    v_mfma_f32_16x16x32_bf16 a[4:7], v[136:139], v[212:215], a[4:7]
    v_exp_f32 v49, v49
    v_mfma_f32_16x16x32_bf16 a[4:7], v[104:107], v[208:211], a[4:7]
    buffer_load_dwordx4 v16, s[12:15], s26 offen offset:2048 lds
    v_mfma_f32_16x16x32_bf16 a[8:11], v[104:107], v[216:219], a[8:11]
    s_add_u32 s26, s26, 12288
    ds_read_b64_tr_b16 v[208:209], v10 offset:24704
    ds_read_b64_tr_b16 v[210:211], v10 offset:30848
    v_mfma_f32_16x16x32_bf16 a[8:11], v[136:139], v[220:223], a[8:11]
    v_add_f32 v6, v6, v48
    v_add_f32 v6, v6, v49
    v_mfma_f32_16x16x32_bf16 a[56:59], v[108:111], v[216:219], a[56:59]
    ds_read_b64_tr_b16 v[212:213], v10 offset:36992
    ds_read_b64_tr_b16 v[214:215], v10 offset:43136
    v_mfma_f32_16x16x32_bf16 a[56:59], v[140:143], v[220:223], a[56:59]
    v_cvt_pk_bf16_f32 v98, v48, v49
    v_mfma_f32_16x16x32_bf16 a[104:107], v[112:115], v[216:219], a[104:107]
    s_add_u32 m0, s36, 12288
    v_exp_f32 v50, v50
    v_mfma_f32_16x16x32_bf16 a[104:107], v[144:147], v[220:223], a[104:107]
    buffer_load_dwordx4 v14, s[12:15], s26 offen lds
    v_mfma_f32_16x16x32_bf16 a[152:155], v[116:119], v[216:219], a[152:155]
    v_exp_f32 v51, v51
    v_mfma_f32_16x16x32_bf16 a[152:155], v[148:151], v[220:223], a[152:155]
    s_waitcnt lgkmcnt(4)
    v_add_f32 v6, v6, v50
    v_add_f32 v6, v6, v51
    v_mfma_f32_16x16x32_bf16 a[156:159], v[148:151], v[204:207], a[156:159]
    ds_read_b64_tr_b16 v[216:217], v11 offset:24704
    ds_read_b64_tr_b16 v[218:219], v11 offset:30848
    v_mfma_f32_16x16x32_bf16 a[156:159], v[116:119], v[200:203], a[156:159]
    v_cvt_pk_bf16_f32 v99, v50, v51
    v_mfma_f32_16x16x32_bf16 a[108:111], v[144:147], v[204:207], a[108:111]
    ds_read_b64_tr_b16 v[220:221], v11 offset:36992
    ds_read_b64_tr_b16 v[222:223], v11 offset:43136
    v_mfma_f32_16x16x32_bf16 a[108:111], v[112:115], v[200:203], a[108:111]
    buffer_load_dwordx4 v15, s[12:15], s26 offen offset:1024 lds
    v_mfma_f32_16x16x32_bf16 a[60:63], v[140:143], v[204:207], a[60:63]
    v_exp_f32 v36, v36
    v_mfma_f32_16x16x32_bf16 a[60:63], v[108:111], v[200:203], a[60:63]
    v_exp_f32 v37, v37
    v_mfma_f32_16x16x32_bf16 a[12:15], v[136:139], v[204:207], a[12:15]
    v_add_f32 v7, v7, v36
    v_add_f32 v7, v7, v37
    v_mfma_f32_16x16x32_bf16 a[12:15], v[104:107], v[200:203], a[12:15]
    s_waitcnt lgkmcnt(4)
    v_cvt_pk_bf16_f32 v100, v36, v37
    v_mfma_f32_16x16x32_bf16 a[16:19], v[104:107], v[208:211], a[16:19]
    ds_read_b64_tr_b16 v[200:201], v12 offset:24704
    ds_read_b64_tr_b16 v[202:203], v12 offset:30848
    v_mfma_f32_16x16x32_bf16 a[16:19], v[136:139], v[212:215], a[16:19]
    buffer_load_dwordx4 v16, s[12:15], s26 offen offset:2048 lds
    v_mfma_f32_16x16x32_bf16 a[64:67], v[108:111], v[208:211], a[64:67]
    s_add_u32 s26, s26, 12288
    ds_read_b64_tr_b16 v[204:205], v12 offset:36992
    ds_read_b64_tr_b16 v[206:207], v12 offset:43136
    v_mfma_f32_16x16x32_bf16 a[64:67], v[140:143], v[212:215], a[64:67]
    v_exp_f32 v38, v38
    v_mfma_f32_16x16x32_bf16 a[112:115], v[112:115], v[208:211], a[112:115]
    v_exp_f32 v39, v39
    v_mfma_f32_16x16x32_bf16 a[112:115], v[144:147], v[212:215], a[112:115]
    v_add_f32 v7, v7, v38
    v_add_f32 v7, v7, v39
    v_mfma_f32_16x16x32_bf16 a[160:163], v[116:119], v[208:211], a[160:163]
    v_cvt_pk_bf16_f32 v101, v38, v39
    v_mfma_f32_16x16x32_bf16 a[160:163], v[148:151], v[212:215], a[160:163]
    s_waitcnt lgkmcnt(4)
    v_exp_f32 v52, v52
    v_mfma_f32_16x16x32_bf16 a[164:167], v[148:151], v[220:223], a[164:167]
    ds_read_b64_tr_b16 v[208:209], v13 offset:24704
    ds_read_b64_tr_b16 v[210:211], v13 offset:30848
    v_mfma_f32_16x16x32_bf16 a[164:167], v[116:119], v[216:219], a[164:167]
    v_exp_f32 v53, v53
    v_mfma_f32_16x16x32_bf16 a[116:119], v[144:147], v[220:223], a[116:119]
    ds_read_b64_tr_b16 v[212:213], v13 offset:36992
    ds_read_b64_tr_b16 v[214:215], v13 offset:43136
    v_mfma_f32_16x16x32_bf16 a[116:119], v[112:115], v[216:219], a[116:119]
    v_add_f32 v7, v7, v52
    v_add_f32 v7, v7, v53
    v_mfma_f32_16x16x32_bf16 a[68:71], v[140:143], v[220:223], a[68:71]
    v_cvt_pk_bf16_f32 v102, v52, v53
    v_mfma_f32_16x16x32_bf16 a[68:71], v[108:111], v[216:219], a[68:71]
    v_exp_f32 v54, v54
    v_mfma_f32_16x16x32_bf16 a[20:23], v[136:139], v[220:223], a[20:23]
    v_exp_f32 v55, v55
    v_mfma_f32_16x16x32_bf16 a[20:23], v[104:107], v[216:219], a[20:23]
    s_waitcnt lgkmcnt(4)
    v_add_f32 v7, v7, v54
    v_add_f32 v7, v7, v55
    v_mfma_f32_16x16x32_bf16 a[24:27], v[104:107], v[200:203], a[24:27]
    ds_read_b64_tr_b16 v[216:217], v10 offset:24832
    ds_read_b64_tr_b16 v[218:219], v10 offset:30976
    v_mfma_f32_16x16x32_bf16 a[24:27], v[136:139], v[204:207], a[24:27]
    v_cvt_pk_bf16_f32 v103, v54, v55
    v_mfma_f32_16x16x32_bf16 a[72:75], v[108:111], v[200:203], a[72:75]
    ds_read_b64_tr_b16 v[220:221], v10 offset:37120
    ds_read_b64_tr_b16 v[222:223], v10 offset:43264
    v_mfma_f32_16x16x32_bf16 a[72:75], v[140:143], v[204:207], a[72:75]
    v_exp_f32 v56, v56
    v_mfma_f32_16x16x32_bf16 a[120:123], v[112:115], v[200:203], a[120:123]
    v_exp_f32 v57, v57
    v_mfma_f32_16x16x32_bf16 a[120:123], v[144:147], v[204:207], a[120:123]
    v_add_f32 v4, v4, v56
    v_add_f32 v4, v4, v57
    v_mfma_f32_16x16x32_bf16 a[168:171], v[116:119], v[200:203], a[168:171]
    v_cvt_pk_bf16_f32 v120, v56, v57
    v_mfma_f32_16x16x32_bf16 a[168:171], v[148:151], v[204:207], a[168:171]
    s_waitcnt lgkmcnt(4)
    v_exp_f32 v58, v58
    v_mfma_f32_16x16x32_bf16 a[172:175], v[148:151], v[212:215], a[172:175]
    ds_read_b64_tr_b16 v[200:201], v11 offset:24832
    ds_read_b64_tr_b16 v[202:203], v11 offset:30976
    v_mfma_f32_16x16x32_bf16 a[172:175], v[116:119], v[208:211], a[172:175]
    v_exp_f32 v59, v59
    v_mfma_f32_16x16x32_bf16 a[124:127], v[144:147], v[212:215], a[124:127]
    ds_read_b64_tr_b16 v[204:205], v11 offset:37120
    ds_read_b64_tr_b16 v[206:207], v11 offset:43264
    v_mfma_f32_16x16x32_bf16 a[124:127], v[112:115], v[208:211], a[124:127]
    v_add_f32 v4, v4, v58
    v_add_f32 v4, v4, v59
    v_mfma_f32_16x16x32_bf16 a[76:79], v[140:143], v[212:215], a[76:79]
    v_cvt_pk_bf16_f32 v121, v58, v59
    v_mfma_f32_16x16x32_bf16 a[76:79], v[108:111], v[208:211], a[76:79]
    v_exp_f32 v72, v72
    v_mfma_f32_16x16x32_bf16 a[28:31], v[136:139], v[212:215], a[28:31]
    v_exp_f32 v73, v73
    v_mfma_f32_16x16x32_bf16 a[28:31], v[104:107], v[208:211], a[28:31]
    s_waitcnt lgkmcnt(4)
    v_add_f32 v4, v4, v72
    v_add_f32 v4, v4, v73
    v_mfma_f32_16x16x32_bf16 a[32:35], v[104:107], v[216:219], a[32:35]
    ds_read_b64_tr_b16 v[208:209], v12 offset:24832
    ds_read_b64_tr_b16 v[210:211], v12 offset:30976
    v_mfma_f32_16x16x32_bf16 a[32:35], v[136:139], v[220:223], a[32:35]
    v_cvt_pk_bf16_f32 v122, v72, v73
    v_mfma_f32_16x16x32_bf16 a[80:83], v[108:111], v[216:219], a[80:83]
    ds_read_b64_tr_b16 v[212:213], v12 offset:37120
    ds_read_b64_tr_b16 v[214:215], v12 offset:43264
    v_mfma_f32_16x16x32_bf16 a[80:83], v[140:143], v[220:223], a[80:83]
    v_exp_f32 v74, v74
    v_mfma_f32_16x16x32_bf16 a[128:131], v[112:115], v[216:219], a[128:131]
    v_exp_f32 v75, v75
    v_mfma_f32_16x16x32_bf16 a[128:131], v[144:147], v[220:223], a[128:131]
    v_add_f32 v4, v4, v74
    v_add_f32 v4, v4, v75
    v_mfma_f32_16x16x32_bf16 a[176:179], v[116:119], v[216:219], a[176:179]
    v_cvt_pk_bf16_f32 v123, v74, v75
    v_mfma_f32_16x16x32_bf16 a[176:179], v[148:151], v[220:223], a[176:179]
    s_waitcnt lgkmcnt(4)
    v_exp_f32 v60, v60
    v_mfma_f32_16x16x32_bf16 a[180:183], v[148:151], v[204:207], a[180:183]
    ds_read_b64_tr_b16 v[216:217], v13 offset:24832
    ds_read_b64_tr_b16 v[218:219], v13 offset:30976
    v_mfma_f32_16x16x32_bf16 a[180:183], v[116:119], v[200:203], a[180:183]
    v_exp_f32 v61, v61
    v_mfma_f32_16x16x32_bf16 a[132:135], v[144:147], v[204:207], a[132:135]
    ds_read_b64_tr_b16 v[220:221], v13 offset:37120
    ds_read_b64_tr_b16 v[222:223], v13 offset:43264
    v_mfma_f32_16x16x32_bf16 a[132:135], v[112:115], v[200:203], a[132:135]
    v_add_f32 v5, v5, v60
    v_add_f32 v5, v5, v61
    v_mfma_f32_16x16x32_bf16 a[84:87], v[140:143], v[204:207], a[84:87]
    v_cvt_pk_bf16_f32 v124, v60, v61
    v_mfma_f32_16x16x32_bf16 a[84:87], v[108:111], v[200:203], a[84:87]
    ds_read_b128 v[152:155], v8 offset:24576
    v_mfma_f32_16x16x32_bf16 a[36:39], v[136:139], v[204:207], a[36:39]
    v_exp_f32 v62, v62
    v_mfma_f32_16x16x32_bf16 a[36:39], v[104:107], v[200:203], a[36:39]
    s_waitcnt lgkmcnt(5)
    ds_read_b128 v[156:159], v9 offset:24576
    v_add_f32 v5, v5, v62
    v_mfma_f32_16x16x32_bf16 a[40:43], v[104:107], v[208:211], a[40:43]
    v_exp_f32 v63, v63
    v_mfma_f32_16x16x32_bf16 a[40:43], v[136:139], v[212:215], a[40:43]
    ds_read_b128 v[160:163], v8 offset:24704
    v_add_f32 v5, v5, v63
    v_mfma_f32_16x16x32_bf16 a[88:91], v[108:111], v[208:211], a[88:91]
    v_cvt_pk_bf16_f32 v125, v62, v63
    v_mfma_f32_16x16x32_bf16 a[88:91], v[140:143], v[212:215], a[88:91]
    ds_read_b128 v[164:167], v9 offset:24704
    v_mfma_f32_16x16x32_bf16 a[136:139], v[112:115], v[208:211], a[136:139]
    v_exp_f32 v76, v76
    v_mfma_f32_16x16x32_bf16 a[136:139], v[144:147], v[212:215], a[136:139]
    ds_read_b128 v[168:171], v8 offset:24832
    v_add_f32 v5, v5, v76
    v_mfma_f32_16x16x32_bf16 a[184:187], v[116:119], v[208:211], a[184:187]
    v_exp_f32 v77, v77
    v_mfma_f32_16x16x32_bf16 a[184:187], v[148:151], v[212:215], a[184:187]
    s_waitcnt lgkmcnt(5)
    ds_read_b128 v[172:175], v9 offset:24832
    v_add_f32 v5, v5, v77
    v_mfma_f32_16x16x32_bf16 a[188:191], v[148:151], v[220:223], a[188:191]
    v_cvt_pk_bf16_f32 v126, v76, v77
    v_mfma_f32_16x16x32_bf16 a[188:191], v[116:119], v[216:219], a[188:191]
    v_exp_f32 v78, v78
    v_mfma_f32_16x16x32_bf16 a[140:143], v[144:147], v[220:223], a[140:143]
    v_exp_f32 v79, v79
    v_mfma_f32_16x16x32_bf16 a[140:143], v[112:115], v[216:219], a[140:143]
    v_add_f32 v5, v5, v78
    v_add_f32 v5, v5, v79
    v_mfma_f32_16x16x32_bf16 a[92:95], v[140:143], v[220:223], a[92:95]
    v_cvt_pk_bf16_f32 v127, v78, v79
    v_mfma_f32_16x16x32_bf16 a[92:95], v[108:111], v[216:219], a[92:95]
    v_mfma_f32_16x16x32_bf16 a[44:47], v[136:139], v[220:223], a[44:47]
    s_waitcnt lgkmcnt(0)
    v_mfma_f32_16x16x32_bf16 a[44:47], v[104:107], v[216:219], a[44:47]
    s_branch L_loop0
L_tail:
    s_waitcnt vmcnt(0)
    s_barrier
    s_movk_i32 s42, 400
    s_movk_i32 s43, 2731
    s_movk_i32 s42, 1600
    s_movk_i32 s40, 800
    s_movk_i32 s41, 384
    s_mov_b32 s50, 0x05040100
    s_mov_b32 s51, 0x07060302
    ds_read_b64_tr_b16 v[200:201], v10 offset:24576
    ds_read_b64_tr_b16 v[202:203], v10 offset:30720
    ds_read_b64_tr_b16 v[204:205], v10 offset:36864
    v_exp_f32 v64, v64
    ds_read_b64_tr_b16 v[206:207], v10 offset:43008
    ds_read_b64_tr_b16 v[208:209], v11 offset:24576
    ds_read_b64_tr_b16 v[210:211], v11 offset:30720
    v_exp_f32 v65, v65
    ds_read_b64_tr_b16 v[212:213], v11 offset:36864
    ds_read_b64_tr_b16 v[214:215], v11 offset:43008
    ds_read_b64_tr_b16 v[216:217], v12 offset:24576
    v_exp_f32 v66, v66
    ds_read_b64_tr_b16 v[218:219], v12 offset:30720
    ds_read_b64_tr_b16 v[220:221], v12 offset:36864
    ds_read_b64_tr_b16 v[222:223], v12 offset:43008
    v_exp_f32 v67, v67
    ds_read_b64_tr_b16 v[152:153], v13 offset:24576
    ds_read_b64_tr_b16 v[154:155], v13 offset:30720
    ds_read_b64_tr_b16 v[156:157], v13 offset:36864
    v_exp_f32 v80, v80
    ds_read_b64_tr_b16 v[158:159], v13 offset:43008
    ds_read_b64_tr_b16 v[160:161], v10 offset:24704
    ds_read_b64_tr_b16 v[162:163], v10 offset:30848
    v_exp_f32 v81, v81
    ds_read_b64_tr_b16 v[164:165], v10 offset:36992
    ds_read_b64_tr_b16 v[166:167], v10 offset:43136
    ds_read_b64_tr_b16 v[168:169], v11 offset:24704
    v_exp_f32 v82, v82
    ds_read_b64_tr_b16 v[170:171], v11 offset:30848
    ds_read_b64_tr_b16 v[172:173], v11 offset:36992
    ds_read_b64_tr_b16 v[174:175], v11 offset:43136
    v_exp_f32 v83, v83
    ds_read_b64_tr_b16 v[176:177], v12 offset:24704
    ds_read_b64_tr_b16 v[178:179], v12 offset:30848
    ds_read_b64_tr_b16 v[180:181], v12 offset:36992
    v_exp_f32 v68, v68
    ds_read_b64_tr_b16 v[182:183], v12 offset:43136
    ds_read_b64_tr_b16 v[184:185], v13 offset:24704
    ds_read_b64_tr_b16 v[186:187], v13 offset:30848
    v_exp_f32 v69, v69
    ds_read_b64_tr_b16 v[188:189], v13 offset:36992
    ds_read_b64_tr_b16 v[190:191], v13 offset:43136
    ds_read_b64_tr_b16 v[192:193], v10 offset:24832
    v_exp_f32 v70, v70
    ds_read_b64_tr_b16 v[194:195], v10 offset:30976
    ds_read_b64_tr_b16 v[196:197], v10 offset:37120
    ds_read_b64_tr_b16 v[198:199], v10 offset:43264
    v_exp_f32 v71, v71
    ds_read_b64_tr_b16 v[24:25], v11 offset:24832
    ds_read_b64_tr_b16 v[26:27], v11 offset:30976
    ds_read_b64_tr_b16 v[28:29], v11 offset:37120
    v_exp_f32 v84, v84
    ds_read_b64_tr_b16 v[30:31], v11 offset:43264
    ds_read_b64_tr_b16 v[32:33], v12 offset:24832
    ds_read_b64_tr_b16 v[34:35], v12 offset:30976
    v_exp_f32 v85, v85
    ds_read_b64_tr_b16 v[36:37], v12 offset:37120
    ds_read_b64_tr_b16 v[38:39], v12 offset:43264
    ds_read_b64_tr_b16 v[40:41], v13 offset:24832
    v_exp_f32 v86, v86
    ds_read_b64_tr_b16 v[42:43], v13 offset:30976
    ds_read_b64_tr_b16 v[44:45], v13 offset:37120
    ds_read_b64_tr_b16 v[46:47], v13 offset:43264
    v_exp_f32 v87, v87
    s_waitcnt lgkmcnt(15)
    v_mfma_f32_16x16x32_bf16 a[0:3], v[104:107], v[200:203], a[0:3]
    v_mfma_f32_16x16x32_bf16 a[0:3], v[136:139], v[204:207], a[0:3]
    v_and_b32 v19, 15, v0
    v_bfe_u32 v20, v0, 4, 2
    v_mfma_f32_16x16x32_bf16 a[4:7], v[104:107], v[208:211], a[4:7]
    v_mul_u32_u24 v9, s42, v20
    v_add_u32 v9, s38, v9
    v_mfma_f32_16x16x32_bf16 a[4:7], v[136:139], v[212:215], a[4:7]
    v_lshl_add_u32 v1, v19, 2, v9
    v_lshrrev_b32 v21, 1, v19
    v_mfma_f32_16x16x32_bf16 a[8:11], v[104:107], v[216:219], a[8:11]
    v_mul_u32_u24 v8, s40, v21
    v_and_b32 v21, 1, v19
    v_mfma_f32_16x16x32_bf16 a[8:11], v[136:139], v[220:223], a[8:11]
    v_lshl_add_u32 v8, v21, 4, v8
    v_add_u32 v8, s38, v8
    v_mfma_f32_16x16x32_bf16 a[12:15], v[104:107], v[152:155], a[12:15]
    v_and_b32 v19, 63, v0
    v_mov_b32 v20, v19
    v_mfma_f32_16x16x32_bf16 a[12:15], v[136:139], v[156:159], a[12:15]
    v_mul_u32_u24 v21, s43, v20
    v_lshrrev_b32 v21, 16, v21
    v_mfma_f32_16x16x32_bf16 a[16:19], v[104:107], v[160:163], a[16:19]
    v_add_u32 v22, v20, v21
    v_lshlrev_b32 v3, 5, v22
    v_mfma_f32_16x16x32_bf16 a[16:19], v[136:139], v[164:167], a[16:19]
    v_add_u32 v3, s38, v3
    v_mul_u32_u24 v2, s41, v21
    v_mfma_f32_16x16x32_bf16 a[20:23], v[104:107], v[168:171], a[20:23]
    v_lshl_add_u32 v2, v20, 4, v2
    v_add_u32 v20, 64, v20
    v_mfma_f32_16x16x32_bf16 a[20:23], v[136:139], v[172:175], a[20:23]
    v_mul_u32_u24 v21, s43, v20
    v_lshrrev_b32 v21, 16, v21
    v_mfma_f32_16x16x32_bf16 a[24:27], v[104:107], v[176:179], a[24:27]
    v_add_u32 v22, v20, v21
    v_lshlrev_b32 v17, 5, v22
    v_mfma_f32_16x16x32_bf16 a[24:27], v[136:139], v[180:183], a[24:27]
    v_add_u32 v17, s38, v17
    v_mul_u32_u24 v10, s41, v21
    v_mfma_f32_16x16x32_bf16 a[28:31], v[104:107], v[184:187], a[28:31]
    v_lshl_add_u32 v10, v20, 4, v10
    v_add_u32 v20, 64, v20
    v_mfma_f32_16x16x32_bf16 a[28:31], v[136:139], v[188:191], a[28:31]
    v_mul_u32_u24 v21, s43, v20
    v_lshrrev_b32 v21, 16, v21
    s_waitcnt lgkmcnt(0)
    v_mfma_f32_16x16x32_bf16 a[32:35], v[104:107], v[192:195], a[32:35]
    v_add_u32 v22, v20, v21
    v_lshlrev_b32 v18, 5, v22
    v_mfma_f32_16x16x32_bf16 a[32:35], v[136:139], v[196:199], a[32:35]
    v_add_u32 v18, s38, v18
    v_mul_u32_u24 v11, s41, v21
    v_mfma_f32_16x16x32_bf16 a[36:39], v[104:107], v[24:27], a[36:39]
    v_lshl_add_u32 v11, v20, 4, v11
    v_mov_b32 v19, v4
    v_mfma_f32_16x16x32_bf16 a[36:39], v[136:139], v[28:31], a[36:39]
    v_mov_b32 v20, v5
    s_nop 1
    v_mfma_f32_16x16x32_bf16 a[40:43], v[104:107], v[32:35], a[40:43]
    v_permlane16_swap_b32 v4, v19
    v_permlane16_swap_b32 v5, v20
    v_mfma_f32_16x16x32_bf16 a[40:43], v[136:139], v[36:39], a[40:43]
    s_nop 0
    v_add_f32 v4, v4, v19
    v_mfma_f32_16x16x32_bf16 a[44:47], v[104:107], v[40:43], a[44:47]
    v_add_f32 v5, v5, v20
    v_mov_b32 v19, v4
    v_mfma_f32_16x16x32_bf16 a[44:47], v[136:139], v[44:47], a[44:47]
    v_mov_b32 v20, v5
    s_nop 1
    v_permlane32_swap_b32 v4, v19
    v_permlane32_swap_b32 v5, v20
    s_nop 0
    v_add_f32 v4, v4, v19
    v_add_f32 v5, v5, v20
    v_add_f32 v21, v4, v5
    v_min_f32 v22, v4, v5
    v_cmp_nle_f32 s[46:47], s32, v22
    v_cmp_nge_f32 vcc, s33, v21
    v_rcp_f32 v4, v4
    v_rcp_f32 v5, v5
    s_nop 0
    s_or_b64 s[46:47], s[46:47], vcc
    s_mov_b64 s[28:29], s[46:47]
    ds_write_b64 v8, v[4:5] offset:768
    ds_read_b64 v[248:249], v9 offset:768
    ds_read_b64 v[250:251], v9 offset:784
    ds_read_b64 v[252:253], v9 offset:1568
    ds_read_b64 v[254:255], v9 offset:1584
    s_waitcnt lgkmcnt(0)
    s_nop 1
    v_mfma_f32_16x16x32_bf16 a[48:51], v[108:111], v[200:203], a[48:51]
    v_accvgpr_read_b32 v48, a0
    v_accvgpr_read_b32 v49, a1
    v_accvgpr_read_b32 v50, a2
    v_accvgpr_read_b32 v51, a3
    v_add_f32 v6, v6, v64
    v_mul_f32 v48, v48, v248
    v_mfma_f32_16x16x32_bf16 a[48:51], v[140:143], v[204:207], a[48:51]
    v_mul_f32 v49, v49, v250
    v_mul_f32 v50, v50, v252
    v_mul_f32 v51, v51, v254
    v_add_f32 v6, v6, v65
    v_cvt_pk_bf16_f32 v52, v48, v49
    v_cvt_pk_bf16_f32 v53, v50, v51
    v_mfma_f32_16x16x32_bf16 a[52:55], v[108:111], v[208:211], a[52:55]
    ds_write_b32 v1, v52 offset:0
    ds_write_b32 v1, v53 offset:800
    v_cvt_pk_bf16_f32 v144, v64, v65
    v_accvgpr_read_b32 v54, a4
    v_accvgpr_read_b32 v55, a5
    v_accvgpr_read_b32 v56, a6
    v_mfma_f32_16x16x32_bf16 a[52:55], v[140:143], v[212:215], a[52:55]
    v_accvgpr_read_b32 v57, a7
    v_add_f32 v6, v6, v66
    v_mul_f32 v54, v54, v248
    v_mul_f32 v55, v55, v250
    v_mul_f32 v56, v56, v252
    v_mul_f32 v57, v57, v254
    v_add_f32 v6, v6, v67
    v_mfma_f32_16x16x32_bf16 a[56:59], v[108:111], v[216:219], a[56:59]
    v_cvt_pk_bf16_f32 v58, v54, v55
    v_cvt_pk_bf16_f32 v59, v56, v57
    ds_write_b32 v1, v58 offset:64
    ds_write_b32 v1, v59 offset:864
    v_cvt_pk_bf16_f32 v145, v66, v67
    v_accvgpr_read_b32 v72, a8
    v_mfma_f32_16x16x32_bf16 a[56:59], v[140:143], v[220:223], a[56:59]
    v_accvgpr_read_b32 v73, a9
    v_accvgpr_read_b32 v74, a10
    v_accvgpr_read_b32 v75, a11
    v_add_f32 v6, v6, v80
    v_mul_f32 v72, v72, v248
    v_mul_f32 v73, v73, v250
    v_mfma_f32_16x16x32_bf16 a[60:63], v[108:111], v[152:155], a[60:63]
    v_mul_f32 v74, v74, v252
    v_mul_f32 v75, v75, v254
    v_add_f32 v6, v6, v81
    v_cvt_pk_bf16_f32 v76, v72, v73
    v_cvt_pk_bf16_f32 v77, v74, v75
    ds_write_b32 v1, v76 offset:128
    v_mfma_f32_16x16x32_bf16 a[60:63], v[140:143], v[156:159], a[60:63]
    ds_write_b32 v1, v77 offset:928
    v_cvt_pk_bf16_f32 v146, v80, v81
    v_accvgpr_read_b32 v48, a12
    v_accvgpr_read_b32 v49, a13
    v_accvgpr_read_b32 v50, a14
    v_accvgpr_read_b32 v51, a15
    v_add_f32 v6, v6, v82
    v_mfma_f32_16x16x32_bf16 a[64:67], v[108:111], v[160:163], a[64:67]
    v_mul_f32 v48, v48, v248
    v_mul_f32 v49, v49, v250
    v_mul_f32 v50, v50, v252
    v_mul_f32 v51, v51, v254
    v_add_f32 v6, v6, v83
    v_cvt_pk_bf16_f32 v52, v48, v49
    v_mfma_f32_16x16x32_bf16 a[64:67], v[140:143], v[164:167], a[64:67]
    v_cvt_pk_bf16_f32 v53, v50, v51
    ds_write_b32 v1, v52 offset:192
    ds_write_b32 v1, v53 offset:992
    v_cvt_pk_bf16_f32 v147, v82, v83
    v_accvgpr_read_b32 v54, a16
    v_accvgpr_read_b32 v55, a17
    v_mfma_f32_16x16x32_bf16 a[68:71], v[108:111], v[168:171], a[68:71]
    v_accvgpr_read_b32 v56, a18
    v_accvgpr_read_b32 v57, a19
    v_add_f32 v7, v7, v68
    v_mul_f32 v54, v54, v248
    v_mul_f32 v55, v55, v250
    v_mul_f32 v56, v56, v252
    v_mfma_f32_16x16x32_bf16 a[68:71], v[140:143], v[172:175], a[68:71]
    v_mul_f32 v57, v57, v254
    v_add_f32 v7, v7, v69
    v_cvt_pk_bf16_f32 v58, v54, v55
    v_cvt_pk_bf16_f32 v59, v56, v57
    ds_write_b32 v1, v58 offset:256
    ds_write_b32 v1, v59 offset:1056
    v_cvt_pk_bf16_f32 v148, v68, v69
    v_mfma_f32_16x16x32_bf16 a[72:75], v[108:111], v[176:179], a[72:75]
    v_accvgpr_read_b32 v72, a20
    v_accvgpr_read_b32 v73, a21
    v_accvgpr_read_b32 v74, a22
    v_accvgpr_read_b32 v75, a23
    v_add_f32 v7, v7, v70
    v_mul_f32 v72, v72, v248
    v_mfma_f32_16x16x32_bf16 a[72:75], v[140:143], v[180:183], a[72:75]
    v_mul_f32 v73, v73, v250
    v_mul_f32 v74, v74, v252
    v_mul_f32 v75, v75, v254
    v_add_f32 v7, v7, v71
    v_cvt_pk_bf16_f32 v76, v72, v73
    v_cvt_pk_bf16_f32 v77, v74, v75
    v_mfma_f32_16x16x32_bf16 a[76:79], v[108:111], v[184:187], a[76:79]
    ds_write_b32 v1, v76 offset:320
    ds_write_b32 v1, v77 offset:1120
    v_cvt_pk_bf16_f32 v149, v70, v71
    v_accvgpr_read_b32 v48, a24
    v_accvgpr_read_b32 v49, a25
    v_accvgpr_read_b32 v50, a26
    v_mfma_f32_16x16x32_bf16 a[76:79], v[140:143], v[188:191], a[76:79]
    v_accvgpr_read_b32 v51, a27
    v_add_f32 v7, v7, v84
    v_mul_f32 v48, v48, v248
    v_mul_f32 v49, v49, v250
    v_mul_f32 v50, v50, v252
    v_mul_f32 v51, v51, v254
    v_add_f32 v7, v7, v85
    v_mfma_f32_16x16x32_bf16 a[80:83], v[108:111], v[192:195], a[80:83]
    v_cvt_pk_bf16_f32 v52, v48, v49
    v_cvt_pk_bf16_f32 v53, v50, v51
    ds_write_b32 v1, v52 offset:384
    ds_write_b32 v1, v53 offset:1184
    v_cvt_pk_bf16_f32 v150, v84, v85
    v_accvgpr_read_b32 v54, a28
    v_mfma_f32_16x16x32_bf16 a[80:83], v[140:143], v[196:199], a[80:83]
    v_accvgpr_read_b32 v55, a29
    v_accvgpr_read_b32 v56, a30
    v_accvgpr_read_b32 v57, a31
    v_add_f32 v7, v7, v86
    v_mul_f32 v54, v54, v248
    v_mul_f32 v55, v55, v250
    v_mfma_f32_16x16x32_bf16 a[84:87], v[108:111], v[24:27], a[84:87]
    v_mul_f32 v56, v56, v252
    v_mul_f32 v57, v57, v254
    v_add_f32 v7, v7, v87
    v_cvt_pk_bf16_f32 v58, v54, v55
    v_cvt_pk_bf16_f32 v59, v56, v57
    ds_write_b32 v1, v58 offset:448
    v_mfma_f32_16x16x32_bf16 a[84:87], v[140:143], v[28:31], a[84:87]
    ds_write_b32 v1, v59 offset:1248
    v_cvt_pk_bf16_f32 v151, v86, v87
    v_accvgpr_read_b32 v72, a32
    v_accvgpr_read_b32 v73, a33
    v_accvgpr_read_b32 v74, a34
    v_accvgpr_read_b32 v75, a35
    v_mfma_f32_16x16x32_bf16 a[88:91], v[108:111], v[32:35], a[88:91]
    v_mul_f32 v72, v72, v248
    v_mul_f32 v73, v73, v250
    v_mul_f32 v74, v74, v252
    v_mul_f32 v75, v75, v254
    v_cvt_pk_bf16_f32 v76, v72, v73
    v_mfma_f32_16x16x32_bf16 a[88:91], v[140:143], v[36:39], a[88:91]
    v_cvt_pk_bf16_f32 v77, v74, v75
    ds_write_b32 v1, v76 offset:512
    ds_write_b32 v1, v77 offset:1312
    v_accvgpr_read_b32 v48, a36
    v_accvgpr_read_b32 v49, a37
    v_mfma_f32_16x16x32_bf16 a[92:95], v[108:111], v[40:43], a[92:95]
    v_accvgpr_read_b32 v50, a38
    v_accvgpr_read_b32 v51, a39
    v_mul_f32 v48, v48, v248
    v_mul_f32 v49, v49, v250
    v_mul_f32 v50, v50, v252
    v_mfma_f32_16x16x32_bf16 a[92:95], v[140:143], v[44:47], a[92:95]
    v_mul_f32 v51, v51, v254
    v_cvt_pk_bf16_f32 v52, v48, v49
    v_cvt_pk_bf16_f32 v53, v50, v51
    ds_write_b32 v1, v52 offset:576
    ds_write_b32 v1, v53 offset:1376
    v_accvgpr_read_b32 v54, a40
    v_accvgpr_read_b32 v55, a41
    v_accvgpr_read_b32 v56, a42
    v_accvgpr_read_b32 v57, a43
    v_mul_f32 v54, v54, v248
    v_mul_f32 v55, v55, v250
    v_mul_f32 v56, v56, v252
    v_mul_f32 v57, v57, v254
    v_cvt_pk_bf16_f32 v58, v54, v55
    v_cvt_pk_bf16_f32 v59, v56, v57
    ds_write_b32 v1, v58 offset:640
    ds_write_b32 v1, v59 offset:1440
    v_accvgpr_read_b32 v72, a44
    v_accvgpr_read_b32 v73, a45
    v_accvgpr_read_b32 v74, a46
    v_accvgpr_read_b32 v75, a47
    v_mul_f32 v72, v72, v248
    v_mul_f32 v73, v73, v250
    v_mul_f32 v74, v74, v252
    v_mul_f32 v75, v75, v254
    v_cvt_pk_bf16_f32 v76, v72, v73
    v_cvt_pk_bf16_f32 v77, v74, v75
    ds_write_b32 v1, v76 offset:704
    ds_write_b32 v1, v77 offset:1504
    ds_read_b128 v[224:227], v3 offset:0
    ds_read_b128 v[228:231], v3 offset:16
    ds_read_b128 v[232:235], v17 offset:0
    ds_read_b128 v[236:239], v17 offset:16
    ds_read_b128 v[240:243], v18 offset:0
    ds_read_b128 v[244:247], v18 offset:16
    s_nop 3
    v_mfma_f32_16x16x32_bf16 a[96:99], v[112:115], v[200:203], a[96:99]
    v_accvgpr_read_b32 v48, a48
    v_accvgpr_read_b32 v49, a49
    v_accvgpr_read_b32 v50, a50
    v_accvgpr_read_b32 v51, a51
    v_mov_b32 v19, v6
    v_mul_f32 v48, v48, v249
    v_mfma_f32_16x16x32_bf16 a[96:99], v[144:147], v[204:207], a[96:99]
    v_mul_f32 v49, v49, v251
    v_mul_f32 v50, v50, v253
    v_mul_f32 v51, v51, v255
    v_mov_b32 v20, v7
    v_cvt_pk_bf16_f32 v52, v48, v49
    v_cvt_pk_bf16_f32 v53, v50, v51
    v_mfma_f32_16x16x32_bf16 a[100:103], v[112:115], v[208:211], a[100:103]
    ds_write_b32 v1, v52 offset:6400
    ds_write_b32 v1, v53 offset:7200
    s_nop 1
    v_accvgpr_read_b32 v54, a52
    s_waitcnt lgkmcnt(6)
    v_perm_b32 v88, v225, v224, s50
    v_perm_b32 v89, v227, v226, s50
    v_perm_b32 v90, v229, v228, s50
    v_perm_b32 v91, v231, v230, s50
    s_movk_i32 s41, 0x0
    buffer_store_dwordx4 v[88:91], v2, s[16:19], s41 offen
    v_accvgpr_read_b32 v55, a53
    v_accvgpr_read_b32 v56, a54
    v_mfma_f32_16x16x32_bf16 a[100:103], v[144:147], v[212:215], a[100:103]
    v_accvgpr_read_b32 v57, a55
    v_permlane16_swap_b32 v6, v19
    v_mul_f32 v54, v54, v249
    v_mul_f32 v55, v55, v251
    v_mul_f32 v56, v56, v253
    v_mul_f32 v57, v57, v255
    v_permlane16_swap_b32 v7, v20
    v_mfma_f32_16x16x32_bf16 a[104:107], v[112:115], v[216:219], a[104:107]
    v_cvt_pk_bf16_f32 v58, v54, v55
    v_cvt_pk_bf16_f32 v59, v56, v57
    ds_write_b32 v1, v58 offset:6464
    ds_write_b32 v1, v59 offset:7264
    s_nop 0
    v_accvgpr_read_b32 v72, a56
    v_mfma_f32_16x16x32_bf16 a[104:107], v[144:147], v[220:223], a[104:107]
    v_accvgpr_read_b32 v73, a57
    v_accvgpr_read_b32 v74, a58
    v_accvgpr_read_b32 v75, a59
    v_add_f32 v6, v6, v19
    v_mul_f32 v72, v72, v249
    s_waitcnt lgkmcnt(8)
    v_perm_b32 v92, v225, v224, s51
    v_perm_b32 v93, v227, v226, s51
    v_perm_b32 v94, v229, v228, s51
    v_perm_b32 v95, v231, v230, s51
    buffer_store_dwordx4 v[92:95], v2, s[16:19], s41 offen offset:384
    v_mul_f32 v73, v73, v251
    v_mfma_f32_16x16x32_bf16 a[108:111], v[112:115], v[152:155], a[108:111]
    v_mul_f32 v74, v74, v253
    v_mul_f32 v75, v75, v255
    v_add_f32 v7, v7, v20
    v_cvt_pk_bf16_f32 v76, v72, v73
    v_cvt_pk_bf16_f32 v77, v74, v75
    ds_write_b32 v1, v76 offset:6528
    v_mfma_f32_16x16x32_bf16 a[108:111], v[144:147], v[156:159], a[108:111]
    ds_write_b32 v1, v77 offset:7328
    v_mov_b32 v19, v6
    v_accvgpr_read_b32 v48, a60
    v_accvgpr_read_b32 v49, a61
    v_accvgpr_read_b32 v50, a62
    v_accvgpr_read_b32 v51, a63
    v_mov_b32 v20, v7
    v_mfma_f32_16x16x32_bf16 a[112:115], v[112:115], v[160:163], a[112:115]
    v_mul_f32 v48, v48, v249
    v_mul_f32 v49, v49, v251
    v_mul_f32 v50, v50, v253
    v_mul_f32 v51, v51, v255
    s_nop 1
    v_cvt_pk_bf16_f32 v52, v48, v49
    s_waitcnt lgkmcnt(8)
    v_perm_b32 v96, v233, v232, s50
    v_perm_b32 v97, v235, v234, s50
    v_perm_b32 v98, v237, v236, s50
    v_perm_b32 v99, v239, v238, s50
    buffer_store_dwordx4 v[96:99], v10, s[16:19], s41 offen
    v_mfma_f32_16x16x32_bf16 a[112:115], v[144:147], v[164:167], a[112:115]
    v_cvt_pk_bf16_f32 v53, v50, v51
    ds_write_b32 v1, v52 offset:6592
    ds_write_b32 v1, v53 offset:7392
    v_permlane32_swap_b32 v6, v19
    v_accvgpr_read_b32 v54, a64
    v_accvgpr_read_b32 v55, a65
    v_mfma_f32_16x16x32_bf16 a[116:119], v[112:115], v[168:171], a[116:119]
    v_accvgpr_read_b32 v56, a66
    v_accvgpr_read_b32 v57, a67
    v_permlane32_swap_b32 v7, v20
    v_mul_f32 v54, v54, v249
    v_mul_f32 v55, v55, v251
    v_mul_f32 v56, v56, v253
    v_mfma_f32_16x16x32_bf16 a[116:119], v[144:147], v[172:175], a[116:119]
    v_mul_f32 v57, v57, v255
    s_nop 0
    v_cvt_pk_bf16_f32 v58, v54, v55
    v_cvt_pk_bf16_f32 v59, v56, v57
    ds_write_b32 v1, v58 offset:6656
    ds_write_b32 v1, v59 offset:7456
    v_add_f32 v6, v6, v19
    v_mfma_f32_16x16x32_bf16 a[120:123], v[112:115], v[176:179], a[120:123]
    v_accvgpr_read_b32 v72, a68
    s_waitcnt lgkmcnt(12)
    v_perm_b32 v100, v233, v232, s51
    v_perm_b32 v101, v235, v234, s51
    v_perm_b32 v102, v237, v236, s51
    v_perm_b32 v103, v239, v238, s51
    buffer_store_dwordx4 v[100:103], v10, s[16:19], s41 offen offset:384
    v_accvgpr_read_b32 v73, a69
    v_accvgpr_read_b32 v74, a70
    v_accvgpr_read_b32 v75, a71
    v_add_f32 v7, v7, v20
    v_mul_f32 v72, v72, v249
    v_mfma_f32_16x16x32_bf16 a[120:123], v[144:147], v[180:183], a[120:123]
    v_mul_f32 v73, v73, v251
    v_mul_f32 v74, v74, v253
    v_mul_f32 v75, v75, v255
    v_add_f32 v21, v6, v7
    v_cvt_pk_bf16_f32 v76, v72, v73
    v_cvt_pk_bf16_f32 v77, v74, v75
    v_mfma_f32_16x16x32_bf16 a[124:127], v[112:115], v[184:187], a[124:127]
    ds_write_b32 v1, v76 offset:6720
    ds_write_b32 v1, v77 offset:7520
    v_min_f32 v22, v6, v7
    v_accvgpr_read_b32 v48, a72
    v_accvgpr_read_b32 v49, a73
    v_accvgpr_read_b32 v50, a74
    v_mfma_f32_16x16x32_bf16 a[124:127], v[144:147], v[188:191], a[124:127]
    v_accvgpr_read_b32 v51, a75
    v_cmp_nle_f32 s[46:47], s32, v22
    v_mul_f32 v48, v48, v249
    s_waitcnt lgkmcnt(12)
    v_perm_b32 v120, v241, v240, s50
    v_perm_b32 v121, v243, v242, s50
    v_perm_b32 v122, v245, v244, s50
    v_perm_b32 v123, v247, v246, s50
    buffer_store_dwordx4 v[120:123], v11, s[16:19], s41 offen
    v_mul_f32 v49, v49, v251
    v_mul_f32 v50, v50, v253
    v_mul_f32 v51, v51, v255
    v_cmp_nge_f32 vcc, s33, v21
    v_mfma_f32_16x16x32_bf16 a[128:131], v[112:115], v[192:195], a[128:131]
    v_cvt_pk_bf16_f32 v52, v48, v49
    v_cvt_pk_bf16_f32 v53, v50, v51
    ds_write_b32 v1, v52 offset:6784
    ds_write_b32 v1, v53 offset:7584
    v_rcp_f32 v6, v6
    v_accvgpr_read_b32 v54, a76
    v_mfma_f32_16x16x32_bf16 a[128:131], v[144:147], v[196:199], a[128:131]
    v_accvgpr_read_b32 v55, a77
    v_accvgpr_read_b32 v56, a78
    v_accvgpr_read_b32 v57, a79
    v_rcp_f32 v7, v7
    v_mul_f32 v54, v54, v249
    v_mul_f32 v55, v55, v251
    v_mfma_f32_16x16x32_bf16 a[132:135], v[112:115], v[24:27], a[132:135]
    v_mul_f32 v56, v56, v253
    v_mul_f32 v57, v57, v255
    s_nop 0
    v_cvt_pk_bf16_f32 v58, v54, v55
    s_waitcnt lgkmcnt(14)
    v_perm_b32 v124, v241, v240, s51
    v_perm_b32 v125, v243, v242, s51
    v_perm_b32 v126, v245, v244, s51
    v_perm_b32 v127, v247, v246, s51
    buffer_store_dwordx4 v[124:127], v11, s[16:19], s41 offen offset:384
    v_cvt_pk_bf16_f32 v59, v56, v57
    ds_write_b32 v1, v58 offset:6848
    v_mfma_f32_16x16x32_bf16 a[132:135], v[144:147], v[28:31], a[132:135]
    ds_write_b32 v1, v59 offset:7648
    s_or_b64 s[46:47], s[46:47], vcc
    v_accvgpr_read_b32 v72, a80
    v_accvgpr_read_b32 v73, a81
    v_accvgpr_read_b32 v74, a82
    v_accvgpr_read_b32 v75, a83
    s_or_b64 s[28:29], s[28:29], s[46:47]
    v_mfma_f32_16x16x32_bf16 a[136:139], v[112:115], v[32:35], a[136:139]
    v_mul_f32 v72, v72, v249
    v_mul_f32 v73, v73, v251
    v_mul_f32 v74, v74, v253
    v_mul_f32 v75, v75, v255
    ds_write_b64 v8, v[6:7] offset:776
    v_cvt_pk_bf16_f32 v76, v72, v73
    v_mfma_f32_16x16x32_bf16 a[136:139], v[144:147], v[36:39], a[136:139]
    v_cvt_pk_bf16_f32 v77, v74, v75
    ds_write_b32 v1, v76 offset:6912
    ds_write_b32 v1, v77 offset:7712
    ds_read_b64 v[128:129], v9 offset:776
    v_accvgpr_read_b32 v48, a84
    v_accvgpr_read_b32 v49, a85
    v_mfma_f32_16x16x32_bf16 a[140:143], v[112:115], v[40:43], a[140:143]
    v_accvgpr_read_b32 v50, a86
    v_accvgpr_read_b32 v51, a87
    ds_read_b64 v[130:131], v9 offset:792
    v_mul_f32 v48, v48, v249
    v_mul_f32 v49, v49, v251
    v_mul_f32 v50, v50, v253
    v_mfma_f32_16x16x32_bf16 a[140:143], v[144:147], v[44:47], a[140:143]
    v_mul_f32 v51, v51, v255
    ds_read_b64 v[132:133], v9 offset:1576
    v_cvt_pk_bf16_f32 v52, v48, v49
    v_cvt_pk_bf16_f32 v53, v50, v51
    ds_write_b32 v1, v52 offset:6976
    ds_write_b32 v1, v53 offset:7776
    ds_read_b64 v[134:135], v9 offset:1592
    v_accvgpr_read_b32 v54, a88
    v_accvgpr_read_b32 v55, a89
    v_accvgpr_read_b32 v56, a90
    v_accvgpr_read_b32 v57, a91
    v_mul_f32 v54, v54, v249
    v_mul_f32 v55, v55, v251
    v_mul_f32 v56, v56, v253
    v_mul_f32 v57, v57, v255
    v_cvt_pk_bf16_f32 v58, v54, v55
    v_cvt_pk_bf16_f32 v59, v56, v57
    ds_write_b32 v1, v58 offset:7040
    ds_write_b32 v1, v59 offset:7840
    v_accvgpr_read_b32 v72, a92
    v_accvgpr_read_b32 v73, a93
    v_accvgpr_read_b32 v74, a94
    v_accvgpr_read_b32 v75, a95
    v_mul_f32 v72, v72, v249
    v_mul_f32 v73, v73, v251
    v_mul_f32 v74, v74, v253
    v_mul_f32 v75, v75, v255
    v_cvt_pk_bf16_f32 v76, v72, v73
    v_cvt_pk_bf16_f32 v77, v74, v75
    ds_write_b32 v1, v76 offset:7104
    ds_write_b32 v1, v77 offset:7904
    ds_read_b128 v[224:227], v3 offset:6400
    ds_read_b128 v[228:231], v3 offset:6416
    ds_read_b128 v[232:235], v17 offset:6400
    ds_read_b128 v[236:239], v17 offset:6416
    ds_read_b128 v[240:243], v18 offset:6400
    ds_read_b128 v[244:247], v18 offset:6416
    s_nop 3
    s_waitcnt lgkmcnt(0)
    v_mfma_f32_16x16x32_bf16 a[144:147], v[116:119], v[200:203], a[144:147]
    v_accvgpr_read_b32 v48, a96
    v_accvgpr_read_b32 v49, a97
    v_accvgpr_read_b32 v50, a98
    v_accvgpr_read_b32 v51, a99
    v_mul_f32 v48, v48, v128
    v_mfma_f32_16x16x32_bf16 a[144:147], v[148:151], v[204:207], a[144:147]
    v_mul_f32 v49, v49, v130
    v_mul_f32 v50, v50, v132
    v_mul_f32 v51, v51, v134
    v_cvt_pk_bf16_f32 v52, v48, v49
    v_cvt_pk_bf16_f32 v53, v50, v51
    v_mfma_f32_16x16x32_bf16 a[148:151], v[116:119], v[208:211], a[148:151]
    ds_write_b32 v1, v52 offset:0
    ds_write_b32 v1, v53 offset:800
    v_accvgpr_read_b32 v54, a100
    s_waitcnt lgkmcnt(6)
    v_perm_b32 v88, v225, v224, s50
    v_perm_b32 v89, v227, v226, s50
    v_perm_b32 v90, v229, v228, s50
    v_perm_b32 v91, v231, v230, s50
    s_movk_i32 s41, 0x1800
    buffer_store_dwordx4 v[88:91], v2, s[16:19], s41 offen
    v_accvgpr_read_b32 v55, a101
    v_accvgpr_read_b32 v56, a102
    v_mfma_f32_16x16x32_bf16 a[148:151], v[148:151], v[212:215], a[148:151]
    v_accvgpr_read_b32 v57, a103
    v_mul_f32 v54, v54, v128
    v_mul_f32 v55, v55, v130
    v_mul_f32 v56, v56, v132
    v_mul_f32 v57, v57, v134
    v_mfma_f32_16x16x32_bf16 a[152:155], v[116:119], v[216:219], a[152:155]
    v_cvt_pk_bf16_f32 v58, v54, v55
    v_cvt_pk_bf16_f32 v59, v56, v57
    ds_write_b32 v1, v58 offset:64
    ds_write_b32 v1, v59 offset:864
    v_accvgpr_read_b32 v72, a104
    v_mfma_f32_16x16x32_bf16 a[152:155], v[148:151], v[220:223], a[152:155]
    v_accvgpr_read_b32 v73, a105
    v_accvgpr_read_b32 v74, a106
    v_accvgpr_read_b32 v75, a107
    v_mul_f32 v72, v72, v128
    s_waitcnt lgkmcnt(8)
    v_perm_b32 v92, v225, v224, s51
    v_perm_b32 v93, v227, v226, s51
    v_perm_b32 v94, v229, v228, s51
    v_perm_b32 v95, v231, v230, s51
    buffer_store_dwordx4 v[92:95], v2, s[16:19], s41 offen offset:384
    v_mul_f32 v73, v73, v130
    v_mfma_f32_16x16x32_bf16 a[156:159], v[116:119], v[152:155], a[156:159]
    v_mul_f32 v74, v74, v132
    v_mul_f32 v75, v75, v134
    v_cvt_pk_bf16_f32 v76, v72, v73
    v_cvt_pk_bf16_f32 v77, v74, v75
    ds_write_b32 v1, v76 offset:128
    v_mfma_f32_16x16x32_bf16 a[156:159], v[148:151], v[156:159], a[156:159]
    ds_write_b32 v1, v77 offset:928
    v_accvgpr_read_b32 v48, a108
    v_accvgpr_read_b32 v49, a109
    v_accvgpr_read_b32 v50, a110
    v_accvgpr_read_b32 v51, a111
    v_mfma_f32_16x16x32_bf16 a[160:163], v[116:119], v[160:163], a[160:163]
    v_mul_f32 v48, v48, v128
    v_mul_f32 v49, v49, v130
    v_mul_f32 v50, v50, v132
    v_mul_f32 v51, v51, v134
    v_cvt_pk_bf16_f32 v52, v48, v49
    s_waitcnt lgkmcnt(8)
    v_perm_b32 v96, v233, v232, s50
    v_perm_b32 v97, v235, v234, s50
    v_perm_b32 v98, v237, v236, s50
    v_perm_b32 v99, v239, v238, s50
    buffer_store_dwordx4 v[96:99], v10, s[16:19], s41 offen
    v_mfma_f32_16x16x32_bf16 a[160:163], v[148:151], v[164:167], a[160:163]
    v_cvt_pk_bf16_f32 v53, v50, v51
    ds_write_b32 v1, v52 offset:192
    ds_write_b32 v1, v53 offset:992
    v_accvgpr_read_b32 v54, a112
    v_accvgpr_read_b32 v55, a113
    v_mfma_f32_16x16x32_bf16 a[164:167], v[116:119], v[168:171], a[164:167]
    v_accvgpr_read_b32 v56, a114
    v_accvgpr_read_b32 v57, a115
    v_mul_f32 v54, v54, v128
    v_mul_f32 v55, v55, v130
    v_mul_f32 v56, v56, v132
    v_mfma_f32_16x16x32_bf16 a[164:167], v[148:151], v[172:175], a[164:167]
    v_mul_f32 v57, v57, v134
    v_cvt_pk_bf16_f32 v58, v54, v55
    v_cvt_pk_bf16_f32 v59, v56, v57
    ds_write_b32 v1, v58 offset:256
    ds_write_b32 v1, v59 offset:1056
    v_mfma_f32_16x16x32_bf16 a[168:171], v[116:119], v[176:179], a[168:171]
    v_accvgpr_read_b32 v72, a116
    s_waitcnt lgkmcnt(12)
    v_perm_b32 v100, v233, v232, s51
    v_perm_b32 v101, v235, v234, s51
    v_perm_b32 v102, v237, v236, s51
    v_perm_b32 v103, v239, v238, s51
    buffer_store_dwordx4 v[100:103], v10, s[16:19], s41 offen offset:384
    v_accvgpr_read_b32 v73, a117
    v_accvgpr_read_b32 v74, a118
    v_accvgpr_read_b32 v75, a119
    v_mul_f32 v72, v72, v128
    v_mfma_f32_16x16x32_bf16 a[168:171], v[148:151], v[180:183], a[168:171]
    v_mul_f32 v73, v73, v130
    v_mul_f32 v74, v74, v132
    v_mul_f32 v75, v75, v134
    v_cvt_pk_bf16_f32 v76, v72, v73
    v_cvt_pk_bf16_f32 v77, v74, v75
    v_mfma_f32_16x16x32_bf16 a[172:175], v[116:119], v[184:187], a[172:175]
    ds_write_b32 v1, v76 offset:320
    ds_write_b32 v1, v77 offset:1120
    v_accvgpr_read_b32 v48, a120
    v_accvgpr_read_b32 v49, a121
    v_accvgpr_read_b32 v50, a122
    v_mfma_f32_16x16x32_bf16 a[172:175], v[148:151], v[188:191], a[172:175]
    v_accvgpr_read_b32 v51, a123
    v_mul_f32 v48, v48, v128
    s_waitcnt lgkmcnt(12)
    v_perm_b32 v120, v241, v240, s50
    v_perm_b32 v121, v243, v242, s50
    v_perm_b32 v122, v245, v244, s50
    v_perm_b32 v123, v247, v246, s50
    buffer_store_dwordx4 v[120:123], v11, s[16:19], s41 offen
    v_mul_f32 v49, v49, v130
    v_mul_f32 v50, v50, v132
    v_mul_f32 v51, v51, v134
    v_mfma_f32_16x16x32_bf16 a[176:179], v[116:119], v[192:195], a[176:179]
    v_cvt_pk_bf16_f32 v52, v48, v49
    v_cvt_pk_bf16_f32 v53, v50, v51
    ds_write_b32 v1, v52 offset:384
    ds_write_b32 v1, v53 offset:1184
    v_accvgpr_read_b32 v54, a124
    v_mfma_f32_16x16x32_bf16 a[176:179], v[148:151], v[196:199], a[176:179]
    v_accvgpr_read_b32 v55, a125
    v_accvgpr_read_b32 v56, a126
    v_accvgpr_read_b32 v57, a127
    v_mul_f32 v54, v54, v128
    v_mul_f32 v55, v55, v130
    v_mfma_f32_16x16x32_bf16 a[180:183], v[116:119], v[24:27], a[180:183]
    v_mul_f32 v56, v56, v132
    v_mul_f32 v57, v57, v134
    v_cvt_pk_bf16_f32 v58, v54, v55
    s_waitcnt lgkmcnt(14)
    v_perm_b32 v124, v241, v240, s51
    v_perm_b32 v125, v243, v242, s51
    v_perm_b32 v126, v245, v244, s51
    v_perm_b32 v127, v247, v246, s51
    buffer_store_dwordx4 v[124:127], v11, s[16:19], s41 offen offset:384
    v_cvt_pk_bf16_f32 v59, v56, v57
    ds_write_b32 v1, v58 offset:448
    v_mfma_f32_16x16x32_bf16 a[180:183], v[148:151], v[28:31], a[180:183]
    ds_write_b32 v1, v59 offset:1248
    v_accvgpr_read_b32 v72, a128
    v_accvgpr_read_b32 v73, a129
    v_accvgpr_read_b32 v74, a130
    v_accvgpr_read_b32 v75, a131
    v_mfma_f32_16x16x32_bf16 a[184:187], v[116:119], v[32:35], a[184:187]
    v_mul_f32 v72, v72, v128
    v_mul_f32 v73, v73, v130
    v_mul_f32 v74, v74, v132
    v_mul_f32 v75, v75, v134
    v_cvt_pk_bf16_f32 v76, v72, v73
    v_mfma_f32_16x16x32_bf16 a[184:187], v[148:151], v[36:39], a[184:187]
    v_cvt_pk_bf16_f32 v77, v74, v75
    ds_write_b32 v1, v76 offset:512
    ds_write_b32 v1, v77 offset:1312
    v_accvgpr_read_b32 v48, a132
    v_accvgpr_read_b32 v49, a133
    v_mfma_f32_16x16x32_bf16 a[188:191], v[116:119], v[40:43], a[188:191]
    v_accvgpr_read_b32 v50, a134
    v_accvgpr_read_b32 v51, a135
    v_mul_f32 v48, v48, v128
    v_mul_f32 v49, v49, v130
    v_mul_f32 v50, v50, v132
    v_mfma_f32_16x16x32_bf16 a[188:191], v[148:151], v[44:47], a[188:191]
    v_mul_f32 v51, v51, v134
    v_cvt_pk_bf16_f32 v52, v48, v49
    v_cvt_pk_bf16_f32 v53, v50, v51
    ds_write_b32 v1, v52 offset:576
    ds_write_b32 v1, v53 offset:1376
    v_accvgpr_read_b32 v54, a136
    v_accvgpr_read_b32 v55, a137
    v_accvgpr_read_b32 v56, a138
    v_accvgpr_read_b32 v57, a139
    v_mul_f32 v54, v54, v128
    v_mul_f32 v55, v55, v130
    v_mul_f32 v56, v56, v132
    v_mul_f32 v57, v57, v134
    v_cvt_pk_bf16_f32 v58, v54, v55
    v_cvt_pk_bf16_f32 v59, v56, v57
    ds_write_b32 v1, v58 offset:640
    ds_write_b32 v1, v59 offset:1440
    v_accvgpr_read_b32 v72, a140
    v_accvgpr_read_b32 v73, a141
    v_accvgpr_read_b32 v74, a142
    v_accvgpr_read_b32 v75, a143
    v_mul_f32 v72, v72, v128
    v_mul_f32 v73, v73, v130
    v_mul_f32 v74, v74, v132
    v_mul_f32 v75, v75, v134
    v_cvt_pk_bf16_f32 v76, v72, v73
    v_cvt_pk_bf16_f32 v77, v74, v75
    ds_write_b32 v1, v76 offset:704
    ds_write_b32 v1, v77 offset:1504
    ds_read_b128 v[224:227], v3 offset:0
    ds_read_b128 v[228:231], v3 offset:16
    ds_read_b128 v[232:235], v17 offset:0
    ds_read_b128 v[236:239], v17 offset:16
    ds_read_b128 v[240:243], v18 offset:0
    ds_read_b128 v[244:247], v18 offset:16
    s_nop 3
    v_accvgpr_read_b32 v48, a144
    v_accvgpr_read_b32 v49, a145
    v_accvgpr_read_b32 v50, a146
    v_accvgpr_read_b32 v51, a147
    v_mul_f32 v48, v48, v129
    v_mul_f32 v49, v49, v131
    v_mul_f32 v50, v50, v133
    v_mul_f32 v51, v51, v135
    v_cvt_pk_bf16_f32 v52, v48, v49
    v_cvt_pk_bf16_f32 v53, v50, v51
    ds_write_b32 v1, v52 offset:6400
    ds_write_b32 v1, v53 offset:7200
    v_accvgpr_read_b32 v54, a148
    s_waitcnt lgkmcnt(6)
    v_perm_b32 v88, v225, v224, s50
    v_perm_b32 v89, v227, v226, s50
    v_perm_b32 v90, v229, v228, s50
    v_perm_b32 v91, v231, v230, s50
    s_movk_i32 s41, 0x3000
    buffer_store_dwordx4 v[88:91], v2, s[16:19], s41 offen
    v_accvgpr_read_b32 v55, a149
    v_accvgpr_read_b32 v56, a150
    v_accvgpr_read_b32 v57, a151
    v_mul_f32 v54, v54, v129
    v_mul_f32 v55, v55, v131
    v_mul_f32 v56, v56, v133
    v_mul_f32 v57, v57, v135
    v_cvt_pk_bf16_f32 v58, v54, v55
    v_cvt_pk_bf16_f32 v59, v56, v57
    ds_write_b32 v1, v58 offset:6464
    ds_write_b32 v1, v59 offset:7264
    v_accvgpr_read_b32 v72, a152
    v_accvgpr_read_b32 v73, a153
    v_accvgpr_read_b32 v74, a154
    v_accvgpr_read_b32 v75, a155
    v_mul_f32 v72, v72, v129
    s_waitcnt lgkmcnt(8)
    v_perm_b32 v92, v225, v224, s51
    v_perm_b32 v93, v227, v226, s51
    v_perm_b32 v94, v229, v228, s51
    v_perm_b32 v95, v231, v230, s51
    buffer_store_dwordx4 v[92:95], v2, s[16:19], s41 offen offset:384
    v_mul_f32 v73, v73, v131
    v_mul_f32 v74, v74, v133
    v_mul_f32 v75, v75, v135
    v_cvt_pk_bf16_f32 v76, v72, v73
    v_cvt_pk_bf16_f32 v77, v74, v75
    ds_write_b32 v1, v76 offset:6528
    ds_write_b32 v1, v77 offset:7328
    v_accvgpr_read_b32 v48, a156
    v_accvgpr_read_b32 v49, a157
    v_accvgpr_read_b32 v50, a158
    v_accvgpr_read_b32 v51, a159
    v_mul_f32 v48, v48, v129
    v_mul_f32 v49, v49, v131
    v_mul_f32 v50, v50, v133
    v_mul_f32 v51, v51, v135
    v_cvt_pk_bf16_f32 v52, v48, v49
    s_waitcnt lgkmcnt(8)
    v_perm_b32 v96, v233, v232, s50
    v_perm_b32 v97, v235, v234, s50
    v_perm_b32 v98, v237, v236, s50
    v_perm_b32 v99, v239, v238, s50
    buffer_store_dwordx4 v[96:99], v10, s[16:19], s41 offen
    v_cvt_pk_bf16_f32 v53, v50, v51
    ds_write_b32 v1, v52 offset:6592
    ds_write_b32 v1, v53 offset:7392
    v_accvgpr_read_b32 v54, a160
    v_accvgpr_read_b32 v55, a161
    v_accvgpr_read_b32 v56, a162
    v_accvgpr_read_b32 v57, a163
    v_mul_f32 v54, v54, v129
    v_mul_f32 v55, v55, v131
    v_mul_f32 v56, v56, v133
    v_mul_f32 v57, v57, v135
    v_cvt_pk_bf16_f32 v58, v54, v55
    v_cvt_pk_bf16_f32 v59, v56, v57
    ds_write_b32 v1, v58 offset:6656
    ds_write_b32 v1, v59 offset:7456
    v_accvgpr_read_b32 v72, a164
    s_waitcnt lgkmcnt(12)
    v_perm_b32 v100, v233, v232, s51
    v_perm_b32 v101, v235, v234, s51
    v_perm_b32 v102, v237, v236, s51
    v_perm_b32 v103, v239, v238, s51
    buffer_store_dwordx4 v[100:103], v10, s[16:19], s41 offen offset:384
    v_accvgpr_read_b32 v73, a165
    v_accvgpr_read_b32 v74, a166
    v_accvgpr_read_b32 v75, a167
    v_mul_f32 v72, v72, v129
    v_mul_f32 v73, v73, v131
    v_mul_f32 v74, v74, v133
    v_mul_f32 v75, v75, v135
    v_cvt_pk_bf16_f32 v76, v72, v73
    v_cvt_pk_bf16_f32 v77, v74, v75
    ds_write_b32 v1, v76 offset:6720
    ds_write_b32 v1, v77 offset:7520
    v_accvgpr_read_b32 v48, a168
    v_accvgpr_read_b32 v49, a169
    v_accvgpr_read_b32 v50, a170
    v_accvgpr_read_b32 v51, a171
    v_mul_f32 v48, v48, v129
    s_waitcnt lgkmcnt(12)
    v_perm_b32 v120, v241, v240, s50
    v_perm_b32 v121, v243, v242, s50
    v_perm_b32 v122, v245, v244, s50
    v_perm_b32 v123, v247, v246, s50
    buffer_store_dwordx4 v[120:123], v11, s[16:19], s41 offen
    v_mul_f32 v49, v49, v131
    v_mul_f32 v50, v50, v133
    v_mul_f32 v51, v51, v135
    v_cvt_pk_bf16_f32 v52, v48, v49
    v_cvt_pk_bf16_f32 v53, v50, v51
    ds_write_b32 v1, v52 offset:6784
    ds_write_b32 v1, v53 offset:7584
    v_accvgpr_read_b32 v54, a172
    v_accvgpr_read_b32 v55, a173
    v_accvgpr_read_b32 v56, a174
    v_accvgpr_read_b32 v57, a175
    v_mul_f32 v54, v54, v129
    v_mul_f32 v55, v55, v131
    v_mul_f32 v56, v56, v133
    v_mul_f32 v57, v57, v135
    v_cvt_pk_bf16_f32 v58, v54, v55
    s_waitcnt lgkmcnt(14)
    v_perm_b32 v124, v241, v240, s51
    v_perm_b32 v125, v243, v242, s51
    v_perm_b32 v126, v245, v244, s51
    v_perm_b32 v127, v247, v246, s51
    buffer_store_dwordx4 v[124:127], v11, s[16:19], s41 offen offset:384
    v_cvt_pk_bf16_f32 v59, v56, v57
    ds_write_b32 v1, v58 offset:6848
    ds_write_b32 v1, v59 offset:7648
    v_accvgpr_read_b32 v72, a176
    v_accvgpr_read_b32 v73, a177
    v_accvgpr_read_b32 v74, a178
    v_accvgpr_read_b32 v75, a179
    v_mul_f32 v72, v72, v129
    v_mul_f32 v73, v73, v131
    v_mul_f32 v74, v74, v133
    v_mul_f32 v75, v75, v135
    v_cvt_pk_bf16_f32 v76, v72, v73
    v_cvt_pk_bf16_f32 v77, v74, v75
    ds_write_b32 v1, v76 offset:6912
    ds_write_b32 v1, v77 offset:7712
    v_accvgpr_read_b32 v48, a180
    v_accvgpr_read_b32 v49, a181
    v_accvgpr_read_b32 v50, a182
    v_accvgpr_read_b32 v51, a183
    v_mul_f32 v48, v48, v129
    v_mul_f32 v49, v49, v131
    v_mul_f32 v50, v50, v133
    v_mul_f32 v51, v51, v135
    v_cvt_pk_bf16_f32 v52, v48, v49
    v_cvt_pk_bf16_f32 v53, v50, v51
    ds_write_b32 v1, v52 offset:6976
    ds_write_b32 v1, v53 offset:7776
    v_accvgpr_read_b32 v54, a184
    v_accvgpr_read_b32 v55, a185
    v_accvgpr_read_b32 v56, a186
    v_accvgpr_read_b32 v57, a187
    v_mul_f32 v54, v54, v129
    v_mul_f32 v55, v55, v131
    v_mul_f32 v56, v56, v133
    v_mul_f32 v57, v57, v135
    v_cvt_pk_bf16_f32 v58, v54, v55
    v_cvt_pk_bf16_f32 v59, v56, v57
    ds_write_b32 v1, v58 offset:7040
    ds_write_b32 v1, v59 offset:7840
    v_accvgpr_read_b32 v72, a188
    v_accvgpr_read_b32 v73, a189
    v_accvgpr_read_b32 v74, a190
    v_accvgpr_read_b32 v75, a191
    v_mul_f32 v72, v72, v129
    v_mul_f32 v73, v73, v131
    v_mul_f32 v74, v74, v133
    v_mul_f32 v75, v75, v135
    v_cvt_pk_bf16_f32 v76, v72, v73
    v_cvt_pk_bf16_f32 v77, v74, v75
    ds_write_b32 v1, v76 offset:7104
    ds_write_b32 v1, v77 offset:7904
    ds_read_b128 v[224:227], v3 offset:6400
    ds_read_b128 v[228:231], v3 offset:6416
    ds_read_b128 v[232:235], v17 offset:6400
    ds_read_b128 v[236:239], v17 offset:6416
    ds_read_b128 v[240:243], v18 offset:6400
    ds_read_b128 v[244:247], v18 offset:6416
    s_waitcnt lgkmcnt(4)
    v_perm_b32 v88, v225, v224, s50
    v_perm_b32 v89, v227, v226, s50
    v_perm_b32 v90, v229, v228, s50
    v_perm_b32 v91, v231, v230, s50
    s_movk_i32 s41, 0x4800
    buffer_store_dwordx4 v[88:91], v2, s[16:19], s41 offen
    s_waitcnt lgkmcnt(4)
    v_perm_b32 v92, v225, v224, s51
    v_perm_b32 v93, v227, v226, s51
    v_perm_b32 v94, v229, v228, s51
    v_perm_b32 v95, v231, v230, s51
    buffer_store_dwordx4 v[92:95], v2, s[16:19], s41 offen offset:384
    s_waitcnt lgkmcnt(2)
    v_perm_b32 v96, v233, v232, s50
    v_perm_b32 v97, v235, v234, s50
    v_perm_b32 v98, v237, v236, s50
    v_perm_b32 v99, v239, v238, s50
    buffer_store_dwordx4 v[96:99], v10, s[16:19], s41 offen
    s_waitcnt lgkmcnt(2)
    v_perm_b32 v100, v233, v232, s51
    v_perm_b32 v101, v235, v234, s51
    v_perm_b32 v102, v237, v236, s51
    v_perm_b32 v103, v239, v238, s51
    buffer_store_dwordx4 v[100:103], v10, s[16:19], s41 offen offset:384
    s_waitcnt lgkmcnt(0)
    v_perm_b32 v120, v241, v240, s50
    v_perm_b32 v121, v243, v242, s50
    v_perm_b32 v122, v245, v244, s50
    v_perm_b32 v123, v247, v246, s50
    buffer_store_dwordx4 v[120:123], v11, s[16:19], s41 offen
    s_waitcnt lgkmcnt(0)
    v_perm_b32 v124, v241, v240, s51
    v_perm_b32 v125, v243, v242, s51
    v_perm_b32 v126, v245, v244, s51
    v_perm_b32 v127, v247, v246, s51
    buffer_store_dwordx4 v[124:127], v11, s[16:19], s41 offen offset:384
    v_mov_b32 v19, 149504
    s_cmp_eq_u64 s[28:29], 0
    s_cbranch_scc1 L_noflag
    v_mov_b32 v20, 1
    ds_write_b32 v19, v20
L_noflag:
    s_waitcnt lgkmcnt(0)
    s_barrier
    ds_read_b32 v20, v19
    s_waitcnt lgkmcnt(0)
    v_readfirstlane_b32 s40, v20
    s_nop 3
    s_cmp_lg_u32 s40, 0
    s_cbranch_scc1 L_slow
L_end:
    s_endpgm
L_slow:
    s_waitcnt vmcnt(0) lgkmcnt(0)
    s_barrier
    s_cmp_ge_u32 s2, 256
    s_cbranch_scc1 Z_end
    s_load_dwordx4 s[4:7], s[0:1], 0
    s_load_dwordx4 s[56:59], s[0:1], 16
    v_and_b32 v1, 63, v0
    v_lshrrev_b32 v2, 6, v0
    v_and_b32 v29, 15, v0
    v_readfirstlane_b32 s24, v2
    v_lshrrev_b32 v30, 4, v1
    s_and_b32 s40, s2, 7
    s_lshl_b32 s40, s40, 2
    s_lshr_b32 s41, s2, 6
    s_add_u32 s40, s40, s41
    s_lshr_b32 s41, s2, 3
    s_and_b32 s41, s41, 7
    s_mul_i32 s42, s40, 786432
    s_mul_i32 s43, s41, 98304
    s_mul_i32 s41, s24, 24576
    s_add_u32 s43, s43, s41
    s_add_u32 s43, s43, s42
    s_mul_i32 s41, s24, 192
    v_add_u32 v2, s41, v1
    v_mul_u32_u24 v3, 2731, v2
    v_lshrrev_b32 v3, 16, v3
    v_mul_u32_u24 v31, 24, v3
    v_sub_u32 v2, v2, v31
    v_and_b32 v31, 6, v3
    v_xor_b32 v2, v2, v31
    v_lshlrev_b32 v2, 4, v2
    v_mul_u32_u24 v3, 384, v3
    v_add_u32 v26, v2, v3
    v_add_u32 v2, s41, v1
    v_add_u32 v2, 64, v2
    v_mul_u32_u24 v3, 2731, v2
    v_lshrrev_b32 v3, 16, v3
    v_mul_u32_u24 v31, 24, v3
    v_sub_u32 v2, v2, v31
    v_and_b32 v31, 6, v3
    v_xor_b32 v2, v2, v31
    v_lshlrev_b32 v2, 4, v2
    v_mul_u32_u24 v3, 384, v3
    v_add_u32 v27, v2, v3
    v_subrev_u32 v27, 1024, v27
    v_add_u32 v2, s41, v1
    v_add_u32 v2, 128, v2
    v_mul_u32_u24 v3, 2731, v2
    v_lshrrev_b32 v3, 16, v3
    v_mul_u32_u24 v31, 24, v3
    v_sub_u32 v2, v2, v31
    v_and_b32 v31, 6, v3
    v_xor_b32 v2, v2, v31
    v_lshlrev_b32 v2, 4, v2
    v_mul_u32_u24 v3, 384, v3
    v_add_u32 v28, v2, v3
    v_subrev_u32 v28, 2048, v28
    s_mul_i32 s41, s24, 3072
    v_subrev_u32 v248, s41, v26
    v_subrev_u32 v249, s41, v27
    v_subrev_u32 v250, s41, v28
    s_mul_i32 s38, s24, 12800
    s_add_u32 s38, s38, 98304
    s_mul_i32 s41, s24, 3072
    s_add_u32 s35, s41, 0
    s_add_u32 s36, s41, 49152
    s_waitcnt lgkmcnt(0)
    s_add_u32 s8, s6, s42
    s_addc_u32 s9, s7, 0
    s_mov_b32 s10, 786432
    s_mov_b32 s11, 0x20000
    s_mov_b32 s41, 0
    s_add_u32 m0, s35, 0
    s_nop 0
    buffer_load_dwordx4 v26, s[8:11], s41 offen lds
    buffer_load_dwordx4 v27, s[8:11], s41 offen offset:1024 lds
    buffer_load_dwordx4 v28, s[8:11], s41 offen offset:2048 lds
    s_add_u32 s20, s4, s43
    s_addc_u32 s21, s5, 0
    s_mov_b32 s22, 24576
    s_mov_b32 s23, 0x20000
    s_mov_b32 s40, 0
    s_add_u32 m0, s38, 0
    s_nop 0
    buffer_load_dwordx4 v248, s[20:23], s40 offen nt lds
    buffer_load_dwordx4 v249, s[20:23], s40 offen offset:1024 nt lds
    buffer_load_dwordx4 v250, s[20:23], s40 offen offset:2048 nt lds
    s_mov_b32 s40, 3072
    s_add_u32 m0, s38, 3072
    s_nop 0
    buffer_load_dwordx4 v248, s[20:23], s40 offen nt lds
    buffer_load_dwordx4 v249, s[20:23], s40 offen offset:1024 nt lds
    buffer_load_dwordx4 v250, s[20:23], s40 offen offset:2048 nt lds
    s_add_u32 s12, s56, s42
    s_addc_u32 s13, s57, 0
    s_mov_b32 s14, 786432
    s_mov_b32 s15, 0x20000
    s_add_u32 s16, s58, s43
    s_addc_u32 s17, s59, 0
    s_mov_b32 s18, 24576
    s_mov_b32 s19, 0x20000
    v_and_b32 v2, 6, v29
    v_xor_b32 v2, v2, v30
    v_lshlrev_b32 v2, 4, v2
    v_mul_u32_u24 v3, 384, v29
    v_add_u32 v20, v2, v3
    v_xor_b32 v21, 64, v20
    v_lshrrev_b32 v2, 2, v29
    v_lshl_add_u32 v2, v30, 2, v2
    v_and_b32 v3, 6, v2
    v_bfe_u32 v31, v29, 1, 1
    v_or_b32 v3, v3, v31
    v_lshlrev_b32 v3, 4, v3
    v_and_b32 v31, 1, v29
    v_lshl_add_u32 v3, v31, 3, v3
    v_mul_u32_u24 v2, 384, v2
    v_add_u32 v22, v2, v3
    v_add_u32 v22, 49152, v22
    v_xor_b32 v23, 32, v22
    v_xor_b32 v24, 64, v22
    v_xor_b32 v25, 96, v22
    v_add_u32 v251, s38, v20
    v_add_u32 v252, s38, v21
    s_mul_i32 s40, s24, 12800
    s_add_u32 s40, s40, 98304
    v_mul_u32_u24 v1, 400, v29
    v_lshl_add_u32 v1, v30, 3, v1
    v_add_u32 v1, s40, v1
    v_and_b32 v29, 63, v0
    v_lshlrev_b32 v2, 4, v29
    v_add_u32 v30, 0, v29
    v_mul_u32_u24 v31, 2731, v30
    v_lshrrev_b32 v31, 16, v31
    v_add_u32 v30, v30, v31
    v_lshlrev_b32 v3, 4, v30
    v_add_u32 v3, s40, v3
    v_add_u32 v30, 64, v29
    v_mul_u32_u24 v31, 2731, v30
    v_lshrrev_b32 v31, 16, v31
    v_add_u32 v30, v30, v31
    v_lshlrev_b32 v253, 4, v30
    v_add_u32 v253, s40, v253
    v_add_u32 v30, 128, v29
    v_mul_u32_u24 v31, 2731, v30
    v_lshrrev_b32 v31, 16, v31
    v_add_u32 v30, v30, v31
    v_lshlrev_b32 v254, 4, v30
    v_add_u32 v254, s40, v254
    v_mov_b32 v12, 0
    v_mov_b32 v13, 0
    v_mov_b32 v14, 0
    v_mov_b32 v15, 0
    s_nop 1
    v_mfma_f32_32x32x16_bf16 a[0:15], v[12:15], v[12:15], 0
    v_mfma_f32_32x32x16_bf16 a[16:31], v[12:15], v[12:15], 0
    v_mfma_f32_32x32x16_bf16 a[32:47], v[12:15], v[12:15], 0
    v_mfma_f32_32x32x16_bf16 a[48:63], v[12:15], v[12:15], 0
    v_mfma_f32_32x32x16_bf16 a[64:79], v[12:15], v[12:15], 0
    v_mfma_f32_32x32x16_bf16 a[80:95], v[12:15], v[12:15], 0
    v_mfma_f32_32x32x16_bf16 a[96:111], v[12:15], v[12:15], 0
    v_mfma_f32_32x32x16_bf16 a[112:127], v[12:15], v[12:15], 0
    v_mfma_f32_32x32x16_bf16 a[128:143], v[12:15], v[12:15], 0
    v_mfma_f32_32x32x16_bf16 a[144:159], v[12:15], v[12:15], 0
    v_mfma_f32_32x32x16_bf16 a[160:175], v[12:15], v[12:15], 0
    v_mfma_f32_32x32x16_bf16 a[176:191], v[12:15], v[12:15], 0
    v_mov_b32 v4, 0
    v_mov_b32 v5, 0
    v_mov_b32 v6, 0
    v_mov_b32 v7, 0
    s_mov_b32 s44, 0x3dd53b95
    s_mov_b32 s34, 0x47800000
    s_mov_b32 s25, 49152
    s_mov_b32 s26, 36864
    s_mov_b32 s31, 0
    s_mov_b32 s41, 12288
    s_add_u32 m0, s35, 12288
    s_nop 0
    buffer_load_dwordx4 v26, s[8:11], s41 offen lds
    buffer_load_dwordx4 v27, s[8:11], s41 offen offset:1024 lds
    buffer_load_dwordx4 v28, s[8:11], s41 offen offset:2048 lds
    s_mov_b32 s40, 6144
    s_add_u32 m0, s38, 6400
    s_nop 0
    buffer_load_dwordx4 v248, s[20:23], s40 offen nt lds
    buffer_load_dwordx4 v249, s[20:23], s40 offen offset:1024 nt lds
    buffer_load_dwordx4 v250, s[20:23], s40 offen offset:2048 nt lds
    s_mov_b32 s40, 9216
    s_add_u32 m0, s38, 9472
    s_nop 0
    buffer_load_dwordx4 v248, s[20:23], s40 offen nt lds
    buffer_load_dwordx4 v249, s[20:23], s40 offen offset:1024 nt lds
    buffer_load_dwordx4 v250, s[20:23], s40 offen offset:2048 nt lds
    s_waitcnt vmcnt(15)
    s_barrier
    ds_read_b128 v[144:147], v20 offset:0
    ds_read_b128 v[148:151], v21 offset:0
    ds_read_b128 v[152:155], v20 offset:128
    ds_read_b128 v[156:159], v21 offset:128
    ds_read_b128 v[160:163], v20 offset:256
    ds_read_b128 v[164:167], v21 offset:256
    ds_read_b128 v[168:171], v20 offset:6144
    ds_read_b128 v[172:175], v21 offset:6144
    ds_read_b128 v[176:179], v20 offset:6272
    ds_read_b128 v[180:183], v21 offset:6272
    ds_read_b128 v[184:187], v20 offset:6400
    ds_read_b128 v[188:191], v21 offset:6400
    s_waitcnt vmcnt(9)
    ds_read_b128 v[64:67], v251 offset:0
    ds_read_b128 v[68:71], v252 offset:0
    ds_read_b128 v[72:75], v251 offset:128
    ds_read_b128 v[76:79], v252 offset:128
    ds_read_b128 v[80:83], v251 offset:256
    ds_read_b128 v[84:87], v252 offset:256
    s_waitcnt lgkmcnt(0)
    s_mov_b32 s40, 12288
    s_add_u32 m0, s38, 0
    s_nop 0
    buffer_load_dwordx4 v248, s[20:23], s40 offen nt lds
    v_and_b32 v12, 0xffff0000, v64
    v_lshlrev_b32 v13, 16, v64
    v_mul_f32 v12, s44, v12
    v_mul_f32 v13, s44, v13
    v_cvt_pk_bf16_f32 v14, v13, v12
    v_accvgpr_write_b32 a192, v14
    v_and_b32 v15, 0xffff0000, v65
    v_lshlrev_b32 v16, 16, v65
    v_mul_f32 v15, s44, v15
    v_mul_f32 v16, s44, v16
    v_cvt_pk_bf16_f32 v17, v16, v15
    v_accvgpr_write_b32 a193, v17
    v_and_b32 v12, 0xffff0000, v66
    v_lshlrev_b32 v13, 16, v66
    v_mul_f32 v12, s44, v12
    v_mul_f32 v13, s44, v13
    v_cvt_pk_bf16_f32 v14, v13, v12
    v_accvgpr_write_b32 a194, v14
    v_and_b32 v15, 0xffff0000, v67
    v_lshlrev_b32 v16, 16, v67
    v_mul_f32 v15, s44, v15
    v_mul_f32 v16, s44, v16
    v_cvt_pk_bf16_f32 v17, v16, v15
    v_accvgpr_write_b32 a195, v17
    buffer_load_dwordx4 v249, s[20:23], s40 offen offset:1024 nt lds
    v_and_b32 v12, 0xffff0000, v68
    v_lshlrev_b32 v13, 16, v68
    v_mul_f32 v12, s44, v12
    v_mul_f32 v13, s44, v13
    v_cvt_pk_bf16_f32 v14, v13, v12
    v_accvgpr_write_b32 a196, v14
    v_and_b32 v15, 0xffff0000, v69
    v_lshlrev_b32 v16, 16, v69
    v_mul_f32 v15, s44, v15
    v_mul_f32 v16, s44, v16
    v_cvt_pk_bf16_f32 v17, v16, v15
    v_accvgpr_write_b32 a197, v17
    s_waitcnt lgkmcnt(0)
    v_mfma_f32_16x16x32_bf16 v[32:35], v[144:147], a[192:195], 0
    v_mfma_f32_16x16x32_bf16 v[48:51], v[168:171], a[192:195], 0
    v_and_b32 v12, 0xffff0000, v70
    v_lshlrev_b32 v13, 16, v70
    v_mul_f32 v12, s44, v12
    v_mul_f32 v13, s44, v13
    v_cvt_pk_bf16_f32 v14, v13, v12
    v_accvgpr_write_b32 a198, v14
    v_and_b32 v15, 0xffff0000, v71
    v_lshlrev_b32 v16, 16, v71
    v_mul_f32 v15, s44, v15
    v_mul_f32 v16, s44, v16
    v_cvt_pk_bf16_f32 v17, v16, v15
    v_accvgpr_write_b32 a199, v17
    buffer_load_dwordx4 v250, s[20:23], s40 offen offset:2048 nt lds
    v_and_b32 v12, 0xffff0000, v72
    v_lshlrev_b32 v13, 16, v72
    v_mul_f32 v12, s44, v12
    v_mul_f32 v13, s44, v13
    v_cvt_pk_bf16_f32 v14, v13, v12
    v_accvgpr_write_b32 a200, v14
    v_and_b32 v15, 0xffff0000, v73
    v_lshlrev_b32 v16, 16, v73
    v_mul_f32 v15, s44, v15
    v_mul_f32 v16, s44, v16
    v_cvt_pk_bf16_f32 v17, v16, v15
    v_accvgpr_write_b32 a201, v17
    v_mfma_f32_16x16x32_bf16 v[32:35], v[148:151], a[196:199], v[32:35]
    v_mfma_f32_16x16x32_bf16 v[48:51], v[172:175], a[196:199], v[48:51]
    v_and_b32 v12, 0xffff0000, v74
    v_lshlrev_b32 v13, 16, v74
    v_mul_f32 v12, s44, v12
    v_mul_f32 v13, s44, v13
    v_cvt_pk_bf16_f32 v14, v13, v12
    v_accvgpr_write_b32 a202, v14
    v_and_b32 v15, 0xffff0000, v75
    v_lshlrev_b32 v16, 16, v75
    v_mul_f32 v15, s44, v15
    v_mul_f32 v16, s44, v16
    v_cvt_pk_bf16_f32 v17, v16, v15
    v_accvgpr_write_b32 a203, v17
    s_mov_b32 s40, 15360
    s_add_u32 m0, s38, 3072
    s_nop 0
    buffer_load_dwordx4 v248, s[20:23], s40 offen nt lds
    v_and_b32 v12, 0xffff0000, v76
    v_lshlrev_b32 v13, 16, v76
    v_mul_f32 v12, s44, v12
    v_mul_f32 v13, s44, v13
    v_cvt_pk_bf16_f32 v14, v13, v12
    v_accvgpr_write_b32 a204, v14
    v_and_b32 v15, 0xffff0000, v77
    v_lshlrev_b32 v16, 16, v77
    v_mul_f32 v15, s44, v15
    v_mul_f32 v16, s44, v16
    v_cvt_pk_bf16_f32 v17, v16, v15
    v_accvgpr_write_b32 a205, v17
    v_mfma_f32_16x16x32_bf16 v[32:35], v[152:155], a[200:203], v[32:35]
    v_mfma_f32_16x16x32_bf16 v[48:51], v[176:179], a[200:203], v[48:51]
    v_and_b32 v12, 0xffff0000, v78
    v_lshlrev_b32 v13, 16, v78
    v_mul_f32 v12, s44, v12
    v_mul_f32 v13, s44, v13
    v_cvt_pk_bf16_f32 v14, v13, v12
    v_accvgpr_write_b32 a206, v14
    v_and_b32 v15, 0xffff0000, v79
    v_lshlrev_b32 v16, 16, v79
    v_mul_f32 v15, s44, v15
    v_mul_f32 v16, s44, v16
    v_cvt_pk_bf16_f32 v17, v16, v15
    v_accvgpr_write_b32 a207, v17
    buffer_load_dwordx4 v249, s[20:23], s40 offen offset:1024 nt lds
    v_and_b32 v12, 0xffff0000, v80
    v_lshlrev_b32 v13, 16, v80
    v_mul_f32 v12, s44, v12
    v_mul_f32 v13, s44, v13
    v_cvt_pk_bf16_f32 v14, v13, v12
    v_accvgpr_write_b32 a208, v14
    v_and_b32 v15, 0xffff0000, v81
    v_lshlrev_b32 v16, 16, v81
    v_mul_f32 v15, s44, v15
    v_mul_f32 v16, s44, v16
    v_cvt_pk_bf16_f32 v17, v16, v15
    v_accvgpr_write_b32 a209, v17
    v_mfma_f32_16x16x32_bf16 v[32:35], v[156:159], a[204:207], v[32:35]
    v_mfma_f32_16x16x32_bf16 v[48:51], v[180:183], a[204:207], v[48:51]
    v_and_b32 v12, 0xffff0000, v82
    v_lshlrev_b32 v13, 16, v82
    v_mul_f32 v12, s44, v12
    v_mul_f32 v13, s44, v13
    v_cvt_pk_bf16_f32 v14, v13, v12
    v_accvgpr_write_b32 a210, v14
    v_and_b32 v15, 0xffff0000, v83
    v_lshlrev_b32 v16, 16, v83
    v_mul_f32 v15, s44, v15
    v_mul_f32 v16, s44, v16
    v_cvt_pk_bf16_f32 v17, v16, v15
    v_accvgpr_write_b32 a211, v17
    buffer_load_dwordx4 v250, s[20:23], s40 offen offset:2048 nt lds
    v_and_b32 v12, 0xffff0000, v84
    v_lshlrev_b32 v13, 16, v84
    v_mul_f32 v12, s44, v12
    v_mul_f32 v13, s44, v13
    v_cvt_pk_bf16_f32 v14, v13, v12
    v_accvgpr_write_b32 a212, v14
    v_and_b32 v15, 0xffff0000, v85
    v_lshlrev_b32 v16, 16, v85
    v_mul_f32 v15, s44, v15
    v_mul_f32 v16, s44, v16
    v_cvt_pk_bf16_f32 v17, v16, v15
    v_accvgpr_write_b32 a213, v17
    v_mfma_f32_16x16x32_bf16 v[32:35], v[160:163], a[208:211], v[32:35]
    v_mfma_f32_16x16x32_bf16 v[48:51], v[184:187], a[208:211], v[48:51]
    v_and_b32 v12, 0xffff0000, v86
    v_lshlrev_b32 v13, 16, v86
    v_mul_f32 v12, s44, v12
    v_mul_f32 v13, s44, v13
    v_cvt_pk_bf16_f32 v14, v13, v12
    v_accvgpr_write_b32 a214, v14
    v_and_b32 v15, 0xffff0000, v87
    v_lshlrev_b32 v16, 16, v87
    v_mul_f32 v15, s44, v15
    v_mul_f32 v16, s44, v16
    v_cvt_pk_bf16_f32 v17, v16, v15
    v_accvgpr_write_b32 a215, v17
    s_nop 1
    v_mfma_f32_16x16x32_bf16 v[32:35], v[164:167], a[212:215], v[32:35]
    v_mfma_f32_16x16x32_bf16 v[48:51], v[188:191], a[212:215], v[48:51]
    s_nop 7
    s_nop 1
    v_max3_f32 v29, v32, v33, v34
    v_max3_f32 v29, v29, v35, v48
    v_max3_f32 v29, v29, v49, v50
    v_max_f32 v29, v29, v51
    v_mov_b32 v30, v29
    s_nop 1
    v_permlane16_swap_b32 v29, v30
    s_nop 1
    v_max_f32 v29, v29, v30
    v_mov_b32 v30, v29
    s_nop 1
    v_permlane32_swap_b32 v29, v30
    s_nop 1
    v_max_f32 v29, v29, v30
    v_sub_f32 v128, 0, v29
    v_sub_f32 v129, 0, v29
    v_sub_f32 v130, 0, v29
    v_sub_f32 v131, 0, v29
    v_sub_f32 v32, v32, v29
    v_sub_f32 v48, v48, v29
    v_sub_f32 v33, v33, v29
    v_sub_f32 v49, v49, v29
    v_sub_f32 v34, v34, v29
    v_sub_f32 v50, v50, v29
    v_sub_f32 v35, v35, v29
    v_sub_f32 v51, v51, v29
    v_exp_f32 v12, v32
    v_exp_f32 v13, v33
    v_exp_f32 v14, v34
    v_exp_f32 v15, v35
    v_exp_f32 v16, v48
    v_exp_f32 v17, v49
    v_exp_f32 v18, v50
    v_exp_f32 v19, v51
    s_nop 0
    v_add_f32 v8, v12, v13
    v_add_f32 v8, v8, v14
    v_add_f32 v8, v8, v15
    v_add_f32 v8, v8, v16
    v_add_f32 v8, v8, v17
    v_add_f32 v8, v8, v18
    v_add_f32 v8, v8, v19
    v_cvt_pk_bf16_f32 v96, v12, v13
    v_cvt_pk_bf16_f32 v97, v14, v15
    v_cvt_pk_bf16_f32 v98, v16, v17
    v_cvt_pk_bf16_f32 v99, v18, v19
    s_waitcnt vmcnt(6)
    ds_read_b128 v[88:91], v251 offset:6400
    ds_read_b128 v[92:95], v252 offset:6400
    ds_read_b128 v[192:195], v251 offset:6528
    ds_read_b128 v[196:199], v252 offset:6528
    ds_read_b128 v[200:203], v251 offset:6656
    ds_read_b128 v[204:207], v252 offset:6656
    s_waitcnt lgkmcnt(0)
    s_mov_b32 s40, 18432
    s_add_u32 m0, s38, 6400
    s_nop 0
    buffer_load_dwordx4 v248, s[20:23], s40 offen nt lds
    v_and_b32 v12, 0xffff0000, v88
    v_lshlrev_b32 v13, 16, v88
    v_mul_f32 v12, s44, v12
    v_mul_f32 v13, s44, v13
    v_cvt_pk_bf16_f32 v14, v13, v12
    v_accvgpr_write_b32 a216, v14
    v_and_b32 v15, 0xffff0000, v89
    v_lshlrev_b32 v16, 16, v89
    v_mul_f32 v15, s44, v15
    v_mul_f32 v16, s44, v16
    v_cvt_pk_bf16_f32 v17, v16, v15
    v_accvgpr_write_b32 a217, v17
    v_and_b32 v12, 0xffff0000, v90
    v_lshlrev_b32 v13, 16, v90
    v_mul_f32 v12, s44, v12
    v_mul_f32 v13, s44, v13
    v_cvt_pk_bf16_f32 v14, v13, v12
    v_accvgpr_write_b32 a218, v14
    v_and_b32 v15, 0xffff0000, v91
    v_lshlrev_b32 v16, 16, v91
    v_mul_f32 v15, s44, v15
    v_mul_f32 v16, s44, v16
    v_cvt_pk_bf16_f32 v17, v16, v15
    v_accvgpr_write_b32 a219, v17
    buffer_load_dwordx4 v249, s[20:23], s40 offen offset:1024 nt lds
    v_and_b32 v12, 0xffff0000, v92
    v_lshlrev_b32 v13, 16, v92
    v_mul_f32 v12, s44, v12
    v_mul_f32 v13, s44, v13
    v_cvt_pk_bf16_f32 v14, v13, v12
    v_accvgpr_write_b32 a220, v14
    v_and_b32 v15, 0xffff0000, v93
    v_lshlrev_b32 v16, 16, v93
    v_mul_f32 v15, s44, v15
    v_mul_f32 v16, s44, v16
    v_cvt_pk_bf16_f32 v17, v16, v15
    v_accvgpr_write_b32 a221, v17
    v_mfma_f32_16x16x32_bf16 v[36:39], v[144:147], a[216:219], 0
    v_mfma_f32_16x16x32_bf16 v[52:55], v[168:171], a[216:219], 0
    v_and_b32 v12, 0xffff0000, v94
    v_lshlrev_b32 v13, 16, v94
    v_mul_f32 v12, s44, v12
    v_mul_f32 v13, s44, v13
    v_cvt_pk_bf16_f32 v14, v13, v12
    v_accvgpr_write_b32 a222, v14
    v_and_b32 v15, 0xffff0000, v95
    v_lshlrev_b32 v16, 16, v95
    v_mul_f32 v15, s44, v15
    v_mul_f32 v16, s44, v16
    v_cvt_pk_bf16_f32 v17, v16, v15
    v_accvgpr_write_b32 a223, v17
    buffer_load_dwordx4 v250, s[20:23], s40 offen offset:2048 nt lds
    v_and_b32 v12, 0xffff0000, v192
    v_lshlrev_b32 v13, 16, v192
    v_mul_f32 v12, s44, v12
    v_mul_f32 v13, s44, v13
    v_cvt_pk_bf16_f32 v14, v13, v12
    v_accvgpr_write_b32 a224, v14
    v_and_b32 v15, 0xffff0000, v193
    v_lshlrev_b32 v16, 16, v193
    v_mul_f32 v15, s44, v15
    v_mul_f32 v16, s44, v16
    v_cvt_pk_bf16_f32 v17, v16, v15
    v_accvgpr_write_b32 a225, v17
    v_mfma_f32_16x16x32_bf16 v[36:39], v[148:151], a[220:223], v[36:39]
    v_mfma_f32_16x16x32_bf16 v[52:55], v[172:175], a[220:223], v[52:55]
    v_and_b32 v12, 0xffff0000, v194
    v_lshlrev_b32 v13, 16, v194
    v_mul_f32 v12, s44, v12
    v_mul_f32 v13, s44, v13
    v_cvt_pk_bf16_f32 v14, v13, v12
    v_accvgpr_write_b32 a226, v14
    v_and_b32 v15, 0xffff0000, v195
    v_lshlrev_b32 v16, 16, v195
    v_mul_f32 v15, s44, v15
    v_mul_f32 v16, s44, v16
    v_cvt_pk_bf16_f32 v17, v16, v15
    v_accvgpr_write_b32 a227, v17
    s_mov_b32 s40, 21504
    s_add_u32 m0, s38, 9472
    s_nop 0
    buffer_load_dwordx4 v248, s[20:23], s40 offen nt lds
    v_and_b32 v12, 0xffff0000, v196
    v_lshlrev_b32 v13, 16, v196
    v_mul_f32 v12, s44, v12
    v_mul_f32 v13, s44, v13
    v_cvt_pk_bf16_f32 v14, v13, v12
    v_accvgpr_write_b32 a228, v14
    v_and_b32 v15, 0xffff0000, v197
    v_lshlrev_b32 v16, 16, v197
    v_mul_f32 v15, s44, v15
    v_mul_f32 v16, s44, v16
    v_cvt_pk_bf16_f32 v17, v16, v15
    v_accvgpr_write_b32 a229, v17
    v_mfma_f32_16x16x32_bf16 v[36:39], v[152:155], a[224:227], v[36:39]
    v_mfma_f32_16x16x32_bf16 v[52:55], v[176:179], a[224:227], v[52:55]
    v_and_b32 v12, 0xffff0000, v198
    v_lshlrev_b32 v13, 16, v198
    v_mul_f32 v12, s44, v12
    v_mul_f32 v13, s44, v13
    v_cvt_pk_bf16_f32 v14, v13, v12
    v_accvgpr_write_b32 a230, v14
    v_and_b32 v15, 0xffff0000, v199
    v_lshlrev_b32 v16, 16, v199
    v_mul_f32 v15, s44, v15
    v_mul_f32 v16, s44, v16
    v_cvt_pk_bf16_f32 v17, v16, v15
    v_accvgpr_write_b32 a231, v17
    buffer_load_dwordx4 v249, s[20:23], s40 offen offset:1024 nt lds
    v_and_b32 v12, 0xffff0000, v200
    v_lshlrev_b32 v13, 16, v200
    v_mul_f32 v12, s44, v12
    v_mul_f32 v13, s44, v13
    v_cvt_pk_bf16_f32 v14, v13, v12
    v_accvgpr_write_b32 a232, v14
    v_and_b32 v15, 0xffff0000, v201
    v_lshlrev_b32 v16, 16, v201
    v_mul_f32 v15, s44, v15
    v_mul_f32 v16, s44, v16
    v_cvt_pk_bf16_f32 v17, v16, v15
    v_accvgpr_write_b32 a233, v17
    v_mfma_f32_16x16x32_bf16 v[36:39], v[156:159], a[228:231], v[36:39]
    v_mfma_f32_16x16x32_bf16 v[52:55], v[180:183], a[228:231], v[52:55]
    v_and_b32 v12, 0xffff0000, v202
    v_lshlrev_b32 v13, 16, v202
    v_mul_f32 v12, s44, v12
    v_mul_f32 v13, s44, v13
    v_cvt_pk_bf16_f32 v14, v13, v12
    v_accvgpr_write_b32 a234, v14
    v_and_b32 v15, 0xffff0000, v203
    v_lshlrev_b32 v16, 16, v203
    v_mul_f32 v15, s44, v15
    v_mul_f32 v16, s44, v16
    v_cvt_pk_bf16_f32 v17, v16, v15
    v_accvgpr_write_b32 a235, v17
    buffer_load_dwordx4 v250, s[20:23], s40 offen offset:2048 nt lds
    v_and_b32 v12, 0xffff0000, v204
    v_lshlrev_b32 v13, 16, v204
    v_mul_f32 v12, s44, v12
    v_mul_f32 v13, s44, v13
    v_cvt_pk_bf16_f32 v14, v13, v12
    v_accvgpr_write_b32 a236, v14
    v_and_b32 v15, 0xffff0000, v205
    v_lshlrev_b32 v16, 16, v205
    v_mul_f32 v15, s44, v15
    v_mul_f32 v16, s44, v16
    v_cvt_pk_bf16_f32 v17, v16, v15
    v_accvgpr_write_b32 a237, v17
    v_mfma_f32_16x16x32_bf16 v[36:39], v[160:163], a[232:235], v[36:39]
    v_mfma_f32_16x16x32_bf16 v[52:55], v[184:187], a[232:235], v[52:55]
    v_and_b32 v12, 0xffff0000, v206
    v_lshlrev_b32 v13, 16, v206
    v_mul_f32 v12, s44, v12
    v_mul_f32 v13, s44, v13
    v_cvt_pk_bf16_f32 v14, v13, v12
    v_accvgpr_write_b32 a238, v14
    v_and_b32 v15, 0xffff0000, v207
    v_lshlrev_b32 v16, 16, v207
    v_mul_f32 v15, s44, v15
    v_mul_f32 v16, s44, v16
    v_cvt_pk_bf16_f32 v17, v16, v15
    v_accvgpr_write_b32 a239, v17
    s_nop 1
    v_mfma_f32_16x16x32_bf16 v[36:39], v[164:167], a[236:239], v[36:39]
    v_mfma_f32_16x16x32_bf16 v[52:55], v[188:191], a[236:239], v[52:55]
    s_nop 7
    s_nop 1
    v_max3_f32 v29, v36, v37, v38
    v_max3_f32 v29, v29, v39, v52
    v_max3_f32 v29, v29, v53, v54
    v_max_f32 v29, v29, v55
    v_mov_b32 v30, v29
    s_nop 1
    v_permlane16_swap_b32 v29, v30
    s_nop 1
    v_max_f32 v29, v29, v30
    v_mov_b32 v30, v29
    s_nop 1
    v_permlane32_swap_b32 v29, v30
    s_nop 1
    v_max_f32 v29, v29, v30
    v_sub_f32 v132, 0, v29
    v_sub_f32 v133, 0, v29
    v_sub_f32 v134, 0, v29
    v_sub_f32 v135, 0, v29
    v_sub_f32 v36, v36, v29
    v_sub_f32 v52, v52, v29
    v_sub_f32 v37, v37, v29
    v_sub_f32 v53, v53, v29
    v_sub_f32 v38, v38, v29
    v_sub_f32 v54, v54, v29
    v_sub_f32 v39, v39, v29
    v_sub_f32 v55, v55, v29
    v_exp_f32 v12, v36
    v_exp_f32 v13, v37
    v_exp_f32 v14, v38
    v_exp_f32 v15, v39
    v_exp_f32 v16, v52
    v_exp_f32 v17, v53
    v_exp_f32 v18, v54
    v_exp_f32 v19, v55
    s_nop 0
    v_add_f32 v9, v12, v13
    v_add_f32 v9, v9, v14
    v_add_f32 v9, v9, v15
    v_add_f32 v9, v9, v16
    v_add_f32 v9, v9, v17
    v_add_f32 v9, v9, v18
    v_add_f32 v9, v9, v19
    v_cvt_pk_bf16_f32 v100, v12, v13
    v_cvt_pk_bf16_f32 v101, v14, v15
    v_cvt_pk_bf16_f32 v102, v16, v17
    v_cvt_pk_bf16_f32 v103, v18, v19
    s_waitcnt vmcnt(18)
    s_barrier
    s_waitcnt vmcnt(6)
    ds_read_b128 v[208:211], v251 offset:0
    ds_read_b128 v[212:215], v252 offset:0
    ds_read_b128 v[112:115], v251 offset:128
    ds_read_b128 v[116:119], v252 offset:128
    ds_read_b128 v[216:219], v251 offset:256
    ds_read_b128 v[220:223], v252 offset:256
    s_waitcnt lgkmcnt(0)
    s_mov_b32 s41, 0
    s_add_u32 m0, s36, 0
    s_nop 0
    buffer_load_dwordx4 v26, s[12:15], s41 offen lds
    buffer_load_dwordx4 v27, s[12:15], s41 offen offset:1024 lds
    buffer_load_dwordx4 v28, s[12:15], s41 offen offset:2048 lds
    v_and_b32 v12, 0xffff0000, v208
    v_lshlrev_b32 v13, 16, v208
    v_mul_f32 v12, s44, v12
    v_mul_f32 v13, s44, v13
    v_cvt_pk_bf16_f32 v14, v13, v12
    v_accvgpr_write_b32 a240, v14
    v_and_b32 v15, 0xffff0000, v209
    v_lshlrev_b32 v16, 16, v209
    v_mul_f32 v15, s44, v15
    v_mul_f32 v16, s44, v16
    v_cvt_pk_bf16_f32 v17, v16, v15
    v_accvgpr_write_b32 a241, v17
    v_and_b32 v12, 0xffff0000, v210
    v_lshlrev_b32 v13, 16, v210
    v_mul_f32 v12, s44, v12
    v_mul_f32 v13, s44, v13
    v_cvt_pk_bf16_f32 v14, v13, v12
    v_accvgpr_write_b32 a242, v14
    v_and_b32 v15, 0xffff0000, v211
    v_lshlrev_b32 v16, 16, v211
    v_mul_f32 v15, s44, v15
    v_mul_f32 v16, s44, v16
    v_cvt_pk_bf16_f32 v17, v16, v15
    v_accvgpr_write_b32 a243, v17
    v_and_b32 v12, 0xffff0000, v212
    v_lshlrev_b32 v13, 16, v212
    v_mul_f32 v12, s44, v12
    v_mul_f32 v13, s44, v13
    v_cvt_pk_bf16_f32 v14, v13, v12
    v_accvgpr_write_b32 a244, v14
    v_and_b32 v15, 0xffff0000, v213
    v_lshlrev_b32 v16, 16, v213
    v_mul_f32 v15, s44, v15
    v_mul_f32 v16, s44, v16
    v_cvt_pk_bf16_f32 v17, v16, v15
    v_accvgpr_write_b32 a245, v17
    v_mfma_f32_16x16x32_bf16 v[40:43], v[144:147], a[240:243], 0
    v_mfma_f32_16x16x32_bf16 v[56:59], v[168:171], a[240:243], 0
    v_and_b32 v12, 0xffff0000, v214
    v_lshlrev_b32 v13, 16, v214
    v_mul_f32 v12, s44, v12
    v_mul_f32 v13, s44, v13
    v_cvt_pk_bf16_f32 v14, v13, v12
    v_accvgpr_write_b32 a246, v14
    v_and_b32 v15, 0xffff0000, v215
    v_lshlrev_b32 v16, 16, v215
    v_mul_f32 v15, s44, v15
    v_mul_f32 v16, s44, v16
    v_cvt_pk_bf16_f32 v17, v16, v15
    v_accvgpr_write_b32 a247, v17
    s_mov_b32 s41, 24576
    s_add_u32 m0, s35, 24576
    s_nop 0
    buffer_load_dwordx4 v26, s[8:11], s41 offen lds
    buffer_load_dwordx4 v27, s[8:11], s41 offen offset:1024 lds
    buffer_load_dwordx4 v28, s[8:11], s41 offen offset:2048 lds
    v_and_b32 v12, 0xffff0000, v112
    v_lshlrev_b32 v13, 16, v112
    v_mul_f32 v12, s44, v12
    v_mul_f32 v13, s44, v13
    v_cvt_pk_bf16_f32 v14, v13, v12
    v_accvgpr_write_b32 a248, v14
    v_and_b32 v15, 0xffff0000, v113
    v_lshlrev_b32 v16, 16, v113
    v_mul_f32 v15, s44, v15
    v_mul_f32 v16, s44, v16
    v_cvt_pk_bf16_f32 v17, v16, v15
    v_accvgpr_write_b32 a249, v17
    v_mfma_f32_16x16x32_bf16 v[40:43], v[148:151], a[244:247], v[40:43]
    v_mfma_f32_16x16x32_bf16 v[56:59], v[172:175], a[244:247], v[56:59]
    v_and_b32 v12, 0xffff0000, v114
    v_lshlrev_b32 v13, 16, v114
    v_mul_f32 v12, s44, v12
    v_mul_f32 v13, s44, v13
    v_cvt_pk_bf16_f32 v14, v13, v12
    v_accvgpr_write_b32 a250, v14
    v_and_b32 v15, 0xffff0000, v115
    v_lshlrev_b32 v16, 16, v115
    v_mul_f32 v15, s44, v15
    v_mul_f32 v16, s44, v16
    v_cvt_pk_bf16_f32 v17, v16, v15
    v_accvgpr_write_b32 a251, v17
    v_and_b32 v12, 0xffff0000, v116
    v_lshlrev_b32 v13, 16, v116
    v_mul_f32 v12, s44, v12
    v_mul_f32 v13, s44, v13
    v_cvt_pk_bf16_f32 v14, v13, v12
    v_accvgpr_write_b32 a252, v14
    v_and_b32 v15, 0xffff0000, v117
    v_lshlrev_b32 v16, 16, v117
    v_mul_f32 v15, s44, v15
    v_mul_f32 v16, s44, v16
    v_cvt_pk_bf16_f32 v17, v16, v15
    v_accvgpr_write_b32 a253, v17
    v_mfma_f32_16x16x32_bf16 v[40:43], v[152:155], a[248:251], v[40:43]
    v_mfma_f32_16x16x32_bf16 v[56:59], v[176:179], a[248:251], v[56:59]
    v_and_b32 v12, 0xffff0000, v118
    v_lshlrev_b32 v13, 16, v118
    v_mul_f32 v12, s44, v12
    v_mul_f32 v13, s44, v13
    v_cvt_pk_bf16_f32 v14, v13, v12
    v_accvgpr_write_b32 a254, v14
    v_and_b32 v15, 0xffff0000, v119
    v_lshlrev_b32 v16, 16, v119
    v_mul_f32 v15, s44, v15
    v_mul_f32 v16, s44, v16
    v_cvt_pk_bf16_f32 v17, v16, v15
    v_accvgpr_write_b32 a255, v17
    s_mov_b32 s41, 12288
    s_add_u32 m0, s36, 12288
    s_nop 0
    buffer_load_dwordx4 v26, s[12:15], s41 offen lds
    buffer_load_dwordx4 v27, s[12:15], s41 offen offset:1024 lds
    buffer_load_dwordx4 v28, s[12:15], s41 offen offset:2048 lds
    v_and_b32 v12, 0xffff0000, v216
    v_lshlrev_b32 v13, 16, v216
    v_mul_f32 v12, s44, v12
    v_mul_f32 v13, s44, v13
    v_cvt_pk_bf16_f32 v216, v13, v12
    v_and_b32 v15, 0xffff0000, v217
    v_lshlrev_b32 v16, 16, v217
    v_mul_f32 v15, s44, v15
    v_mul_f32 v16, s44, v16
    v_cvt_pk_bf16_f32 v217, v16, v15
    v_mfma_f32_16x16x32_bf16 v[40:43], v[156:159], a[252:255], v[40:43]
    v_mfma_f32_16x16x32_bf16 v[56:59], v[180:183], a[252:255], v[56:59]
    v_and_b32 v12, 0xffff0000, v218
    v_lshlrev_b32 v13, 16, v218
    v_mul_f32 v12, s44, v12
    v_mul_f32 v13, s44, v13
    v_cvt_pk_bf16_f32 v218, v13, v12
    v_and_b32 v15, 0xffff0000, v219
    v_lshlrev_b32 v16, 16, v219
    v_mul_f32 v15, s44, v15
    v_mul_f32 v16, s44, v16
    v_cvt_pk_bf16_f32 v219, v16, v15
    v_and_b32 v12, 0xffff0000, v220
    v_lshlrev_b32 v13, 16, v220
    v_mul_f32 v12, s44, v12
    v_mul_f32 v13, s44, v13
    v_cvt_pk_bf16_f32 v220, v13, v12
    v_and_b32 v15, 0xffff0000, v221
    v_lshlrev_b32 v16, 16, v221
    v_mul_f32 v15, s44, v15
    v_mul_f32 v16, s44, v16
    v_cvt_pk_bf16_f32 v221, v16, v15
    v_mfma_f32_16x16x32_bf16 v[40:43], v[160:163], v[216:219], v[40:43]
    v_mfma_f32_16x16x32_bf16 v[56:59], v[184:187], v[216:219], v[56:59]
    v_and_b32 v12, 0xffff0000, v222
    v_lshlrev_b32 v13, 16, v222
    v_mul_f32 v12, s44, v12
    v_mul_f32 v13, s44, v13
    v_cvt_pk_bf16_f32 v222, v13, v12
    v_and_b32 v15, 0xffff0000, v223
    v_lshlrev_b32 v16, 16, v223
    v_mul_f32 v15, s44, v15
    v_mul_f32 v16, s44, v16
    v_cvt_pk_bf16_f32 v223, v16, v15
    s_nop 1
    v_mfma_f32_16x16x32_bf16 v[40:43], v[164:167], v[220:223], v[40:43]
    v_mfma_f32_16x16x32_bf16 v[56:59], v[188:191], v[220:223], v[56:59]
    s_nop 7
    s_nop 1
    v_max3_f32 v29, v40, v41, v42
    v_max3_f32 v29, v29, v43, v56
    v_max3_f32 v29, v29, v57, v58
    v_max_f32 v29, v29, v59
    v_mov_b32 v30, v29
    s_nop 1
    v_permlane16_swap_b32 v29, v30
    s_nop 1
    v_max_f32 v29, v29, v30
    v_mov_b32 v30, v29
    s_nop 1
    v_permlane32_swap_b32 v29, v30
    s_nop 1
    v_max_f32 v29, v29, v30
    v_sub_f32 v136, 0, v29
    v_sub_f32 v137, 0, v29
    v_sub_f32 v138, 0, v29
    v_sub_f32 v139, 0, v29
    v_sub_f32 v40, v40, v29
    v_sub_f32 v56, v56, v29
    v_sub_f32 v41, v41, v29
    v_sub_f32 v57, v57, v29
    v_sub_f32 v42, v42, v29
    v_sub_f32 v58, v58, v29
    v_sub_f32 v43, v43, v29
    v_sub_f32 v59, v59, v29
    s_waitcnt vmcnt(9)
    ds_read_b128 v[224:227], v251 offset:6400
    ds_read_b128 v[228:231], v252 offset:6400
    ds_read_b128 v[232:235], v251 offset:6528
    ds_read_b128 v[236:239], v252 offset:6528
    ds_read_b128 v[240:243], v251 offset:6656
    ds_read_b128 v[244:247], v252 offset:6656
    s_waitcnt lgkmcnt(0)
    v_and_b32 v12, 0xffff0000, v224
    v_lshlrev_b32 v13, 16, v224
    v_mul_f32 v12, s44, v12
    v_mul_f32 v13, s44, v13
    v_cvt_pk_bf16_f32 v224, v13, v12
    v_and_b32 v15, 0xffff0000, v225
    v_lshlrev_b32 v16, 16, v225
    v_mul_f32 v15, s44, v15
    v_mul_f32 v16, s44, v16
    v_cvt_pk_bf16_f32 v225, v16, v15
    v_and_b32 v12, 0xffff0000, v226
    v_lshlrev_b32 v13, 16, v226
    v_mul_f32 v12, s44, v12
    v_mul_f32 v13, s44, v13
    v_cvt_pk_bf16_f32 v226, v13, v12
    v_and_b32 v15, 0xffff0000, v227
    v_lshlrev_b32 v16, 16, v227
    v_mul_f32 v15, s44, v15
    v_mul_f32 v16, s44, v16
    v_cvt_pk_bf16_f32 v227, v16, v15
    s_mov_b32 s41, 36864
    s_add_u32 m0, s35, 36864
    s_nop 0
    buffer_load_dwordx4 v26, s[8:11], s41 offen lds
    buffer_load_dwordx4 v27, s[8:11], s41 offen offset:1024 lds
    buffer_load_dwordx4 v28, s[8:11], s41 offen offset:2048 lds
    v_and_b32 v12, 0xffff0000, v228
    v_lshlrev_b32 v13, 16, v228
    v_mul_f32 v12, s44, v12
    v_mul_f32 v13, s44, v13
    v_cvt_pk_bf16_f32 v228, v13, v12
    v_and_b32 v15, 0xffff0000, v229
    v_lshlrev_b32 v16, 16, v229
    v_mul_f32 v15, s44, v15
    v_mul_f32 v16, s44, v16
    v_cvt_pk_bf16_f32 v229, v16, v15
    v_mfma_f32_16x16x32_bf16 v[44:47], v[144:147], v[224:227], 0
    v_mfma_f32_16x16x32_bf16 v[60:63], v[168:171], v[224:227], 0
    v_and_b32 v12, 0xffff0000, v230
    v_lshlrev_b32 v13, 16, v230
    v_mul_f32 v12, s44, v12
    v_mul_f32 v13, s44, v13
    v_cvt_pk_bf16_f32 v230, v13, v12
    v_and_b32 v15, 0xffff0000, v231
    v_lshlrev_b32 v16, 16, v231
    v_mul_f32 v15, s44, v15
    v_mul_f32 v16, s44, v16
    v_cvt_pk_bf16_f32 v231, v16, v15
    v_and_b32 v12, 0xffff0000, v232
    v_lshlrev_b32 v13, 16, v232
    v_mul_f32 v12, s44, v12
    v_mul_f32 v13, s44, v13
    v_cvt_pk_bf16_f32 v232, v13, v12
    v_and_b32 v15, 0xffff0000, v233
    v_lshlrev_b32 v16, 16, v233
    v_mul_f32 v15, s44, v15
    v_mul_f32 v16, s44, v16
    v_cvt_pk_bf16_f32 v233, v16, v15
    v_mfma_f32_16x16x32_bf16 v[44:47], v[148:151], v[228:231], v[44:47]
    v_mfma_f32_16x16x32_bf16 v[60:63], v[172:175], v[228:231], v[60:63]
    v_and_b32 v12, 0xffff0000, v234
    v_lshlrev_b32 v13, 16, v234
    v_mul_f32 v12, s44, v12
    v_mul_f32 v13, s44, v13
    v_cvt_pk_bf16_f32 v234, v13, v12
    v_and_b32 v15, 0xffff0000, v235
    v_lshlrev_b32 v16, 16, v235
    v_mul_f32 v15, s44, v15
    v_mul_f32 v16, s44, v16
    v_cvt_pk_bf16_f32 v235, v16, v15
    s_mov_b32 s41, 24576
    s_add_u32 m0, s36, 24576
    s_nop 0
    buffer_load_dwordx4 v26, s[12:15], s41 offen lds
    buffer_load_dwordx4 v27, s[12:15], s41 offen offset:1024 lds
    buffer_load_dwordx4 v28, s[12:15], s41 offen offset:2048 lds
    v_and_b32 v12, 0xffff0000, v236
    v_lshlrev_b32 v13, 16, v236
    v_mul_f32 v12, s44, v12
    v_mul_f32 v13, s44, v13
    v_cvt_pk_bf16_f32 v236, v13, v12
    v_and_b32 v15, 0xffff0000, v237
    v_lshlrev_b32 v16, 16, v237
    v_mul_f32 v15, s44, v15
    v_mul_f32 v16, s44, v16
    v_cvt_pk_bf16_f32 v237, v16, v15
    v_mfma_f32_16x16x32_bf16 v[44:47], v[152:155], v[232:235], v[44:47]
    v_mfma_f32_16x16x32_bf16 v[60:63], v[176:179], v[232:235], v[60:63]
    v_and_b32 v12, 0xffff0000, v238
    v_lshlrev_b32 v13, 16, v238
    v_mul_f32 v12, s44, v12
    v_mul_f32 v13, s44, v13
    v_cvt_pk_bf16_f32 v238, v13, v12
    v_and_b32 v15, 0xffff0000, v239
    v_lshlrev_b32 v16, 16, v239
    v_mul_f32 v15, s44, v15
    v_mul_f32 v16, s44, v16
    v_cvt_pk_bf16_f32 v239, v16, v15
    v_and_b32 v12, 0xffff0000, v240
    v_lshlrev_b32 v13, 16, v240
    v_mul_f32 v12, s44, v12
    v_mul_f32 v13, s44, v13
    v_cvt_pk_bf16_f32 v240, v13, v12
    v_and_b32 v15, 0xffff0000, v241
    v_lshlrev_b32 v16, 16, v241
    v_mul_f32 v15, s44, v15
    v_mul_f32 v16, s44, v16
    v_cvt_pk_bf16_f32 v241, v16, v15
    v_mfma_f32_16x16x32_bf16 v[44:47], v[156:159], v[236:239], v[44:47]
    v_mfma_f32_16x16x32_bf16 v[60:63], v[180:183], v[236:239], v[60:63]
    v_and_b32 v12, 0xffff0000, v242
    v_lshlrev_b32 v13, 16, v242
    v_mul_f32 v12, s44, v12
    v_mul_f32 v13, s44, v13
    v_cvt_pk_bf16_f32 v242, v13, v12
    v_and_b32 v15, 0xffff0000, v243
    v_lshlrev_b32 v16, 16, v243
    v_mul_f32 v15, s44, v15
    v_mul_f32 v16, s44, v16
    v_cvt_pk_bf16_f32 v243, v16, v15
    v_and_b32 v12, 0xffff0000, v244
    v_lshlrev_b32 v13, 16, v244
    v_mul_f32 v12, s44, v12
    v_mul_f32 v13, s44, v13
    v_cvt_pk_bf16_f32 v244, v13, v12
    v_and_b32 v15, 0xffff0000, v245
    v_lshlrev_b32 v16, 16, v245
    v_mul_f32 v15, s44, v15
    v_mul_f32 v16, s44, v16
    v_cvt_pk_bf16_f32 v245, v16, v15
    v_mfma_f32_16x16x32_bf16 v[44:47], v[160:163], v[240:243], v[44:47]
    v_mfma_f32_16x16x32_bf16 v[60:63], v[184:187], v[240:243], v[60:63]
    v_and_b32 v12, 0xffff0000, v246
    v_lshlrev_b32 v13, 16, v246
    v_mul_f32 v12, s44, v12
    v_mul_f32 v13, s44, v13
    v_cvt_pk_bf16_f32 v246, v13, v12
    v_and_b32 v15, 0xffff0000, v247
    v_lshlrev_b32 v16, 16, v247
    v_mul_f32 v15, s44, v15
    v_mul_f32 v16, s44, v16
    v_cvt_pk_bf16_f32 v247, v16, v15
    s_nop 1
    v_mfma_f32_16x16x32_bf16 v[44:47], v[164:167], v[244:247], v[44:47]
    v_mfma_f32_16x16x32_bf16 v[60:63], v[188:191], v[244:247], v[60:63]
    ds_read_b128 v[144:147], v20 offset:12288
    ds_read_b128 v[148:151], v21 offset:12288
    ds_read_b128 v[152:155], v20 offset:12416
    ds_read_b128 v[156:159], v21 offset:12416
    ds_read_b128 v[160:163], v20 offset:12544
    ds_read_b128 v[164:167], v21 offset:12544
    s_nop 7
    s_nop 1
    v_max3_f32 v29, v44, v45, v46
    v_max3_f32 v29, v29, v47, v60
    v_max3_f32 v29, v29, v61, v62
    v_max_f32 v29, v29, v63
    v_mov_b32 v30, v29
    s_nop 1
    v_permlane16_swap_b32 v29, v30
    s_nop 1
    v_max_f32 v29, v29, v30
    v_mov_b32 v30, v29
    s_nop 1
    v_permlane32_swap_b32 v29, v30
    s_nop 1
    v_max_f32 v29, v29, v30
    v_sub_f32 v140, 0, v29
    v_sub_f32 v141, 0, v29
    v_sub_f32 v142, 0, v29
    v_sub_f32 v143, 0, v29
    v_sub_f32 v44, v44, v29
    v_sub_f32 v60, v60, v29
    v_sub_f32 v45, v45, v29
    v_sub_f32 v61, v61, v29
    v_sub_f32 v46, v46, v29
    v_sub_f32 v62, v62, v29
    v_sub_f32 v47, v47, v29
    v_sub_f32 v63, v63, v29
    s_waitcnt lgkmcnt(0)
    .p2align 6
Z_loop:
    v_mfma_f32_16x16x32_bf16 v[64:67], v[144:147], a[192:195], v[128:131]
    s_waitcnt vmcnt(9)
    ds_read_b128 v[168:171], v20 offset:18432
    v_mfma_f32_16x16x32_bf16 v[64:67], v[148:151], a[196:199], v[64:67]
    s_barrier
    v_exp_f32 v12, v40
    v_mfma_f32_16x16x32_bf16 v[64:67], v[152:155], a[200:203], v[64:67]
    s_add_u32 m0, s35, 0
    ds_read_b128 v[172:175], v21 offset:18432
    v_mfma_f32_16x16x32_bf16 v[64:67], v[156:159], a[204:207], v[64:67]
    v_exp_f32 v13, v41
    v_mfma_f32_16x16x32_bf16 v[64:67], v[160:163], a[208:211], v[64:67]
    buffer_load_dwordx4 v26, s[8:11], s25 offen lds
    ds_read_b128 v[176:179], v20 offset:18560
    v_mfma_f32_16x16x32_bf16 v[64:67], v[164:167], a[212:215], v[64:67]
    v_add_f32 v10, v12, v13
    v_cvt_pk_bf16_f32 v104, v12, v13
    v_mfma_f32_16x16x32_bf16 v[68:71], v[144:147], a[216:219], v[132:135]
    ds_read_b128 v[180:183], v21 offset:18560
    v_mfma_f32_16x16x32_bf16 v[68:71], v[148:151], a[220:223], v[68:71]
    v_exp_f32 v14, v42
    v_mfma_f32_16x16x32_bf16 v[68:71], v[152:155], a[224:227], v[68:71]
    buffer_load_dwordx4 v27, s[8:11], s25 offen offset:1024 lds
    ds_read_b128 v[184:187], v20 offset:18688
    v_mfma_f32_16x16x32_bf16 v[68:71], v[156:159], a[228:231], v[68:71]
    v_exp_f32 v15, v43
    v_mfma_f32_16x16x32_bf16 v[68:71], v[160:163], a[232:235], v[68:71]
    ds_read_b128 v[188:191], v21 offset:18688
    v_add_f32 v10, v10, v14
    v_mfma_f32_16x16x32_bf16 v[68:71], v[164:167], a[236:239], v[68:71]
    v_add_f32 v10, v10, v15
    v_cvt_pk_bf16_f32 v105, v14, v15
    v_mfma_f32_16x16x32_bf16 v[72:75], v[144:147], a[240:243], v[136:139]
    buffer_load_dwordx4 v28, s[8:11], s25 offen offset:2048 lds
    v_mfma_f32_16x16x32_bf16 v[72:75], v[148:151], a[244:247], v[72:75]
    v_exp_f32 v16, v56
    v_mfma_f32_16x16x32_bf16 v[72:75], v[152:155], a[248:251], v[72:75]
    s_add_u32 m0, s36, 36864
    v_exp_f32 v17, v57
    v_mfma_f32_16x16x32_bf16 v[72:75], v[156:159], a[252:255], v[72:75]
    v_add_f32 v10, v10, v16
    v_mfma_f32_16x16x32_bf16 v[72:75], v[160:163], v[216:219], v[72:75]
    buffer_load_dwordx4 v26, s[12:15], s26 offen lds
    v_add_f32 v10, v10, v17
    v_mfma_f32_16x16x32_bf16 v[72:75], v[164:167], v[220:223], v[72:75]
    v_cvt_pk_bf16_f32 v106, v16, v17
    v_mfma_f32_16x16x32_bf16 v[76:79], v[144:147], v[224:227], v[140:143]
    v_exp_f32 v18, v58
    v_mfma_f32_16x16x32_bf16 v[76:79], v[148:151], v[228:231], v[76:79]
    v_exp_f32 v19, v59
    v_mfma_f32_16x16x32_bf16 v[76:79], v[152:155], v[232:235], v[76:79]
    buffer_load_dwordx4 v27, s[12:15], s26 offen offset:1024 lds
    v_add_f32 v10, v10, v18
    v_mfma_f32_16x16x32_bf16 v[76:79], v[156:159], v[236:239], v[76:79]
    v_add_f32 v10, v10, v19
    v_cvt_pk_bf16_f32 v107, v18, v19
    v_mfma_f32_16x16x32_bf16 v[76:79], v[160:163], v[240:243], v[76:79]
    v_exp_f32 v12, v44
    v_mfma_f32_16x16x32_bf16 v[76:79], v[164:167], v[244:247], v[76:79]
    s_waitcnt lgkmcnt(0)
    v_exp_f32 v13, v45
    v_mfma_f32_16x16x32_bf16 v[80:83], v[168:171], a[192:195], v[128:131]
    ds_read_b64_tr_b16 v[192:193], v22 offset:0
    ds_read_b64_tr_b16 v[194:195], v22 offset:6144
    v_mfma_f32_16x16x32_bf16 v[80:83], v[172:175], a[196:199], v[80:83]
    v_add_f32 v11, v12, v13
    v_cvt_pk_bf16_f32 v108, v12, v13
    v_mfma_f32_16x16x32_bf16 v[80:83], v[176:179], a[200:203], v[80:83]
    buffer_load_dwordx4 v28, s[12:15], s26 offen offset:2048 lds
    v_mfma_f32_16x16x32_bf16 v[80:83], v[180:183], a[204:207], v[80:83]
    ds_read_b64_tr_b16 v[196:197], v23 offset:0
    ds_read_b64_tr_b16 v[198:199], v23 offset:6144
    v_mfma_f32_16x16x32_bf16 v[80:83], v[184:187], a[208:211], v[80:83]
    s_mov_b32 s26, s25
    v_exp_f32 v14, v46
    v_mfma_f32_16x16x32_bf16 v[80:83], v[188:191], a[212:215], v[80:83]
    s_add_u32 s25, s25, 12288
    v_exp_f32 v15, v47
    v_mfma_f32_16x16x32_bf16 v[84:87], v[168:171], a[216:219], v[132:135]
    s_min_u32 s25, s25, 774144
    ds_read_b64_tr_b16 v[200:201], v24 offset:0
    ds_read_b64_tr_b16 v[202:203], v24 offset:6144
    v_mfma_f32_16x16x32_bf16 v[84:87], v[172:175], a[220:223], v[84:87]
    v_add_f32 v11, v11, v14
    v_add_f32 v11, v11, v15
    v_mfma_f32_16x16x32_bf16 v[84:87], v[176:179], a[224:227], v[84:87]
    v_cvt_pk_bf16_f32 v109, v14, v15
    v_mfma_f32_16x16x32_bf16 v[84:87], v[180:183], a[228:231], v[84:87]
    ds_read_b64_tr_b16 v[204:205], v25 offset:0
    ds_read_b64_tr_b16 v[206:207], v25 offset:6144
    v_mfma_f32_16x16x32_bf16 v[84:87], v[184:187], a[232:235], v[84:87]
    v_exp_f32 v16, v60
    v_mfma_f32_16x16x32_bf16 v[84:87], v[188:191], a[236:239], v[84:87]
    v_exp_f32 v17, v61
    v_mfma_f32_16x16x32_bf16 v[88:91], v[168:171], a[240:243], v[136:139]
    ds_read_b64_tr_b16 v[208:209], v22 offset:128
    ds_read_b64_tr_b16 v[210:211], v22 offset:6272
    v_mfma_f32_16x16x32_bf16 v[88:91], v[172:175], a[244:247], v[88:91]
    v_add_f32 v11, v11, v16
    v_add_f32 v11, v11, v17
    v_mfma_f32_16x16x32_bf16 v[88:91], v[176:179], a[248:251], v[88:91]
    v_cvt_pk_bf16_f32 v110, v16, v17
    v_mfma_f32_16x16x32_bf16 v[88:91], v[180:183], a[252:255], v[88:91]
    ds_read_b64_tr_b16 v[212:213], v23 offset:128
    ds_read_b64_tr_b16 v[214:215], v23 offset:6272
    v_mfma_f32_16x16x32_bf16 v[88:91], v[184:187], v[216:219], v[88:91]
    v_exp_f32 v18, v62
    v_mfma_f32_16x16x32_bf16 v[88:91], v[188:191], v[220:223], v[88:91]
    v_exp_f32 v19, v63
    v_mfma_f32_16x16x32_bf16 v[92:95], v[168:171], v[224:227], v[140:143]
    v_add_f32 v11, v11, v18
    v_max3_f32 v29, v8, v9, v10
    v_mfma_f32_16x16x32_bf16 v[92:95], v[172:175], v[228:231], v[92:95]
    v_add_f32 v11, v11, v19
    v_cvt_pk_bf16_f32 v111, v18, v19
    v_mfma_f32_16x16x32_bf16 v[92:95], v[176:179], v[232:235], v[92:95]
    v_max_f32 v29, v29, v11
    v_cmp_nge_f32 vcc, s34, v29
    v_mfma_f32_16x16x32_bf16 v[92:95], v[180:183], v[236:239], v[92:95]
    v_mfma_f32_16x16x32_bf16 v[92:95], v[184:187], v[240:243], v[92:95]
    s_waitcnt lgkmcnt(0)
    v_mfma_f32_16x16x32_bf16 v[92:95], v[188:191], v[244:247], v[92:95]
    s_cbranch_vccnz Z_call0
Z_ret0:
    v_mfma_f32_16x16x32_bf16 a[0:3], v[192:195], v[96:99], a[0:3]
    v_add_f32 v4, v4, v8
    v_add_f32 v5, v5, v9
    v_mfma_f32_16x16x32_bf16 a[48:51], v[192:195], v[100:103], a[48:51]
    v_add_f32 v6, v6, v10
    v_add_f32 v7, v7, v11
    v_mfma_f32_16x16x32_bf16 a[96:99], v[192:195], v[104:107], a[96:99]
    v_exp_f32 v12, v64
    v_mfma_f32_16x16x32_bf16 a[144:147], v[192:195], v[108:111], a[144:147]
    v_exp_f32 v13, v65
    v_mfma_f32_16x16x32_bf16 a[4:7], v[196:199], v[96:99], a[4:7]
    ds_read_b64_tr_b16 v[192:193], v24 offset:128
    ds_read_b64_tr_b16 v[194:195], v24 offset:6272
    v_mfma_f32_16x16x32_bf16 a[52:55], v[196:199], v[100:103], a[52:55]
    v_add_f32 v8, v12, v13
    v_cvt_pk_bf16_f32 v112, v12, v13
    v_mfma_f32_16x16x32_bf16 a[100:103], v[196:199], v[104:107], a[100:103]
    v_exp_f32 v14, v66
    v_mfma_f32_16x16x32_bf16 a[148:151], v[196:199], v[108:111], a[148:151]
    v_exp_f32 v15, v67
    v_mfma_f32_16x16x32_bf16 a[8:11], v[200:203], v[96:99], a[8:11]
    ds_read_b64_tr_b16 v[196:197], v25 offset:128
    ds_read_b64_tr_b16 v[198:199], v25 offset:6272
    v_mfma_f32_16x16x32_bf16 a[56:59], v[200:203], v[100:103], a[56:59]
    v_add_f32 v8, v8, v14
    v_add_f32 v8, v8, v15
    v_mfma_f32_16x16x32_bf16 a[104:107], v[200:203], v[104:107], a[104:107]
    v_cvt_pk_bf16_f32 v113, v14, v15
    v_mfma_f32_16x16x32_bf16 a[152:155], v[200:203], v[108:111], a[152:155]
    v_exp_f32 v16, v80
    v_mfma_f32_16x16x32_bf16 a[12:15], v[204:207], v[96:99], a[12:15]
    ds_read_b64_tr_b16 v[200:201], v22 offset:256
    ds_read_b64_tr_b16 v[202:203], v22 offset:6400
    v_mfma_f32_16x16x32_bf16 a[60:63], v[204:207], v[100:103], a[60:63]
    v_exp_f32 v17, v81
    v_mfma_f32_16x16x32_bf16 a[108:111], v[204:207], v[104:107], a[108:111]
    v_add_f32 v8, v8, v16
    v_mfma_f32_16x16x32_bf16 a[156:159], v[204:207], v[108:111], a[156:159]
    v_add_f32 v8, v8, v17
    v_cvt_pk_bf16_f32 v114, v16, v17
    v_mfma_f32_16x16x32_bf16 a[16:19], v[208:211], v[96:99], a[16:19]
    ds_read_b64_tr_b16 v[204:205], v23 offset:256
    ds_read_b64_tr_b16 v[206:207], v23 offset:6400
    v_mfma_f32_16x16x32_bf16 a[64:67], v[208:211], v[100:103], a[64:67]
    v_exp_f32 v18, v82
    v_mfma_f32_16x16x32_bf16 a[112:115], v[208:211], v[104:107], a[112:115]
    v_exp_f32 v19, v83
    v_mfma_f32_16x16x32_bf16 a[160:163], v[208:211], v[108:111], a[160:163]
    v_add_f32 v8, v8, v18
    v_mfma_f32_16x16x32_bf16 a[20:23], v[212:215], v[96:99], a[20:23]
    ds_read_b64_tr_b16 v[208:209], v24 offset:256
    ds_read_b64_tr_b16 v[210:211], v24 offset:6400
    v_mfma_f32_16x16x32_bf16 a[68:71], v[212:215], v[100:103], a[68:71]
    v_add_f32 v8, v8, v19
    v_cvt_pk_bf16_f32 v115, v18, v19
    v_mfma_f32_16x16x32_bf16 a[116:119], v[212:215], v[104:107], a[116:119]
    v_exp_f32 v12, v68
    v_mfma_f32_16x16x32_bf16 a[164:167], v[212:215], v[108:111], a[164:167]
    s_waitcnt lgkmcnt(4)
    v_exp_f32 v13, v69
    v_mfma_f32_16x16x32_bf16 a[24:27], v[192:195], v[96:99], a[24:27]
    ds_read_b64_tr_b16 v[212:213], v25 offset:256
    ds_read_b64_tr_b16 v[214:215], v25 offset:6400
    v_mfma_f32_16x16x32_bf16 a[72:75], v[192:195], v[100:103], a[72:75]
    v_add_f32 v9, v12, v13
    v_cvt_pk_bf16_f32 v116, v12, v13
    v_mfma_f32_16x16x32_bf16 a[120:123], v[192:195], v[104:107], a[120:123]
    ds_read_b128 v[144:147], v20 offset:24576
    v_mfma_f32_16x16x32_bf16 a[168:171], v[192:195], v[108:111], a[168:171]
    v_exp_f32 v14, v70
    v_mfma_f32_16x16x32_bf16 a[28:31], v[196:199], v[96:99], a[28:31]
    ds_read_b128 v[148:151], v21 offset:24576
    v_mfma_f32_16x16x32_bf16 a[76:79], v[196:199], v[100:103], a[76:79]
    v_exp_f32 v15, v71
    v_mfma_f32_16x16x32_bf16 a[124:127], v[196:199], v[104:107], a[124:127]
    ds_read_b128 v[152:155], v20 offset:24704
    v_add_f32 v9, v9, v14
    v_mfma_f32_16x16x32_bf16 a[172:175], v[196:199], v[108:111], a[172:175]
    v_add_f32 v9, v9, v15
    v_cvt_pk_bf16_f32 v117, v14, v15
    v_mfma_f32_16x16x32_bf16 a[32:35], v[200:203], v[96:99], a[32:35]
    ds_read_b128 v[156:159], v21 offset:24704
    v_mfma_f32_16x16x32_bf16 a[80:83], v[200:203], v[100:103], a[80:83]
    v_exp_f32 v16, v84
    v_mfma_f32_16x16x32_bf16 a[128:131], v[200:203], v[104:107], a[128:131]
    ds_read_b128 v[160:163], v20 offset:24832
    v_mfma_f32_16x16x32_bf16 a[176:179], v[200:203], v[108:111], a[176:179]
    s_waitcnt lgkmcnt(5)
    v_exp_f32 v17, v85
    v_mfma_f32_16x16x32_bf16 a[36:39], v[204:207], v[96:99], a[36:39]
    ds_read_b128 v[164:167], v21 offset:24832
    v_add_f32 v9, v9, v16
    v_mfma_f32_16x16x32_bf16 a[84:87], v[204:207], v[100:103], a[84:87]
    v_add_f32 v9, v9, v17
    v_cvt_pk_bf16_f32 v118, v16, v17
    v_mfma_f32_16x16x32_bf16 a[132:135], v[204:207], v[104:107], a[132:135]
    v_exp_f32 v18, v86
    v_mfma_f32_16x16x32_bf16 a[180:183], v[204:207], v[108:111], a[180:183]
    v_exp_f32 v19, v87
    v_mfma_f32_16x16x32_bf16 a[40:43], v[208:211], v[96:99], a[40:43]
    v_add_f32 v9, v9, v18
    v_mfma_f32_16x16x32_bf16 a[88:91], v[208:211], v[100:103], a[88:91]
    v_add_f32 v9, v9, v19
    v_mfma_f32_16x16x32_bf16 a[136:139], v[208:211], v[104:107], a[136:139]
    v_cvt_pk_bf16_f32 v119, v18, v19
    v_mfma_f32_16x16x32_bf16 a[184:187], v[208:211], v[108:111], a[184:187]
    v_mfma_f32_16x16x32_bf16 a[44:47], v[212:215], v[96:99], a[44:47]
    v_mfma_f32_16x16x32_bf16 a[92:95], v[212:215], v[100:103], a[92:95]
    v_mfma_f32_16x16x32_bf16 a[140:143], v[212:215], v[104:107], a[140:143]
    s_waitcnt lgkmcnt(0)
    v_mfma_f32_16x16x32_bf16 a[188:191], v[212:215], v[108:111], a[188:191]
    v_mfma_f32_16x16x32_bf16 v[32:35], v[144:147], a[192:195], v[128:131]
    s_waitcnt vmcnt(9)
    ds_read_b128 v[168:171], v20 offset:30720
    v_mfma_f32_16x16x32_bf16 v[32:35], v[148:151], a[196:199], v[32:35]
    s_barrier
    v_exp_f32 v12, v72
    v_mfma_f32_16x16x32_bf16 v[32:35], v[152:155], a[200:203], v[32:35]
    s_add_u32 m0, s35, 12288
    ds_read_b128 v[172:175], v21 offset:30720
    v_mfma_f32_16x16x32_bf16 v[32:35], v[156:159], a[204:207], v[32:35]
    v_exp_f32 v13, v73
    v_mfma_f32_16x16x32_bf16 v[32:35], v[160:163], a[208:211], v[32:35]
    buffer_load_dwordx4 v26, s[8:11], s25 offen lds
    ds_read_b128 v[176:179], v20 offset:30848
    v_mfma_f32_16x16x32_bf16 v[32:35], v[164:167], a[212:215], v[32:35]
    v_add_f32 v10, v12, v13
    v_cvt_pk_bf16_f32 v120, v12, v13
    v_mfma_f32_16x16x32_bf16 v[36:39], v[144:147], a[216:219], v[132:135]
    ds_read_b128 v[180:183], v21 offset:30848
    v_mfma_f32_16x16x32_bf16 v[36:39], v[148:151], a[220:223], v[36:39]
    v_exp_f32 v14, v74
    v_mfma_f32_16x16x32_bf16 v[36:39], v[152:155], a[224:227], v[36:39]
    buffer_load_dwordx4 v27, s[8:11], s25 offen offset:1024 lds
    ds_read_b128 v[184:187], v20 offset:30976
    v_mfma_f32_16x16x32_bf16 v[36:39], v[156:159], a[228:231], v[36:39]
    v_exp_f32 v15, v75
    v_mfma_f32_16x16x32_bf16 v[36:39], v[160:163], a[232:235], v[36:39]
    ds_read_b128 v[188:191], v21 offset:30976
    v_add_f32 v10, v10, v14
    v_mfma_f32_16x16x32_bf16 v[36:39], v[164:167], a[236:239], v[36:39]
    v_add_f32 v10, v10, v15
    v_cvt_pk_bf16_f32 v121, v14, v15
    v_mfma_f32_16x16x32_bf16 v[40:43], v[144:147], a[240:243], v[136:139]
    buffer_load_dwordx4 v28, s[8:11], s25 offen offset:2048 lds
    v_mfma_f32_16x16x32_bf16 v[40:43], v[148:151], a[244:247], v[40:43]
    v_exp_f32 v16, v88
    v_mfma_f32_16x16x32_bf16 v[40:43], v[152:155], a[248:251], v[40:43]
    s_add_u32 m0, s36, 0
    v_exp_f32 v17, v89
    v_mfma_f32_16x16x32_bf16 v[40:43], v[156:159], a[252:255], v[40:43]
    v_add_f32 v10, v10, v16
    v_mfma_f32_16x16x32_bf16 v[40:43], v[160:163], v[216:219], v[40:43]
    buffer_load_dwordx4 v26, s[12:15], s26 offen lds
    v_add_f32 v10, v10, v17
    v_mfma_f32_16x16x32_bf16 v[40:43], v[164:167], v[220:223], v[40:43]
    v_cvt_pk_bf16_f32 v122, v16, v17
    v_mfma_f32_16x16x32_bf16 v[44:47], v[144:147], v[224:227], v[140:143]
    v_exp_f32 v18, v90
    v_mfma_f32_16x16x32_bf16 v[44:47], v[148:151], v[228:231], v[44:47]
    v_exp_f32 v19, v91
    v_mfma_f32_16x16x32_bf16 v[44:47], v[152:155], v[232:235], v[44:47]
    buffer_load_dwordx4 v27, s[12:15], s26 offen offset:1024 lds
    v_add_f32 v10, v10, v18
    v_mfma_f32_16x16x32_bf16 v[44:47], v[156:159], v[236:239], v[44:47]
    v_add_f32 v10, v10, v19
    v_cvt_pk_bf16_f32 v123, v18, v19
    v_mfma_f32_16x16x32_bf16 v[44:47], v[160:163], v[240:243], v[44:47]
    v_exp_f32 v12, v76
    v_mfma_f32_16x16x32_bf16 v[44:47], v[164:167], v[244:247], v[44:47]
    s_waitcnt lgkmcnt(0)
    v_exp_f32 v13, v77
    v_mfma_f32_16x16x32_bf16 v[48:51], v[168:171], a[192:195], v[128:131]
    ds_read_b64_tr_b16 v[192:193], v22 offset:12288
    ds_read_b64_tr_b16 v[194:195], v22 offset:18432
    v_mfma_f32_16x16x32_bf16 v[48:51], v[172:175], a[196:199], v[48:51]
    v_add_f32 v11, v12, v13
    v_cvt_pk_bf16_f32 v124, v12, v13
    v_mfma_f32_16x16x32_bf16 v[48:51], v[176:179], a[200:203], v[48:51]
    buffer_load_dwordx4 v28, s[12:15], s26 offen offset:2048 lds
    v_mfma_f32_16x16x32_bf16 v[48:51], v[180:183], a[204:207], v[48:51]
    ds_read_b64_tr_b16 v[196:197], v23 offset:12288
    ds_read_b64_tr_b16 v[198:199], v23 offset:18432
    v_mfma_f32_16x16x32_bf16 v[48:51], v[184:187], a[208:211], v[48:51]
    s_mov_b32 s26, s25
    v_exp_f32 v14, v78
    v_mfma_f32_16x16x32_bf16 v[48:51], v[188:191], a[212:215], v[48:51]
    s_add_u32 s25, s25, 12288
    v_exp_f32 v15, v79
    v_mfma_f32_16x16x32_bf16 v[52:55], v[168:171], a[216:219], v[132:135]
    s_min_u32 s25, s25, 774144
    ds_read_b64_tr_b16 v[200:201], v24 offset:12288
    ds_read_b64_tr_b16 v[202:203], v24 offset:18432
    v_mfma_f32_16x16x32_bf16 v[52:55], v[172:175], a[220:223], v[52:55]
    v_add_f32 v11, v11, v14
    v_add_f32 v11, v11, v15
    v_mfma_f32_16x16x32_bf16 v[52:55], v[176:179], a[224:227], v[52:55]
    v_cvt_pk_bf16_f32 v125, v14, v15
    v_mfma_f32_16x16x32_bf16 v[52:55], v[180:183], a[228:231], v[52:55]
    ds_read_b64_tr_b16 v[204:205], v25 offset:12288
    ds_read_b64_tr_b16 v[206:207], v25 offset:18432
    v_mfma_f32_16x16x32_bf16 v[52:55], v[184:187], a[232:235], v[52:55]
    v_exp_f32 v16, v92
    v_mfma_f32_16x16x32_bf16 v[52:55], v[188:191], a[236:239], v[52:55]
    v_exp_f32 v17, v93
    v_mfma_f32_16x16x32_bf16 v[56:59], v[168:171], a[240:243], v[136:139]
    ds_read_b64_tr_b16 v[208:209], v22 offset:12416
    ds_read_b64_tr_b16 v[210:211], v22 offset:18560
    v_mfma_f32_16x16x32_bf16 v[56:59], v[172:175], a[244:247], v[56:59]
    v_add_f32 v11, v11, v16
    v_add_f32 v11, v11, v17
    v_mfma_f32_16x16x32_bf16 v[56:59], v[176:179], a[248:251], v[56:59]
    v_cvt_pk_bf16_f32 v126, v16, v17
    v_mfma_f32_16x16x32_bf16 v[56:59], v[180:183], a[252:255], v[56:59]
    ds_read_b64_tr_b16 v[212:213], v23 offset:12416
    ds_read_b64_tr_b16 v[214:215], v23 offset:18560
    v_mfma_f32_16x16x32_bf16 v[56:59], v[184:187], v[216:219], v[56:59]
    v_exp_f32 v18, v94
    v_mfma_f32_16x16x32_bf16 v[56:59], v[188:191], v[220:223], v[56:59]
    v_exp_f32 v19, v95
    v_mfma_f32_16x16x32_bf16 v[60:63], v[168:171], v[224:227], v[140:143]
    v_add_f32 v11, v11, v18
    v_max3_f32 v29, v8, v9, v10
    v_mfma_f32_16x16x32_bf16 v[60:63], v[172:175], v[228:231], v[60:63]
    v_add_f32 v11, v11, v19
    v_cvt_pk_bf16_f32 v127, v18, v19
    v_mfma_f32_16x16x32_bf16 v[60:63], v[176:179], v[232:235], v[60:63]
    v_max_f32 v29, v29, v11
    v_cmp_nge_f32 vcc, s34, v29
    v_mfma_f32_16x16x32_bf16 v[60:63], v[180:183], v[236:239], v[60:63]
    v_mfma_f32_16x16x32_bf16 v[60:63], v[184:187], v[240:243], v[60:63]
    s_waitcnt lgkmcnt(0)
    v_mfma_f32_16x16x32_bf16 v[60:63], v[188:191], v[244:247], v[60:63]
    s_cbranch_vccnz Z_call1
Z_ret1:
    v_mfma_f32_16x16x32_bf16 a[0:3], v[192:195], v[112:115], a[0:3]
    v_add_f32 v4, v4, v8
    v_add_f32 v5, v5, v9
    v_mfma_f32_16x16x32_bf16 a[48:51], v[192:195], v[116:119], a[48:51]
    v_add_f32 v6, v6, v10
    v_add_f32 v7, v7, v11
    v_mfma_f32_16x16x32_bf16 a[96:99], v[192:195], v[120:123], a[96:99]
    v_exp_f32 v12, v32
    v_mfma_f32_16x16x32_bf16 a[144:147], v[192:195], v[124:127], a[144:147]
    v_exp_f32 v13, v33
    v_mfma_f32_16x16x32_bf16 a[4:7], v[196:199], v[112:115], a[4:7]
    ds_read_b64_tr_b16 v[192:193], v24 offset:12416
    ds_read_b64_tr_b16 v[194:195], v24 offset:18560
    v_mfma_f32_16x16x32_bf16 a[52:55], v[196:199], v[116:119], a[52:55]
    v_add_f32 v8, v12, v13
    v_cvt_pk_bf16_f32 v96, v12, v13
    v_mfma_f32_16x16x32_bf16 a[100:103], v[196:199], v[120:123], a[100:103]
    v_exp_f32 v14, v34
    v_mfma_f32_16x16x32_bf16 a[148:151], v[196:199], v[124:127], a[148:151]
    v_exp_f32 v15, v35
    v_mfma_f32_16x16x32_bf16 a[8:11], v[200:203], v[112:115], a[8:11]
    ds_read_b64_tr_b16 v[196:197], v25 offset:12416
    ds_read_b64_tr_b16 v[198:199], v25 offset:18560
    v_mfma_f32_16x16x32_bf16 a[56:59], v[200:203], v[116:119], a[56:59]
    v_add_f32 v8, v8, v14
    v_add_f32 v8, v8, v15
    v_mfma_f32_16x16x32_bf16 a[104:107], v[200:203], v[120:123], a[104:107]
    v_cvt_pk_bf16_f32 v97, v14, v15
    v_mfma_f32_16x16x32_bf16 a[152:155], v[200:203], v[124:127], a[152:155]
    v_exp_f32 v16, v48
    v_mfma_f32_16x16x32_bf16 a[12:15], v[204:207], v[112:115], a[12:15]
    ds_read_b64_tr_b16 v[200:201], v22 offset:12544
    ds_read_b64_tr_b16 v[202:203], v22 offset:18688
    v_mfma_f32_16x16x32_bf16 a[60:63], v[204:207], v[116:119], a[60:63]
    v_exp_f32 v17, v49
    v_mfma_f32_16x16x32_bf16 a[108:111], v[204:207], v[120:123], a[108:111]
    v_add_f32 v8, v8, v16
    v_mfma_f32_16x16x32_bf16 a[156:159], v[204:207], v[124:127], a[156:159]
    v_add_f32 v8, v8, v17
    v_cvt_pk_bf16_f32 v98, v16, v17
    v_mfma_f32_16x16x32_bf16 a[16:19], v[208:211], v[112:115], a[16:19]
    ds_read_b64_tr_b16 v[204:205], v23 offset:12544
    ds_read_b64_tr_b16 v[206:207], v23 offset:18688
    v_mfma_f32_16x16x32_bf16 a[64:67], v[208:211], v[116:119], a[64:67]
    v_exp_f32 v18, v50
    v_mfma_f32_16x16x32_bf16 a[112:115], v[208:211], v[120:123], a[112:115]
    v_exp_f32 v19, v51
    v_mfma_f32_16x16x32_bf16 a[160:163], v[208:211], v[124:127], a[160:163]
    v_add_f32 v8, v8, v18
    v_mfma_f32_16x16x32_bf16 a[20:23], v[212:215], v[112:115], a[20:23]
    ds_read_b64_tr_b16 v[208:209], v24 offset:12544
    ds_read_b64_tr_b16 v[210:211], v24 offset:18688
    v_mfma_f32_16x16x32_bf16 a[68:71], v[212:215], v[116:119], a[68:71]
    v_add_f32 v8, v8, v19
    v_cvt_pk_bf16_f32 v99, v18, v19
    v_mfma_f32_16x16x32_bf16 a[116:119], v[212:215], v[120:123], a[116:119]
    v_exp_f32 v12, v36
    v_mfma_f32_16x16x32_bf16 a[164:167], v[212:215], v[124:127], a[164:167]
    s_waitcnt lgkmcnt(4)
    v_exp_f32 v13, v37
    v_mfma_f32_16x16x32_bf16 a[24:27], v[192:195], v[112:115], a[24:27]
    ds_read_b64_tr_b16 v[212:213], v25 offset:12544
    ds_read_b64_tr_b16 v[214:215], v25 offset:18688
    v_mfma_f32_16x16x32_bf16 a[72:75], v[192:195], v[116:119], a[72:75]
    v_add_f32 v9, v12, v13
    v_cvt_pk_bf16_f32 v100, v12, v13
    v_mfma_f32_16x16x32_bf16 a[120:123], v[192:195], v[120:123], a[120:123]
    ds_read_b128 v[144:147], v20 offset:36864
    v_mfma_f32_16x16x32_bf16 a[168:171], v[192:195], v[124:127], a[168:171]
    v_exp_f32 v14, v38
    v_mfma_f32_16x16x32_bf16 a[28:31], v[196:199], v[112:115], a[28:31]
    ds_read_b128 v[148:151], v21 offset:36864
    v_mfma_f32_16x16x32_bf16 a[76:79], v[196:199], v[116:119], a[76:79]
    v_exp_f32 v15, v39
    v_mfma_f32_16x16x32_bf16 a[124:127], v[196:199], v[120:123], a[124:127]
    ds_read_b128 v[152:155], v20 offset:36992
    v_add_f32 v9, v9, v14
    v_mfma_f32_16x16x32_bf16 a[172:175], v[196:199], v[124:127], a[172:175]
    v_add_f32 v9, v9, v15
    v_cvt_pk_bf16_f32 v101, v14, v15
    v_mfma_f32_16x16x32_bf16 a[32:35], v[200:203], v[112:115], a[32:35]
    ds_read_b128 v[156:159], v21 offset:36992
    v_mfma_f32_16x16x32_bf16 a[80:83], v[200:203], v[116:119], a[80:83]
    v_exp_f32 v16, v52
    v_mfma_f32_16x16x32_bf16 a[128:131], v[200:203], v[120:123], a[128:131]
    ds_read_b128 v[160:163], v20 offset:37120
    v_mfma_f32_16x16x32_bf16 a[176:179], v[200:203], v[124:127], a[176:179]
    s_waitcnt lgkmcnt(5)
    v_exp_f32 v17, v53
    v_mfma_f32_16x16x32_bf16 a[36:39], v[204:207], v[112:115], a[36:39]
    ds_read_b128 v[164:167], v21 offset:37120
    v_add_f32 v9, v9, v16
    v_mfma_f32_16x16x32_bf16 a[84:87], v[204:207], v[116:119], a[84:87]
    v_add_f32 v9, v9, v17
    v_cvt_pk_bf16_f32 v102, v16, v17
    v_mfma_f32_16x16x32_bf16 a[132:135], v[204:207], v[120:123], a[132:135]
    v_exp_f32 v18, v54
    v_mfma_f32_16x16x32_bf16 a[180:183], v[204:207], v[124:127], a[180:183]
    v_exp_f32 v19, v55
    v_mfma_f32_16x16x32_bf16 a[40:43], v[208:211], v[112:115], a[40:43]
    v_add_f32 v9, v9, v18
    v_mfma_f32_16x16x32_bf16 a[88:91], v[208:211], v[116:119], a[88:91]
    v_add_f32 v9, v9, v19
    v_mfma_f32_16x16x32_bf16 a[136:139], v[208:211], v[120:123], a[136:139]
    v_cvt_pk_bf16_f32 v103, v18, v19
    v_mfma_f32_16x16x32_bf16 a[184:187], v[208:211], v[124:127], a[184:187]
    v_mfma_f32_16x16x32_bf16 a[44:47], v[212:215], v[112:115], a[44:47]
    v_mfma_f32_16x16x32_bf16 a[92:95], v[212:215], v[116:119], a[92:95]
    v_mfma_f32_16x16x32_bf16 a[140:143], v[212:215], v[120:123], a[140:143]
    s_waitcnt lgkmcnt(0)
    v_mfma_f32_16x16x32_bf16 a[188:191], v[212:215], v[124:127], a[188:191]
    v_mfma_f32_16x16x32_bf16 v[64:67], v[144:147], a[192:195], v[128:131]
    s_waitcnt vmcnt(9)
    ds_read_b128 v[168:171], v20 offset:43008
    v_mfma_f32_16x16x32_bf16 v[64:67], v[148:151], a[196:199], v[64:67]
    s_barrier
    v_exp_f32 v12, v40
    v_mfma_f32_16x16x32_bf16 v[64:67], v[152:155], a[200:203], v[64:67]
    s_add_u32 m0, s35, 24576
    ds_read_b128 v[172:175], v21 offset:43008
    v_mfma_f32_16x16x32_bf16 v[64:67], v[156:159], a[204:207], v[64:67]
    v_exp_f32 v13, v41
    v_mfma_f32_16x16x32_bf16 v[64:67], v[160:163], a[208:211], v[64:67]
    buffer_load_dwordx4 v26, s[8:11], s25 offen lds
    ds_read_b128 v[176:179], v20 offset:43136
    v_mfma_f32_16x16x32_bf16 v[64:67], v[164:167], a[212:215], v[64:67]
    v_add_f32 v10, v12, v13
    v_cvt_pk_bf16_f32 v104, v12, v13
    v_mfma_f32_16x16x32_bf16 v[68:71], v[144:147], a[216:219], v[132:135]
    ds_read_b128 v[180:183], v21 offset:43136
    v_mfma_f32_16x16x32_bf16 v[68:71], v[148:151], a[220:223], v[68:71]
    v_exp_f32 v14, v42
    v_mfma_f32_16x16x32_bf16 v[68:71], v[152:155], a[224:227], v[68:71]
    buffer_load_dwordx4 v27, s[8:11], s25 offen offset:1024 lds
    ds_read_b128 v[184:187], v20 offset:43264
    v_mfma_f32_16x16x32_bf16 v[68:71], v[156:159], a[228:231], v[68:71]
    v_exp_f32 v15, v43
    v_mfma_f32_16x16x32_bf16 v[68:71], v[160:163], a[232:235], v[68:71]
    ds_read_b128 v[188:191], v21 offset:43264
    v_add_f32 v10, v10, v14
    v_mfma_f32_16x16x32_bf16 v[68:71], v[164:167], a[236:239], v[68:71]
    v_add_f32 v10, v10, v15
    v_cvt_pk_bf16_f32 v105, v14, v15
    v_mfma_f32_16x16x32_bf16 v[72:75], v[144:147], a[240:243], v[136:139]
    buffer_load_dwordx4 v28, s[8:11], s25 offen offset:2048 lds
    v_mfma_f32_16x16x32_bf16 v[72:75], v[148:151], a[244:247], v[72:75]
    v_exp_f32 v16, v56
    v_mfma_f32_16x16x32_bf16 v[72:75], v[152:155], a[248:251], v[72:75]
    s_add_u32 m0, s36, 12288
    v_exp_f32 v17, v57
    v_mfma_f32_16x16x32_bf16 v[72:75], v[156:159], a[252:255], v[72:75]
    v_add_f32 v10, v10, v16
    v_mfma_f32_16x16x32_bf16 v[72:75], v[160:163], v[216:219], v[72:75]
    buffer_load_dwordx4 v26, s[12:15], s26 offen lds
    v_add_f32 v10, v10, v17
    v_mfma_f32_16x16x32_bf16 v[72:75], v[164:167], v[220:223], v[72:75]
    v_cvt_pk_bf16_f32 v106, v16, v17
    v_mfma_f32_16x16x32_bf16 v[76:79], v[144:147], v[224:227], v[140:143]
    v_exp_f32 v18, v58
    v_mfma_f32_16x16x32_bf16 v[76:79], v[148:151], v[228:231], v[76:79]
    v_exp_f32 v19, v59
    v_mfma_f32_16x16x32_bf16 v[76:79], v[152:155], v[232:235], v[76:79]
    buffer_load_dwordx4 v27, s[12:15], s26 offen offset:1024 lds
    v_add_f32 v10, v10, v18
    v_mfma_f32_16x16x32_bf16 v[76:79], v[156:159], v[236:239], v[76:79]
    v_add_f32 v10, v10, v19
    v_cvt_pk_bf16_f32 v107, v18, v19
    v_mfma_f32_16x16x32_bf16 v[76:79], v[160:163], v[240:243], v[76:79]
    v_exp_f32 v12, v44
    v_mfma_f32_16x16x32_bf16 v[76:79], v[164:167], v[244:247], v[76:79]
    s_waitcnt lgkmcnt(0)
    v_exp_f32 v13, v45
    v_mfma_f32_16x16x32_bf16 v[80:83], v[168:171], a[192:195], v[128:131]
    ds_read_b64_tr_b16 v[192:193], v22 offset:24576
    ds_read_b64_tr_b16 v[194:195], v22 offset:30720
    v_mfma_f32_16x16x32_bf16 v[80:83], v[172:175], a[196:199], v[80:83]
    v_add_f32 v11, v12, v13
    v_cvt_pk_bf16_f32 v108, v12, v13
    v_mfma_f32_16x16x32_bf16 v[80:83], v[176:179], a[200:203], v[80:83]
    buffer_load_dwordx4 v28, s[12:15], s26 offen offset:2048 lds
    v_mfma_f32_16x16x32_bf16 v[80:83], v[180:183], a[204:207], v[80:83]
    ds_read_b64_tr_b16 v[196:197], v23 offset:24576
    ds_read_b64_tr_b16 v[198:199], v23 offset:30720
    v_mfma_f32_16x16x32_bf16 v[80:83], v[184:187], a[208:211], v[80:83]
    s_mov_b32 s26, s25
    v_exp_f32 v14, v46
    v_mfma_f32_16x16x32_bf16 v[80:83], v[188:191], a[212:215], v[80:83]
    s_add_u32 s25, s25, 12288
    v_exp_f32 v15, v47
    v_mfma_f32_16x16x32_bf16 v[84:87], v[168:171], a[216:219], v[132:135]
    s_min_u32 s25, s25, 774144
    ds_read_b64_tr_b16 v[200:201], v24 offset:24576
    ds_read_b64_tr_b16 v[202:203], v24 offset:30720
    v_mfma_f32_16x16x32_bf16 v[84:87], v[172:175], a[220:223], v[84:87]
    v_add_f32 v11, v11, v14
    v_add_f32 v11, v11, v15
    v_mfma_f32_16x16x32_bf16 v[84:87], v[176:179], a[224:227], v[84:87]
    s_add_u32 s31, s31, 4
    v_cvt_pk_bf16_f32 v109, v14, v15
    v_mfma_f32_16x16x32_bf16 v[84:87], v[180:183], a[228:231], v[84:87]
    s_cmp_ge_u32 s31, 64
    ds_read_b64_tr_b16 v[204:205], v25 offset:24576
    ds_read_b64_tr_b16 v[206:207], v25 offset:30720
    v_mfma_f32_16x16x32_bf16 v[84:87], v[184:187], a[232:235], v[84:87]
    v_exp_f32 v16, v60
    v_mfma_f32_16x16x32_bf16 v[84:87], v[188:191], a[236:239], v[84:87]
    v_exp_f32 v17, v61
    v_mfma_f32_16x16x32_bf16 v[88:91], v[168:171], a[240:243], v[136:139]
    ds_read_b64_tr_b16 v[208:209], v22 offset:24704
    ds_read_b64_tr_b16 v[210:211], v22 offset:30848
    v_mfma_f32_16x16x32_bf16 v[88:91], v[172:175], a[244:247], v[88:91]
    v_add_f32 v11, v11, v16
    v_add_f32 v11, v11, v17
    v_mfma_f32_16x16x32_bf16 v[88:91], v[176:179], a[248:251], v[88:91]
    v_cvt_pk_bf16_f32 v110, v16, v17
    v_mfma_f32_16x16x32_bf16 v[88:91], v[180:183], a[252:255], v[88:91]
    ds_read_b64_tr_b16 v[212:213], v23 offset:24704
    ds_read_b64_tr_b16 v[214:215], v23 offset:30848
    v_mfma_f32_16x16x32_bf16 v[88:91], v[184:187], v[216:219], v[88:91]
    v_exp_f32 v18, v62
    v_mfma_f32_16x16x32_bf16 v[88:91], v[188:191], v[220:223], v[88:91]
    v_exp_f32 v19, v63
    v_mfma_f32_16x16x32_bf16 v[92:95], v[168:171], v[224:227], v[140:143]
    v_add_f32 v11, v11, v18
    v_max3_f32 v29, v8, v9, v10
    v_mfma_f32_16x16x32_bf16 v[92:95], v[172:175], v[228:231], v[92:95]
    v_add_f32 v11, v11, v19
    v_cvt_pk_bf16_f32 v111, v18, v19
    v_mfma_f32_16x16x32_bf16 v[92:95], v[176:179], v[232:235], v[92:95]
    v_max_f32 v29, v29, v11
    v_cmp_nge_f32 vcc, s34, v29
    v_mfma_f32_16x16x32_bf16 v[92:95], v[180:183], v[236:239], v[92:95]
    v_mfma_f32_16x16x32_bf16 v[92:95], v[184:187], v[240:243], v[92:95]
    s_waitcnt lgkmcnt(0)
    v_mfma_f32_16x16x32_bf16 v[92:95], v[188:191], v[244:247], v[92:95]
    s_cbranch_vccnz Z_call2
Z_ret2:
    v_mfma_f32_16x16x32_bf16 a[0:3], v[192:195], v[96:99], a[0:3]
    v_add_f32 v4, v4, v8
    v_add_f32 v5, v5, v9
    v_mfma_f32_16x16x32_bf16 a[48:51], v[192:195], v[100:103], a[48:51]
    v_add_f32 v6, v6, v10
    v_add_f32 v7, v7, v11
    v_mfma_f32_16x16x32_bf16 a[96:99], v[192:195], v[104:107], a[96:99]
    v_exp_f32 v12, v64
    v_mfma_f32_16x16x32_bf16 a[144:147], v[192:195], v[108:111], a[144:147]
    v_exp_f32 v13, v65
    v_mfma_f32_16x16x32_bf16 a[4:7], v[196:199], v[96:99], a[4:7]
    ds_read_b64_tr_b16 v[192:193], v24 offset:24704
    ds_read_b64_tr_b16 v[194:195], v24 offset:30848
    v_mfma_f32_16x16x32_bf16 a[52:55], v[196:199], v[100:103], a[52:55]
    v_add_f32 v8, v12, v13
    v_cvt_pk_bf16_f32 v112, v12, v13
    v_mfma_f32_16x16x32_bf16 a[100:103], v[196:199], v[104:107], a[100:103]
    v_exp_f32 v14, v66
    v_mfma_f32_16x16x32_bf16 a[148:151], v[196:199], v[108:111], a[148:151]
    v_exp_f32 v15, v67
    v_mfma_f32_16x16x32_bf16 a[8:11], v[200:203], v[96:99], a[8:11]
    ds_read_b64_tr_b16 v[196:197], v25 offset:24704
    ds_read_b64_tr_b16 v[198:199], v25 offset:30848
    v_mfma_f32_16x16x32_bf16 a[56:59], v[200:203], v[100:103], a[56:59]
    v_add_f32 v8, v8, v14
    v_add_f32 v8, v8, v15
    v_mfma_f32_16x16x32_bf16 a[104:107], v[200:203], v[104:107], a[104:107]
    v_cvt_pk_bf16_f32 v113, v14, v15
    v_mfma_f32_16x16x32_bf16 a[152:155], v[200:203], v[108:111], a[152:155]
    v_exp_f32 v16, v80
    v_mfma_f32_16x16x32_bf16 a[12:15], v[204:207], v[96:99], a[12:15]
    ds_read_b64_tr_b16 v[200:201], v22 offset:24832
    ds_read_b64_tr_b16 v[202:203], v22 offset:30976
    v_mfma_f32_16x16x32_bf16 a[60:63], v[204:207], v[100:103], a[60:63]
    v_exp_f32 v17, v81
    v_mfma_f32_16x16x32_bf16 a[108:111], v[204:207], v[104:107], a[108:111]
    v_add_f32 v8, v8, v16
    v_mfma_f32_16x16x32_bf16 a[156:159], v[204:207], v[108:111], a[156:159]
    v_add_f32 v8, v8, v17
    v_cvt_pk_bf16_f32 v114, v16, v17
    v_mfma_f32_16x16x32_bf16 a[16:19], v[208:211], v[96:99], a[16:19]
    ds_read_b64_tr_b16 v[204:205], v23 offset:24832
    ds_read_b64_tr_b16 v[206:207], v23 offset:30976
    v_mfma_f32_16x16x32_bf16 a[64:67], v[208:211], v[100:103], a[64:67]
    v_exp_f32 v18, v82
    v_mfma_f32_16x16x32_bf16 a[112:115], v[208:211], v[104:107], a[112:115]
    v_exp_f32 v19, v83
    v_mfma_f32_16x16x32_bf16 a[160:163], v[208:211], v[108:111], a[160:163]
    v_add_f32 v8, v8, v18
    v_mfma_f32_16x16x32_bf16 a[20:23], v[212:215], v[96:99], a[20:23]
    ds_read_b64_tr_b16 v[208:209], v24 offset:24832
    ds_read_b64_tr_b16 v[210:211], v24 offset:30976
    v_mfma_f32_16x16x32_bf16 a[68:71], v[212:215], v[100:103], a[68:71]
    v_add_f32 v8, v8, v19
    v_cvt_pk_bf16_f32 v115, v18, v19
    v_mfma_f32_16x16x32_bf16 a[116:119], v[212:215], v[104:107], a[116:119]
    v_exp_f32 v12, v68
    v_mfma_f32_16x16x32_bf16 a[164:167], v[212:215], v[108:111], a[164:167]
    s_waitcnt lgkmcnt(4)
    v_exp_f32 v13, v69
    v_mfma_f32_16x16x32_bf16 a[24:27], v[192:195], v[96:99], a[24:27]
    ds_read_b64_tr_b16 v[212:213], v25 offset:24832
    ds_read_b64_tr_b16 v[214:215], v25 offset:30976
    v_mfma_f32_16x16x32_bf16 a[72:75], v[192:195], v[100:103], a[72:75]
    v_add_f32 v9, v12, v13
    v_cvt_pk_bf16_f32 v116, v12, v13
    v_mfma_f32_16x16x32_bf16 a[120:123], v[192:195], v[104:107], a[120:123]
    ds_read_b128 v[144:147], v20 offset:0
    v_mfma_f32_16x16x32_bf16 a[168:171], v[192:195], v[108:111], a[168:171]
    v_exp_f32 v14, v70
    v_mfma_f32_16x16x32_bf16 a[28:31], v[196:199], v[96:99], a[28:31]
    ds_read_b128 v[148:151], v21 offset:0
    v_mfma_f32_16x16x32_bf16 a[76:79], v[196:199], v[100:103], a[76:79]
    v_exp_f32 v15, v71
    v_mfma_f32_16x16x32_bf16 a[124:127], v[196:199], v[104:107], a[124:127]
    ds_read_b128 v[152:155], v20 offset:128
    v_add_f32 v9, v9, v14
    v_mfma_f32_16x16x32_bf16 a[172:175], v[196:199], v[108:111], a[172:175]
    v_add_f32 v9, v9, v15
    v_cvt_pk_bf16_f32 v117, v14, v15
    v_mfma_f32_16x16x32_bf16 a[32:35], v[200:203], v[96:99], a[32:35]
    ds_read_b128 v[156:159], v21 offset:128
    v_mfma_f32_16x16x32_bf16 a[80:83], v[200:203], v[100:103], a[80:83]
    v_exp_f32 v16, v84
    v_mfma_f32_16x16x32_bf16 a[128:131], v[200:203], v[104:107], a[128:131]
    ds_read_b128 v[160:163], v20 offset:256
    v_mfma_f32_16x16x32_bf16 a[176:179], v[200:203], v[108:111], a[176:179]
    s_waitcnt lgkmcnt(5)
    v_exp_f32 v17, v85
    v_mfma_f32_16x16x32_bf16 a[36:39], v[204:207], v[96:99], a[36:39]
    ds_read_b128 v[164:167], v21 offset:256
    v_add_f32 v9, v9, v16
    v_mfma_f32_16x16x32_bf16 a[84:87], v[204:207], v[100:103], a[84:87]
    v_add_f32 v9, v9, v17
    v_cvt_pk_bf16_f32 v118, v16, v17
    v_mfma_f32_16x16x32_bf16 a[132:135], v[204:207], v[104:107], a[132:135]
    v_exp_f32 v18, v86
    v_mfma_f32_16x16x32_bf16 a[180:183], v[204:207], v[108:111], a[180:183]
    v_exp_f32 v19, v87
    v_mfma_f32_16x16x32_bf16 a[40:43], v[208:211], v[96:99], a[40:43]
    v_add_f32 v9, v9, v18
    v_mfma_f32_16x16x32_bf16 a[88:91], v[208:211], v[100:103], a[88:91]
    v_add_f32 v9, v9, v19
    v_mfma_f32_16x16x32_bf16 a[136:139], v[208:211], v[104:107], a[136:139]
    v_cvt_pk_bf16_f32 v119, v18, v19
    v_mfma_f32_16x16x32_bf16 a[184:187], v[208:211], v[108:111], a[184:187]
    v_mfma_f32_16x16x32_bf16 a[44:47], v[212:215], v[96:99], a[44:47]
    v_mfma_f32_16x16x32_bf16 a[92:95], v[212:215], v[100:103], a[92:95]
    v_mfma_f32_16x16x32_bf16 a[140:143], v[212:215], v[104:107], a[140:143]
    s_waitcnt lgkmcnt(0)
    v_mfma_f32_16x16x32_bf16 a[188:191], v[212:215], v[108:111], a[188:191]
    s_cbranch_scc1 Z_tail
    v_mfma_f32_16x16x32_bf16 v[32:35], v[144:147], a[192:195], v[128:131]
    s_waitcnt vmcnt(9)
    ds_read_b128 v[168:171], v20 offset:6144
    v_mfma_f32_16x16x32_bf16 v[32:35], v[148:151], a[196:199], v[32:35]
    s_barrier
    v_exp_f32 v12, v72
    v_mfma_f32_16x16x32_bf16 v[32:35], v[152:155], a[200:203], v[32:35]
    s_add_u32 m0, s35, 36864
    ds_read_b128 v[172:175], v21 offset:6144
    v_mfma_f32_16x16x32_bf16 v[32:35], v[156:159], a[204:207], v[32:35]
    v_exp_f32 v13, v73
    v_mfma_f32_16x16x32_bf16 v[32:35], v[160:163], a[208:211], v[32:35]
    buffer_load_dwordx4 v26, s[8:11], s25 offen lds
    ds_read_b128 v[176:179], v20 offset:6272
    v_mfma_f32_16x16x32_bf16 v[32:35], v[164:167], a[212:215], v[32:35]
    v_add_f32 v10, v12, v13
    v_cvt_pk_bf16_f32 v120, v12, v13
    v_mfma_f32_16x16x32_bf16 v[36:39], v[144:147], a[216:219], v[132:135]
    ds_read_b128 v[180:183], v21 offset:6272
    v_mfma_f32_16x16x32_bf16 v[36:39], v[148:151], a[220:223], v[36:39]
    v_exp_f32 v14, v74
    v_mfma_f32_16x16x32_bf16 v[36:39], v[152:155], a[224:227], v[36:39]
    buffer_load_dwordx4 v27, s[8:11], s25 offen offset:1024 lds
    ds_read_b128 v[184:187], v20 offset:6400
    v_mfma_f32_16x16x32_bf16 v[36:39], v[156:159], a[228:231], v[36:39]
    v_exp_f32 v15, v75
    v_mfma_f32_16x16x32_bf16 v[36:39], v[160:163], a[232:235], v[36:39]
    ds_read_b128 v[188:191], v21 offset:6400
    v_add_f32 v10, v10, v14
    v_mfma_f32_16x16x32_bf16 v[36:39], v[164:167], a[236:239], v[36:39]
    v_add_f32 v10, v10, v15
    v_cvt_pk_bf16_f32 v121, v14, v15
    v_mfma_f32_16x16x32_bf16 v[40:43], v[144:147], a[240:243], v[136:139]
    buffer_load_dwordx4 v28, s[8:11], s25 offen offset:2048 lds
    v_mfma_f32_16x16x32_bf16 v[40:43], v[148:151], a[244:247], v[40:43]
    v_exp_f32 v16, v88
    v_mfma_f32_16x16x32_bf16 v[40:43], v[152:155], a[248:251], v[40:43]
    s_add_u32 m0, s36, 24576
    v_exp_f32 v17, v89
    v_mfma_f32_16x16x32_bf16 v[40:43], v[156:159], a[252:255], v[40:43]
    v_add_f32 v10, v10, v16
    v_mfma_f32_16x16x32_bf16 v[40:43], v[160:163], v[216:219], v[40:43]
    buffer_load_dwordx4 v26, s[12:15], s26 offen lds
    v_add_f32 v10, v10, v17
    v_mfma_f32_16x16x32_bf16 v[40:43], v[164:167], v[220:223], v[40:43]
    v_cvt_pk_bf16_f32 v122, v16, v17
    v_mfma_f32_16x16x32_bf16 v[44:47], v[144:147], v[224:227], v[140:143]
    v_exp_f32 v18, v90
    v_mfma_f32_16x16x32_bf16 v[44:47], v[148:151], v[228:231], v[44:47]
    v_exp_f32 v19, v91
    v_mfma_f32_16x16x32_bf16 v[44:47], v[152:155], v[232:235], v[44:47]
    buffer_load_dwordx4 v27, s[12:15], s26 offen offset:1024 lds
    v_add_f32 v10, v10, v18
    v_mfma_f32_16x16x32_bf16 v[44:47], v[156:159], v[236:239], v[44:47]
    v_add_f32 v10, v10, v19
    v_cvt_pk_bf16_f32 v123, v18, v19
    v_mfma_f32_16x16x32_bf16 v[44:47], v[160:163], v[240:243], v[44:47]
    v_exp_f32 v12, v76
    v_mfma_f32_16x16x32_bf16 v[44:47], v[164:167], v[244:247], v[44:47]
    s_waitcnt lgkmcnt(0)
    v_exp_f32 v13, v77
    v_mfma_f32_16x16x32_bf16 v[48:51], v[168:171], a[192:195], v[128:131]
    ds_read_b64_tr_b16 v[192:193], v22 offset:36864
    ds_read_b64_tr_b16 v[194:195], v22 offset:43008
    v_mfma_f32_16x16x32_bf16 v[48:51], v[172:175], a[196:199], v[48:51]
    v_add_f32 v11, v12, v13
    v_cvt_pk_bf16_f32 v124, v12, v13
    v_mfma_f32_16x16x32_bf16 v[48:51], v[176:179], a[200:203], v[48:51]
    buffer_load_dwordx4 v28, s[12:15], s26 offen offset:2048 lds
    v_mfma_f32_16x16x32_bf16 v[48:51], v[180:183], a[204:207], v[48:51]
    ds_read_b64_tr_b16 v[196:197], v23 offset:36864
    ds_read_b64_tr_b16 v[198:199], v23 offset:43008
    v_mfma_f32_16x16x32_bf16 v[48:51], v[184:187], a[208:211], v[48:51]
    s_mov_b32 s26, s25
    v_exp_f32 v14, v78
    v_mfma_f32_16x16x32_bf16 v[48:51], v[188:191], a[212:215], v[48:51]
    s_add_u32 s25, s25, 12288
    v_exp_f32 v15, v79
    v_mfma_f32_16x16x32_bf16 v[52:55], v[168:171], a[216:219], v[132:135]
    s_min_u32 s25, s25, 774144
    ds_read_b64_tr_b16 v[200:201], v24 offset:36864
    ds_read_b64_tr_b16 v[202:203], v24 offset:43008
    v_mfma_f32_16x16x32_bf16 v[52:55], v[172:175], a[220:223], v[52:55]
    v_add_f32 v11, v11, v14
    v_add_f32 v11, v11, v15
    v_mfma_f32_16x16x32_bf16 v[52:55], v[176:179], a[224:227], v[52:55]
    v_cvt_pk_bf16_f32 v125, v14, v15
    v_mfma_f32_16x16x32_bf16 v[52:55], v[180:183], a[228:231], v[52:55]
    ds_read_b64_tr_b16 v[204:205], v25 offset:36864
    ds_read_b64_tr_b16 v[206:207], v25 offset:43008
    v_mfma_f32_16x16x32_bf16 v[52:55], v[184:187], a[232:235], v[52:55]
    v_exp_f32 v16, v92
    v_mfma_f32_16x16x32_bf16 v[52:55], v[188:191], a[236:239], v[52:55]
    v_exp_f32 v17, v93
    v_mfma_f32_16x16x32_bf16 v[56:59], v[168:171], a[240:243], v[136:139]
    ds_read_b64_tr_b16 v[208:209], v22 offset:36992
    ds_read_b64_tr_b16 v[210:211], v22 offset:43136
    v_mfma_f32_16x16x32_bf16 v[56:59], v[172:175], a[244:247], v[56:59]
    v_add_f32 v11, v11, v16
    v_add_f32 v11, v11, v17
    v_mfma_f32_16x16x32_bf16 v[56:59], v[176:179], a[248:251], v[56:59]
    v_cvt_pk_bf16_f32 v126, v16, v17
    v_mfma_f32_16x16x32_bf16 v[56:59], v[180:183], a[252:255], v[56:59]
    ds_read_b64_tr_b16 v[212:213], v23 offset:36992
    ds_read_b64_tr_b16 v[214:215], v23 offset:43136
    v_mfma_f32_16x16x32_bf16 v[56:59], v[184:187], v[216:219], v[56:59]
    v_exp_f32 v18, v94
    v_mfma_f32_16x16x32_bf16 v[56:59], v[188:191], v[220:223], v[56:59]
    v_exp_f32 v19, v95
    v_mfma_f32_16x16x32_bf16 v[60:63], v[168:171], v[224:227], v[140:143]
    v_add_f32 v11, v11, v18
    v_max3_f32 v29, v8, v9, v10
    v_mfma_f32_16x16x32_bf16 v[60:63], v[172:175], v[228:231], v[60:63]
    v_add_f32 v11, v11, v19
    v_cvt_pk_bf16_f32 v127, v18, v19
    v_mfma_f32_16x16x32_bf16 v[60:63], v[176:179], v[232:235], v[60:63]
    v_max_f32 v29, v29, v11
    v_cmp_nge_f32 vcc, s34, v29
    v_mfma_f32_16x16x32_bf16 v[60:63], v[180:183], v[236:239], v[60:63]
    v_mfma_f32_16x16x32_bf16 v[60:63], v[184:187], v[240:243], v[60:63]
    s_waitcnt lgkmcnt(0)
    v_mfma_f32_16x16x32_bf16 v[60:63], v[188:191], v[244:247], v[60:63]
    s_cbranch_vccnz Z_call3
Z_ret3:
    v_mfma_f32_16x16x32_bf16 a[0:3], v[192:195], v[112:115], a[0:3]
    v_add_f32 v4, v4, v8
    v_add_f32 v5, v5, v9
    v_mfma_f32_16x16x32_bf16 a[48:51], v[192:195], v[116:119], a[48:51]
    v_add_f32 v6, v6, v10
    v_add_f32 v7, v7, v11
    v_mfma_f32_16x16x32_bf16 a[96:99], v[192:195], v[120:123], a[96:99]
    v_exp_f32 v12, v32
    v_mfma_f32_16x16x32_bf16 a[144:147], v[192:195], v[124:127], a[144:147]
    v_exp_f32 v13, v33
    v_mfma_f32_16x16x32_bf16 a[4:7], v[196:199], v[112:115], a[4:7]
    ds_read_b64_tr_b16 v[192:193], v24 offset:36992
    ds_read_b64_tr_b16 v[194:195], v24 offset:43136
    v_mfma_f32_16x16x32_bf16 a[52:55], v[196:199], v[116:119], a[52:55]
    v_add_f32 v8, v12, v13
    v_cvt_pk_bf16_f32 v96, v12, v13
    v_mfma_f32_16x16x32_bf16 a[100:103], v[196:199], v[120:123], a[100:103]
    v_exp_f32 v14, v34
    v_mfma_f32_16x16x32_bf16 a[148:151], v[196:199], v[124:127], a[148:151]
    v_exp_f32 v15, v35
    v_mfma_f32_16x16x32_bf16 a[8:11], v[200:203], v[112:115], a[8:11]
    ds_read_b64_tr_b16 v[196:197], v25 offset:36992
    ds_read_b64_tr_b16 v[198:199], v25 offset:43136
    v_mfma_f32_16x16x32_bf16 a[56:59], v[200:203], v[116:119], a[56:59]
    v_add_f32 v8, v8, v14
    v_add_f32 v8, v8, v15
    v_mfma_f32_16x16x32_bf16 a[104:107], v[200:203], v[120:123], a[104:107]
    v_cvt_pk_bf16_f32 v97, v14, v15
    v_mfma_f32_16x16x32_bf16 a[152:155], v[200:203], v[124:127], a[152:155]
    v_exp_f32 v16, v48
    v_mfma_f32_16x16x32_bf16 a[12:15], v[204:207], v[112:115], a[12:15]
    ds_read_b64_tr_b16 v[200:201], v22 offset:37120
    ds_read_b64_tr_b16 v[202:203], v22 offset:43264
    v_mfma_f32_16x16x32_bf16 a[60:63], v[204:207], v[116:119], a[60:63]
    v_exp_f32 v17, v49
    v_mfma_f32_16x16x32_bf16 a[108:111], v[204:207], v[120:123], a[108:111]
    v_add_f32 v8, v8, v16
    v_mfma_f32_16x16x32_bf16 a[156:159], v[204:207], v[124:127], a[156:159]
    v_add_f32 v8, v8, v17
    v_cvt_pk_bf16_f32 v98, v16, v17
    v_mfma_f32_16x16x32_bf16 a[16:19], v[208:211], v[112:115], a[16:19]
    ds_read_b64_tr_b16 v[204:205], v23 offset:37120
    ds_read_b64_tr_b16 v[206:207], v23 offset:43264
    v_mfma_f32_16x16x32_bf16 a[64:67], v[208:211], v[116:119], a[64:67]
    v_exp_f32 v18, v50
    v_mfma_f32_16x16x32_bf16 a[112:115], v[208:211], v[120:123], a[112:115]
    v_exp_f32 v19, v51
    v_mfma_f32_16x16x32_bf16 a[160:163], v[208:211], v[124:127], a[160:163]
    v_add_f32 v8, v8, v18
    v_mfma_f32_16x16x32_bf16 a[20:23], v[212:215], v[112:115], a[20:23]
    ds_read_b64_tr_b16 v[208:209], v24 offset:37120
    ds_read_b64_tr_b16 v[210:211], v24 offset:43264
    v_mfma_f32_16x16x32_bf16 a[68:71], v[212:215], v[116:119], a[68:71]
    v_add_f32 v8, v8, v19
    v_cvt_pk_bf16_f32 v99, v18, v19
    v_mfma_f32_16x16x32_bf16 a[116:119], v[212:215], v[120:123], a[116:119]
    v_exp_f32 v12, v36
    v_mfma_f32_16x16x32_bf16 a[164:167], v[212:215], v[124:127], a[164:167]
    s_waitcnt lgkmcnt(4)
    v_exp_f32 v13, v37
    v_mfma_f32_16x16x32_bf16 a[24:27], v[192:195], v[112:115], a[24:27]
    ds_read_b64_tr_b16 v[212:213], v25 offset:37120
    ds_read_b64_tr_b16 v[214:215], v25 offset:43264
    v_mfma_f32_16x16x32_bf16 a[72:75], v[192:195], v[116:119], a[72:75]
    v_add_f32 v9, v12, v13
    v_cvt_pk_bf16_f32 v100, v12, v13
    v_mfma_f32_16x16x32_bf16 a[120:123], v[192:195], v[120:123], a[120:123]
    ds_read_b128 v[144:147], v20 offset:12288
    v_mfma_f32_16x16x32_bf16 a[168:171], v[192:195], v[124:127], a[168:171]
    v_exp_f32 v14, v38
    v_mfma_f32_16x16x32_bf16 a[28:31], v[196:199], v[112:115], a[28:31]
    ds_read_b128 v[148:151], v21 offset:12288
    v_mfma_f32_16x16x32_bf16 a[76:79], v[196:199], v[116:119], a[76:79]
    v_exp_f32 v15, v39
    v_mfma_f32_16x16x32_bf16 a[124:127], v[196:199], v[120:123], a[124:127]
    ds_read_b128 v[152:155], v20 offset:12416
    v_add_f32 v9, v9, v14
    v_mfma_f32_16x16x32_bf16 a[172:175], v[196:199], v[124:127], a[172:175]
    v_add_f32 v9, v9, v15
    v_cvt_pk_bf16_f32 v101, v14, v15
    v_mfma_f32_16x16x32_bf16 a[32:35], v[200:203], v[112:115], a[32:35]
    ds_read_b128 v[156:159], v21 offset:12416
    v_mfma_f32_16x16x32_bf16 a[80:83], v[200:203], v[116:119], a[80:83]
    v_exp_f32 v16, v52
    v_mfma_f32_16x16x32_bf16 a[128:131], v[200:203], v[120:123], a[128:131]
    ds_read_b128 v[160:163], v20 offset:12544
    v_mfma_f32_16x16x32_bf16 a[176:179], v[200:203], v[124:127], a[176:179]
    s_waitcnt lgkmcnt(5)
    v_exp_f32 v17, v53
    v_mfma_f32_16x16x32_bf16 a[36:39], v[204:207], v[112:115], a[36:39]
    ds_read_b128 v[164:167], v21 offset:12544
    v_add_f32 v9, v9, v16
    v_mfma_f32_16x16x32_bf16 a[84:87], v[204:207], v[116:119], a[84:87]
    v_add_f32 v9, v9, v17
    v_cvt_pk_bf16_f32 v102, v16, v17
    v_mfma_f32_16x16x32_bf16 a[132:135], v[204:207], v[120:123], a[132:135]
    v_exp_f32 v18, v54
    v_mfma_f32_16x16x32_bf16 a[180:183], v[204:207], v[124:127], a[180:183]
    v_exp_f32 v19, v55
    v_mfma_f32_16x16x32_bf16 a[40:43], v[208:211], v[112:115], a[40:43]
    v_add_f32 v9, v9, v18
    v_mfma_f32_16x16x32_bf16 a[88:91], v[208:211], v[116:119], a[88:91]
    v_add_f32 v9, v9, v19
    v_mfma_f32_16x16x32_bf16 a[136:139], v[208:211], v[120:123], a[136:139]
    v_cvt_pk_bf16_f32 v103, v18, v19
    v_mfma_f32_16x16x32_bf16 a[184:187], v[208:211], v[124:127], a[184:187]
    v_mfma_f32_16x16x32_bf16 a[44:47], v[212:215], v[112:115], a[44:47]
    v_mfma_f32_16x16x32_bf16 a[92:95], v[212:215], v[116:119], a[92:95]
    v_mfma_f32_16x16x32_bf16 a[140:143], v[212:215], v[120:123], a[140:143]
    s_waitcnt lgkmcnt(0)
    v_mfma_f32_16x16x32_bf16 a[188:191], v[212:215], v[124:127], a[188:191]
    s_branch Z_loop
Z_tail:
    s_waitcnt vmcnt(9)
    v_exp_f32 v12, v72
    s_nop 0
    s_barrier
    v_exp_f32 v13, v73
    s_nop 0
    v_add_f32 v10, v12, v13
    v_cvt_pk_bf16_f32 v120, v12, v13
    ds_read_b64_tr_b16 v[192:193], v22 offset:36864
    ds_read_b64_tr_b16 v[194:195], v22 offset:43008
    v_exp_f32 v14, v74
    s_nop 0
    v_exp_f32 v15, v75
    s_nop 0
    ds_read_b64_tr_b16 v[196:197], v23 offset:36864
    ds_read_b64_tr_b16 v[198:199], v23 offset:43008
    v_add_f32 v10, v10, v14
    v_add_f32 v10, v10, v15
    v_cvt_pk_bf16_f32 v121, v14, v15
    ds_read_b64_tr_b16 v[200:201], v24 offset:36864
    ds_read_b64_tr_b16 v[202:203], v24 offset:43008
    v_exp_f32 v16, v88
    s_nop 0
    v_exp_f32 v17, v89
    s_nop 0
    ds_read_b64_tr_b16 v[204:205], v25 offset:36864
    ds_read_b64_tr_b16 v[206:207], v25 offset:43008
    v_add_f32 v10, v10, v16
    v_add_f32 v10, v10, v17
    v_cvt_pk_bf16_f32 v122, v16, v17
    ds_read_b64_tr_b16 v[208:209], v22 offset:36992
    ds_read_b64_tr_b16 v[210:211], v22 offset:43136
    v_exp_f32 v18, v90
    s_nop 0
    v_exp_f32 v19, v91
    s_nop 0
    ds_read_b64_tr_b16 v[212:213], v23 offset:36992
    ds_read_b64_tr_b16 v[214:215], v23 offset:43136
    v_add_f32 v10, v10, v18
    v_add_f32 v10, v10, v19
    v_cvt_pk_bf16_f32 v123, v18, v19
    ds_read_b64_tr_b16 v[144:145], v24 offset:36992
    ds_read_b64_tr_b16 v[146:147], v24 offset:43136
    v_exp_f32 v12, v76
    s_nop 0
    v_exp_f32 v13, v77
    s_nop 0
    ds_read_b64_tr_b16 v[148:149], v25 offset:36992
    ds_read_b64_tr_b16 v[150:151], v25 offset:43136
    v_add_f32 v11, v12, v13
    v_cvt_pk_bf16_f32 v124, v12, v13
    v_exp_f32 v14, v78
    s_nop 0
    ds_read_b64_tr_b16 v[152:153], v22 offset:37120
    ds_read_b64_tr_b16 v[154:155], v22 offset:43264
    v_exp_f32 v15, v79
    s_nop 0
    v_add_f32 v11, v11, v14
    ds_read_b64_tr_b16 v[156:157], v23 offset:37120
    ds_read_b64_tr_b16 v[158:159], v23 offset:43264
    v_add_f32 v11, v11, v15
    v_cvt_pk_bf16_f32 v125, v14, v15
    v_exp_f32 v16, v92
    s_nop 0
    ds_read_b64_tr_b16 v[160:161], v24 offset:37120
    ds_read_b64_tr_b16 v[162:163], v24 offset:43264
    v_exp_f32 v17, v93
    s_nop 0
    v_add_f32 v11, v11, v16
    ds_read_b64_tr_b16 v[164:165], v25 offset:37120
    ds_read_b64_tr_b16 v[166:167], v25 offset:43264
    v_add_f32 v11, v11, v17
    v_cvt_pk_bf16_f32 v126, v16, v17
    v_exp_f32 v18, v94
    s_nop 0
    v_exp_f32 v19, v95
    s_nop 0
    v_add_f32 v11, v11, v18
    v_max3_f32 v29, v8, v9, v10
    v_add_f32 v11, v11, v19
    v_cvt_pk_bf16_f32 v127, v18, v19
    v_max_f32 v29, v29, v11
    v_cmp_nge_f32 vcc, s34, v29
    s_waitcnt lgkmcnt(0)
    s_cbranch_vccnz Z_callL
Z_retL:
    v_add_f32 v4, v4, v8
    v_add_f32 v5, v5, v9
    v_add_f32 v6, v6, v10
    v_add_f32 v7, v7, v11
    v_mfma_f32_16x16x32_bf16 a[0:3], v[192:195], v[112:115], a[0:3]
    v_mfma_f32_16x16x32_bf16 a[4:7], v[196:199], v[112:115], a[4:7]
    v_mfma_f32_16x16x32_bf16 a[8:11], v[200:203], v[112:115], a[8:11]
    v_mfma_f32_16x16x32_bf16 a[12:15], v[204:207], v[112:115], a[12:15]
    v_mfma_f32_16x16x32_bf16 a[16:19], v[208:211], v[112:115], a[16:19]
    v_mfma_f32_16x16x32_bf16 a[20:23], v[212:215], v[112:115], a[20:23]
    v_mfma_f32_16x16x32_bf16 a[24:27], v[144:147], v[112:115], a[24:27]
    v_mfma_f32_16x16x32_bf16 a[28:31], v[148:151], v[112:115], a[28:31]
    v_mfma_f32_16x16x32_bf16 a[32:35], v[152:155], v[112:115], a[32:35]
    v_mfma_f32_16x16x32_bf16 a[36:39], v[156:159], v[112:115], a[36:39]
    v_mfma_f32_16x16x32_bf16 a[40:43], v[160:163], v[112:115], a[40:43]
    v_mfma_f32_16x16x32_bf16 a[44:47], v[164:167], v[112:115], a[44:47]
    v_mov_b32 v12, v4
    v_mov_b32 v13, v5
    v_mov_b32 v14, v6
    v_mov_b32 v15, v7
    s_nop 0
    v_permlane16_swap_b32 v4, v12
    v_permlane16_swap_b32 v5, v13
    v_permlane16_swap_b32 v6, v14
    v_permlane16_swap_b32 v7, v15
    s_nop 0
    v_add_f32 v4, v4, v12
    v_add_f32 v5, v5, v13
    v_add_f32 v6, v6, v14
    v_add_f32 v7, v7, v15
    v_mov_b32 v12, v4
    v_mov_b32 v13, v5
    v_mov_b32 v14, v6
    v_mov_b32 v15, v7
    s_nop 0
    v_permlane32_swap_b32 v4, v12
    v_permlane32_swap_b32 v5, v13
    v_permlane32_swap_b32 v6, v14
    v_permlane32_swap_b32 v7, v15
    s_nop 0
    v_add_f32 v4, v4, v12
    v_add_f32 v5, v5, v13
    v_add_f32 v6, v6, v14
    v_add_f32 v7, v7, v15
    v_rcp_f32 v4, v4
    v_rcp_f32 v5, v5
    v_rcp_f32 v6, v6
    v_rcp_f32 v7, v7
    v_mfma_f32_16x16x32_bf16 a[48:51], v[192:195], v[116:119], a[48:51]
    v_accvgpr_read_b32 v32, a0
    v_accvgpr_read_b32 v33, a1
    v_accvgpr_read_b32 v34, a2
    v_accvgpr_read_b32 v35, a3
    v_mul_f32 v32, v32, v4
    v_mul_f32 v33, v33, v4
    v_mul_f32 v34, v34, v4
    v_mul_f32 v35, v35, v4
    v_cvt_pk_bf16_f32 v36, v32, v33
    v_cvt_pk_bf16_f32 v37, v34, v35
    ds_write_b64 v1, v[36:37] offset:0
    v_mfma_f32_16x16x32_bf16 a[52:55], v[196:199], v[116:119], a[52:55]
    v_accvgpr_read_b32 v38, a4
    v_accvgpr_read_b32 v39, a5
    v_accvgpr_read_b32 v40, a6
    v_accvgpr_read_b32 v41, a7
    v_mul_f32 v38, v38, v4
    v_mul_f32 v39, v39, v4
    v_mul_f32 v40, v40, v4
    v_mul_f32 v41, v41, v4
    v_cvt_pk_bf16_f32 v42, v38, v39
    v_cvt_pk_bf16_f32 v43, v40, v41
    ds_write_b64 v1, v[42:43] offset:32
    v_mfma_f32_16x16x32_bf16 a[56:59], v[200:203], v[116:119], a[56:59]
    v_accvgpr_read_b32 v44, a8
    v_accvgpr_read_b32 v45, a9
    v_accvgpr_read_b32 v46, a10
    v_accvgpr_read_b32 v47, a11
    v_mul_f32 v44, v44, v4
    v_mul_f32 v45, v45, v4
    v_mul_f32 v46, v46, v4
    v_mul_f32 v47, v47, v4
    v_cvt_pk_bf16_f32 v48, v44, v45
    v_cvt_pk_bf16_f32 v49, v46, v47
    ds_write_b64 v1, v[48:49] offset:64
    v_mfma_f32_16x16x32_bf16 a[60:63], v[204:207], v[116:119], a[60:63]
    v_accvgpr_read_b32 v50, a12
    v_accvgpr_read_b32 v51, a13
    v_accvgpr_read_b32 v52, a14
    v_accvgpr_read_b32 v53, a15
    v_mul_f32 v50, v50, v4
    v_mul_f32 v51, v51, v4
    v_mul_f32 v52, v52, v4
    v_mul_f32 v53, v53, v4
    v_cvt_pk_bf16_f32 v54, v50, v51
    v_cvt_pk_bf16_f32 v55, v52, v53
    ds_write_b64 v1, v[54:55] offset:96
    v_mfma_f32_16x16x32_bf16 a[64:67], v[208:211], v[116:119], a[64:67]
    v_accvgpr_read_b32 v32, a16
    v_accvgpr_read_b32 v33, a17
    v_accvgpr_read_b32 v34, a18
    v_accvgpr_read_b32 v35, a19
    v_mul_f32 v32, v32, v4
    v_mul_f32 v33, v33, v4
    v_mul_f32 v34, v34, v4
    v_mul_f32 v35, v35, v4
    v_cvt_pk_bf16_f32 v36, v32, v33
    v_cvt_pk_bf16_f32 v37, v34, v35
    ds_write_b64 v1, v[36:37] offset:128
    v_mfma_f32_16x16x32_bf16 a[68:71], v[212:215], v[116:119], a[68:71]
    v_accvgpr_read_b32 v38, a20
    v_accvgpr_read_b32 v39, a21
    v_accvgpr_read_b32 v40, a22
    v_accvgpr_read_b32 v41, a23
    v_mul_f32 v38, v38, v4
    v_mul_f32 v39, v39, v4
    v_mul_f32 v40, v40, v4
    v_mul_f32 v41, v41, v4
    v_cvt_pk_bf16_f32 v42, v38, v39
    v_cvt_pk_bf16_f32 v43, v40, v41
    ds_write_b64 v1, v[42:43] offset:160
    v_mfma_f32_16x16x32_bf16 a[72:75], v[144:147], v[116:119], a[72:75]
    v_accvgpr_read_b32 v44, a24
    v_accvgpr_read_b32 v45, a25
    v_accvgpr_read_b32 v46, a26
    v_accvgpr_read_b32 v47, a27
    v_mul_f32 v44, v44, v4
    v_mul_f32 v45, v45, v4
    v_mul_f32 v46, v46, v4
    v_mul_f32 v47, v47, v4
    v_cvt_pk_bf16_f32 v48, v44, v45
    v_cvt_pk_bf16_f32 v49, v46, v47
    ds_write_b64 v1, v[48:49] offset:192
    v_mfma_f32_16x16x32_bf16 a[76:79], v[148:151], v[116:119], a[76:79]
    v_accvgpr_read_b32 v50, a28
    v_accvgpr_read_b32 v51, a29
    v_accvgpr_read_b32 v52, a30
    v_accvgpr_read_b32 v53, a31
    v_mul_f32 v50, v50, v4
    v_mul_f32 v51, v51, v4
    v_mul_f32 v52, v52, v4
    v_mul_f32 v53, v53, v4
    v_cvt_pk_bf16_f32 v54, v50, v51
    v_cvt_pk_bf16_f32 v55, v52, v53
    ds_write_b64 v1, v[54:55] offset:224
    v_mfma_f32_16x16x32_bf16 a[80:83], v[152:155], v[116:119], a[80:83]
    v_accvgpr_read_b32 v32, a32
    v_accvgpr_read_b32 v33, a33
    v_accvgpr_read_b32 v34, a34
    v_accvgpr_read_b32 v35, a35
    v_mul_f32 v32, v32, v4
    v_mul_f32 v33, v33, v4
    v_mul_f32 v34, v34, v4
    v_mul_f32 v35, v35, v4
    v_cvt_pk_bf16_f32 v36, v32, v33
    v_cvt_pk_bf16_f32 v37, v34, v35
    ds_write_b64 v1, v[36:37] offset:256
    v_mfma_f32_16x16x32_bf16 a[84:87], v[156:159], v[116:119], a[84:87]
    v_accvgpr_read_b32 v38, a36
    v_accvgpr_read_b32 v39, a37
    v_accvgpr_read_b32 v40, a38
    v_accvgpr_read_b32 v41, a39
    v_mul_f32 v38, v38, v4
    v_mul_f32 v39, v39, v4
    v_mul_f32 v40, v40, v4
    v_mul_f32 v41, v41, v4
    v_cvt_pk_bf16_f32 v42, v38, v39
    v_cvt_pk_bf16_f32 v43, v40, v41
    ds_write_b64 v1, v[42:43] offset:288
    v_mfma_f32_16x16x32_bf16 a[88:91], v[160:163], v[116:119], a[88:91]
    v_accvgpr_read_b32 v44, a40
    v_accvgpr_read_b32 v45, a41
    v_accvgpr_read_b32 v46, a42
    v_accvgpr_read_b32 v47, a43
    v_mul_f32 v44, v44, v4
    v_mul_f32 v45, v45, v4
    v_mul_f32 v46, v46, v4
    v_mul_f32 v47, v47, v4
    v_cvt_pk_bf16_f32 v48, v44, v45
    v_cvt_pk_bf16_f32 v49, v46, v47
    ds_write_b64 v1, v[48:49] offset:320
    v_mfma_f32_16x16x32_bf16 a[92:95], v[164:167], v[116:119], a[92:95]
    v_accvgpr_read_b32 v50, a44
    v_accvgpr_read_b32 v51, a45
    v_accvgpr_read_b32 v52, a46
    v_accvgpr_read_b32 v53, a47
    v_mul_f32 v50, v50, v4
    v_mul_f32 v51, v51, v4
    v_mul_f32 v52, v52, v4
    v_mul_f32 v53, v53, v4
    v_cvt_pk_bf16_f32 v54, v50, v51
    v_cvt_pk_bf16_f32 v55, v52, v53
    ds_write_b64 v1, v[54:55] offset:352
    s_waitcnt lgkmcnt(0)
    ds_read_b128 v[216:219], v3 offset:0
    ds_read_b128 v[220:223], v253 offset:0
    ds_read_b128 v[224:227], v254 offset:0
    ds_read_b128 v[228:231], v3 offset:3200
    ds_read_b128 v[232:235], v253 offset:3200
    ds_read_b128 v[236:239], v254 offset:3200
    s_waitcnt lgkmcnt(5)
    s_mov_b32 s41, 0
    buffer_store_dwordx4 v[216:219], v2, s[16:19], s41 offen offset:0
    s_waitcnt lgkmcnt(4)
    s_mov_b32 s41, 0
    buffer_store_dwordx4 v[220:223], v2, s[16:19], s41 offen offset:1024
    s_waitcnt lgkmcnt(3)
    s_mov_b32 s41, 0
    buffer_store_dwordx4 v[224:227], v2, s[16:19], s41 offen offset:2048
    s_waitcnt lgkmcnt(2)
    s_mov_b32 s41, 3072
    buffer_store_dwordx4 v[228:231], v2, s[16:19], s41 offen offset:0
    s_waitcnt lgkmcnt(1)
    s_mov_b32 s41, 3072
    buffer_store_dwordx4 v[232:235], v2, s[16:19], s41 offen offset:1024
    s_waitcnt lgkmcnt(0)
    s_mov_b32 s41, 3072
    buffer_store_dwordx4 v[236:239], v2, s[16:19], s41 offen offset:2048
    s_nop 7
    v_mfma_f32_16x16x32_bf16 a[96:99], v[192:195], v[120:123], a[96:99]
    v_accvgpr_read_b32 v64, a48
    v_accvgpr_read_b32 v65, a49
    v_accvgpr_read_b32 v66, a50
    v_accvgpr_read_b32 v67, a51
    v_mul_f32 v64, v64, v5
    v_mul_f32 v65, v65, v5
    v_mul_f32 v66, v66, v5
    v_mul_f32 v67, v67, v5
    v_cvt_pk_bf16_f32 v68, v64, v65
    v_cvt_pk_bf16_f32 v69, v66, v67
    ds_write_b64 v1, v[68:69] offset:6400
    v_mfma_f32_16x16x32_bf16 a[100:103], v[196:199], v[120:123], a[100:103]
    v_accvgpr_read_b32 v70, a52
    v_accvgpr_read_b32 v71, a53
    v_accvgpr_read_b32 v72, a54
    v_accvgpr_read_b32 v73, a55
    v_mul_f32 v70, v70, v5
    v_mul_f32 v71, v71, v5
    v_mul_f32 v72, v72, v5
    v_mul_f32 v73, v73, v5
    v_cvt_pk_bf16_f32 v74, v70, v71
    v_cvt_pk_bf16_f32 v75, v72, v73
    ds_write_b64 v1, v[74:75] offset:6432
    v_mfma_f32_16x16x32_bf16 a[104:107], v[200:203], v[120:123], a[104:107]
    v_accvgpr_read_b32 v76, a56
    v_accvgpr_read_b32 v77, a57
    v_accvgpr_read_b32 v78, a58
    v_accvgpr_read_b32 v79, a59
    v_mul_f32 v76, v76, v5
    v_mul_f32 v77, v77, v5
    v_mul_f32 v78, v78, v5
    v_mul_f32 v79, v79, v5
    v_cvt_pk_bf16_f32 v80, v76, v77
    v_cvt_pk_bf16_f32 v81, v78, v79
    ds_write_b64 v1, v[80:81] offset:6464
    v_mfma_f32_16x16x32_bf16 a[108:111], v[204:207], v[120:123], a[108:111]
    v_accvgpr_read_b32 v82, a60
    v_accvgpr_read_b32 v83, a61
    v_accvgpr_read_b32 v84, a62
    v_accvgpr_read_b32 v85, a63
    v_mul_f32 v82, v82, v5
    v_mul_f32 v83, v83, v5
    v_mul_f32 v84, v84, v5
    v_mul_f32 v85, v85, v5
    v_cvt_pk_bf16_f32 v86, v82, v83
    v_cvt_pk_bf16_f32 v87, v84, v85
    ds_write_b64 v1, v[86:87] offset:6496
    v_mfma_f32_16x16x32_bf16 a[112:115], v[208:211], v[120:123], a[112:115]
    v_accvgpr_read_b32 v64, a64
    v_accvgpr_read_b32 v65, a65
    v_accvgpr_read_b32 v66, a66
    v_accvgpr_read_b32 v67, a67
    v_mul_f32 v64, v64, v5
    v_mul_f32 v65, v65, v5
    v_mul_f32 v66, v66, v5
    v_mul_f32 v67, v67, v5
    v_cvt_pk_bf16_f32 v68, v64, v65
    v_cvt_pk_bf16_f32 v69, v66, v67
    ds_write_b64 v1, v[68:69] offset:6528
    v_mfma_f32_16x16x32_bf16 a[116:119], v[212:215], v[120:123], a[116:119]
    v_accvgpr_read_b32 v70, a68
    v_accvgpr_read_b32 v71, a69
    v_accvgpr_read_b32 v72, a70
    v_accvgpr_read_b32 v73, a71
    v_mul_f32 v70, v70, v5
    v_mul_f32 v71, v71, v5
    v_mul_f32 v72, v72, v5
    v_mul_f32 v73, v73, v5
    v_cvt_pk_bf16_f32 v74, v70, v71
    v_cvt_pk_bf16_f32 v75, v72, v73
    ds_write_b64 v1, v[74:75] offset:6560
    v_mfma_f32_16x16x32_bf16 a[120:123], v[144:147], v[120:123], a[120:123]
    v_accvgpr_read_b32 v76, a72
    v_accvgpr_read_b32 v77, a73
    v_accvgpr_read_b32 v78, a74
    v_accvgpr_read_b32 v79, a75
    v_mul_f32 v76, v76, v5
    v_mul_f32 v77, v77, v5
    v_mul_f32 v78, v78, v5
    v_mul_f32 v79, v79, v5
    v_cvt_pk_bf16_f32 v80, v76, v77
    v_cvt_pk_bf16_f32 v81, v78, v79
    ds_write_b64 v1, v[80:81] offset:6592
    v_mfma_f32_16x16x32_bf16 a[124:127], v[148:151], v[120:123], a[124:127]
    v_accvgpr_read_b32 v82, a76
    v_accvgpr_read_b32 v83, a77
    v_accvgpr_read_b32 v84, a78
    v_accvgpr_read_b32 v85, a79
    v_mul_f32 v82, v82, v5
    v_mul_f32 v83, v83, v5
    v_mul_f32 v84, v84, v5
    v_mul_f32 v85, v85, v5
    v_cvt_pk_bf16_f32 v86, v82, v83
    v_cvt_pk_bf16_f32 v87, v84, v85
    ds_write_b64 v1, v[86:87] offset:6624
    v_mfma_f32_16x16x32_bf16 a[128:131], v[152:155], v[120:123], a[128:131]
    v_accvgpr_read_b32 v64, a80
    v_accvgpr_read_b32 v65, a81
    v_accvgpr_read_b32 v66, a82
    v_accvgpr_read_b32 v67, a83
    v_mul_f32 v64, v64, v5
    v_mul_f32 v65, v65, v5
    v_mul_f32 v66, v66, v5
    v_mul_f32 v67, v67, v5
    v_cvt_pk_bf16_f32 v68, v64, v65
    v_cvt_pk_bf16_f32 v69, v66, v67
    ds_write_b64 v1, v[68:69] offset:6656
    v_mfma_f32_16x16x32_bf16 a[132:135], v[156:159], v[120:123], a[132:135]
    v_accvgpr_read_b32 v70, a84
    v_accvgpr_read_b32 v71, a85
    v_accvgpr_read_b32 v72, a86
    v_accvgpr_read_b32 v73, a87
    v_mul_f32 v70, v70, v5
    v_mul_f32 v71, v71, v5
    v_mul_f32 v72, v72, v5
    v_mul_f32 v73, v73, v5
    v_cvt_pk_bf16_f32 v74, v70, v71
    v_cvt_pk_bf16_f32 v75, v72, v73
    ds_write_b64 v1, v[74:75] offset:6688
    v_mfma_f32_16x16x32_bf16 a[136:139], v[160:163], v[120:123], a[136:139]
    v_accvgpr_read_b32 v76, a88
    v_accvgpr_read_b32 v77, a89
    v_accvgpr_read_b32 v78, a90
    v_accvgpr_read_b32 v79, a91
    v_mul_f32 v76, v76, v5
    v_mul_f32 v77, v77, v5
    v_mul_f32 v78, v78, v5
    v_mul_f32 v79, v79, v5
    v_cvt_pk_bf16_f32 v80, v76, v77
    v_cvt_pk_bf16_f32 v81, v78, v79
    ds_write_b64 v1, v[80:81] offset:6720
    v_mfma_f32_16x16x32_bf16 a[140:143], v[164:167], v[120:123], a[140:143]
    v_accvgpr_read_b32 v82, a92
    v_accvgpr_read_b32 v83, a93
    v_accvgpr_read_b32 v84, a94
    v_accvgpr_read_b32 v85, a95
    v_mul_f32 v82, v82, v5
    v_mul_f32 v83, v83, v5
    v_mul_f32 v84, v84, v5
    v_mul_f32 v85, v85, v5
    v_cvt_pk_bf16_f32 v86, v82, v83
    v_cvt_pk_bf16_f32 v87, v84, v85
    ds_write_b64 v1, v[86:87] offset:6752
    s_waitcnt lgkmcnt(0)
    ds_read_b128 v[128:131], v3 offset:6400
    ds_read_b128 v[132:135], v253 offset:6400
    ds_read_b128 v[136:139], v254 offset:6400
    ds_read_b128 v[140:143], v3 offset:9600
    ds_read_b128 v[240:243], v253 offset:9600
    ds_read_b128 v[244:247], v254 offset:9600
    s_waitcnt lgkmcnt(5)
    s_mov_b32 s41, 6144
    buffer_store_dwordx4 v[128:131], v2, s[16:19], s41 offen offset:0
    s_waitcnt lgkmcnt(4)
    s_mov_b32 s41, 6144
    buffer_store_dwordx4 v[132:135], v2, s[16:19], s41 offen offset:1024
    s_waitcnt lgkmcnt(3)
    s_mov_b32 s41, 6144
    buffer_store_dwordx4 v[136:139], v2, s[16:19], s41 offen offset:2048
    s_waitcnt lgkmcnt(2)
    s_mov_b32 s41, 9216
    buffer_store_dwordx4 v[140:143], v2, s[16:19], s41 offen offset:0
    s_waitcnt lgkmcnt(1)
    s_mov_b32 s41, 9216
    buffer_store_dwordx4 v[240:243], v2, s[16:19], s41 offen offset:1024
    s_waitcnt lgkmcnt(0)
    s_mov_b32 s41, 9216
    buffer_store_dwordx4 v[244:247], v2, s[16:19], s41 offen offset:2048
    s_nop 7
    v_mfma_f32_16x16x32_bf16 a[144:147], v[192:195], v[124:127], a[144:147]
    v_accvgpr_read_b32 v32, a96
    v_accvgpr_read_b32 v33, a97
    v_accvgpr_read_b32 v34, a98
    v_accvgpr_read_b32 v35, a99
    v_mul_f32 v32, v32, v6
    v_mul_f32 v33, v33, v6
    v_mul_f32 v34, v34, v6
    v_mul_f32 v35, v35, v6
    v_cvt_pk_bf16_f32 v36, v32, v33
    v_cvt_pk_bf16_f32 v37, v34, v35
    ds_write_b64 v1, v[36:37] offset:0
    v_mfma_f32_16x16x32_bf16 a[148:151], v[196:199], v[124:127], a[148:151]
    v_accvgpr_read_b32 v38, a100
    v_accvgpr_read_b32 v39, a101
    v_accvgpr_read_b32 v40, a102
    v_accvgpr_read_b32 v41, a103
    v_mul_f32 v38, v38, v6
    v_mul_f32 v39, v39, v6
    v_mul_f32 v40, v40, v6
    v_mul_f32 v41, v41, v6
    v_cvt_pk_bf16_f32 v42, v38, v39
    v_cvt_pk_bf16_f32 v43, v40, v41
    ds_write_b64 v1, v[42:43] offset:32
    v_mfma_f32_16x16x32_bf16 a[152:155], v[200:203], v[124:127], a[152:155]
    v_accvgpr_read_b32 v44, a104
    v_accvgpr_read_b32 v45, a105
    v_accvgpr_read_b32 v46, a106
    v_accvgpr_read_b32 v47, a107
    v_mul_f32 v44, v44, v6
    v_mul_f32 v45, v45, v6
    v_mul_f32 v46, v46, v6
    v_mul_f32 v47, v47, v6
    v_cvt_pk_bf16_f32 v48, v44, v45
    v_cvt_pk_bf16_f32 v49, v46, v47
    ds_write_b64 v1, v[48:49] offset:64
    v_mfma_f32_16x16x32_bf16 a[156:159], v[204:207], v[124:127], a[156:159]
    v_accvgpr_read_b32 v50, a108
    v_accvgpr_read_b32 v51, a109
    v_accvgpr_read_b32 v52, a110
    v_accvgpr_read_b32 v53, a111
    v_mul_f32 v50, v50, v6
    v_mul_f32 v51, v51, v6
    v_mul_f32 v52, v52, v6
    v_mul_f32 v53, v53, v6
    v_cvt_pk_bf16_f32 v54, v50, v51
    v_cvt_pk_bf16_f32 v55, v52, v53
    ds_write_b64 v1, v[54:55] offset:96
    v_mfma_f32_16x16x32_bf16 a[160:163], v[208:211], v[124:127], a[160:163]
    v_accvgpr_read_b32 v32, a112
    v_accvgpr_read_b32 v33, a113
    v_accvgpr_read_b32 v34, a114
    v_accvgpr_read_b32 v35, a115
    v_mul_f32 v32, v32, v6
    v_mul_f32 v33, v33, v6
    v_mul_f32 v34, v34, v6
    v_mul_f32 v35, v35, v6
    v_cvt_pk_bf16_f32 v36, v32, v33
    v_cvt_pk_bf16_f32 v37, v34, v35
    ds_write_b64 v1, v[36:37] offset:128
    v_mfma_f32_16x16x32_bf16 a[164:167], v[212:215], v[124:127], a[164:167]
    v_accvgpr_read_b32 v38, a116
    v_accvgpr_read_b32 v39, a117
    v_accvgpr_read_b32 v40, a118
    v_accvgpr_read_b32 v41, a119
    v_mul_f32 v38, v38, v6
    v_mul_f32 v39, v39, v6
    v_mul_f32 v40, v40, v6
    v_mul_f32 v41, v41, v6
    v_cvt_pk_bf16_f32 v42, v38, v39
    v_cvt_pk_bf16_f32 v43, v40, v41
    ds_write_b64 v1, v[42:43] offset:160
    v_mfma_f32_16x16x32_bf16 a[168:171], v[144:147], v[124:127], a[168:171]
    v_accvgpr_read_b32 v44, a120
    v_accvgpr_read_b32 v45, a121
    v_accvgpr_read_b32 v46, a122
    v_accvgpr_read_b32 v47, a123
    v_mul_f32 v44, v44, v6
    v_mul_f32 v45, v45, v6
    v_mul_f32 v46, v46, v6
    v_mul_f32 v47, v47, v6
    v_cvt_pk_bf16_f32 v48, v44, v45
    v_cvt_pk_bf16_f32 v49, v46, v47
    ds_write_b64 v1, v[48:49] offset:192
    v_mfma_f32_16x16x32_bf16 a[172:175], v[148:151], v[124:127], a[172:175]
    v_accvgpr_read_b32 v50, a124
    v_accvgpr_read_b32 v51, a125
    v_accvgpr_read_b32 v52, a126
    v_accvgpr_read_b32 v53, a127
    v_mul_f32 v50, v50, v6
    v_mul_f32 v51, v51, v6
    v_mul_f32 v52, v52, v6
    v_mul_f32 v53, v53, v6
    v_cvt_pk_bf16_f32 v54, v50, v51
    v_cvt_pk_bf16_f32 v55, v52, v53
    ds_write_b64 v1, v[54:55] offset:224
    v_mfma_f32_16x16x32_bf16 a[176:179], v[152:155], v[124:127], a[176:179]
    v_accvgpr_read_b32 v32, a128
    v_accvgpr_read_b32 v33, a129
    v_accvgpr_read_b32 v34, a130
    v_accvgpr_read_b32 v35, a131
    v_mul_f32 v32, v32, v6
    v_mul_f32 v33, v33, v6
    v_mul_f32 v34, v34, v6
    v_mul_f32 v35, v35, v6
    v_cvt_pk_bf16_f32 v36, v32, v33
    v_cvt_pk_bf16_f32 v37, v34, v35
    ds_write_b64 v1, v[36:37] offset:256
    v_mfma_f32_16x16x32_bf16 a[180:183], v[156:159], v[124:127], a[180:183]
    v_accvgpr_read_b32 v38, a132
    v_accvgpr_read_b32 v39, a133
    v_accvgpr_read_b32 v40, a134
    v_accvgpr_read_b32 v41, a135
    v_mul_f32 v38, v38, v6
    v_mul_f32 v39, v39, v6
    v_mul_f32 v40, v40, v6
    v_mul_f32 v41, v41, v6
    v_cvt_pk_bf16_f32 v42, v38, v39
    v_cvt_pk_bf16_f32 v43, v40, v41
    ds_write_b64 v1, v[42:43] offset:288
    v_mfma_f32_16x16x32_bf16 a[184:187], v[160:163], v[124:127], a[184:187]
    v_accvgpr_read_b32 v44, a136
    v_accvgpr_read_b32 v45, a137
    v_accvgpr_read_b32 v46, a138
    v_accvgpr_read_b32 v47, a139
    v_mul_f32 v44, v44, v6
    v_mul_f32 v45, v45, v6
    v_mul_f32 v46, v46, v6
    v_mul_f32 v47, v47, v6
    v_cvt_pk_bf16_f32 v48, v44, v45
    v_cvt_pk_bf16_f32 v49, v46, v47
    ds_write_b64 v1, v[48:49] offset:320
    v_mfma_f32_16x16x32_bf16 a[188:191], v[164:167], v[124:127], a[188:191]
    v_accvgpr_read_b32 v50, a140
    v_accvgpr_read_b32 v51, a141
    v_accvgpr_read_b32 v52, a142
    v_accvgpr_read_b32 v53, a143
    v_mul_f32 v50, v50, v6
    v_mul_f32 v51, v51, v6
    v_mul_f32 v52, v52, v6
    v_mul_f32 v53, v53, v6
    v_cvt_pk_bf16_f32 v54, v50, v51
    v_cvt_pk_bf16_f32 v55, v52, v53
    ds_write_b64 v1, v[54:55] offset:352
    s_waitcnt lgkmcnt(0)
    ds_read_b128 v[216:219], v3 offset:0
    ds_read_b128 v[220:223], v253 offset:0
    ds_read_b128 v[224:227], v254 offset:0
    ds_read_b128 v[228:231], v3 offset:3200
    ds_read_b128 v[232:235], v253 offset:3200
    ds_read_b128 v[236:239], v254 offset:3200
    s_waitcnt lgkmcnt(5)
    s_mov_b32 s41, 12288
    buffer_store_dwordx4 v[216:219], v2, s[16:19], s41 offen offset:0
    s_waitcnt lgkmcnt(4)
    s_mov_b32 s41, 12288
    buffer_store_dwordx4 v[220:223], v2, s[16:19], s41 offen offset:1024
    s_waitcnt lgkmcnt(3)
    s_mov_b32 s41, 12288
    buffer_store_dwordx4 v[224:227], v2, s[16:19], s41 offen offset:2048
    s_waitcnt lgkmcnt(2)
    s_mov_b32 s41, 15360
    buffer_store_dwordx4 v[228:231], v2, s[16:19], s41 offen offset:0
    s_waitcnt lgkmcnt(1)
    s_mov_b32 s41, 15360
    buffer_store_dwordx4 v[232:235], v2, s[16:19], s41 offen offset:1024
    s_waitcnt lgkmcnt(0)
    s_mov_b32 s41, 15360
    buffer_store_dwordx4 v[236:239], v2, s[16:19], s41 offen offset:2048
    s_nop 7
    v_accvgpr_read_b32 v64, a144
    v_accvgpr_read_b32 v65, a145
    v_accvgpr_read_b32 v66, a146
    v_accvgpr_read_b32 v67, a147
    v_mul_f32 v64, v64, v7
    v_mul_f32 v65, v65, v7
    v_mul_f32 v66, v66, v7
    v_mul_f32 v67, v67, v7
    v_cvt_pk_bf16_f32 v68, v64, v65
    v_cvt_pk_bf16_f32 v69, v66, v67
    ds_write_b64 v1, v[68:69] offset:6400
    v_accvgpr_read_b32 v70, a148
    v_accvgpr_read_b32 v71, a149
    v_accvgpr_read_b32 v72, a150
    v_accvgpr_read_b32 v73, a151
    v_mul_f32 v70, v70, v7
    v_mul_f32 v71, v71, v7
    v_mul_f32 v72, v72, v7
    v_mul_f32 v73, v73, v7
    v_cvt_pk_bf16_f32 v74, v70, v71
    v_cvt_pk_bf16_f32 v75, v72, v73
    ds_write_b64 v1, v[74:75] offset:6432
    v_accvgpr_read_b32 v76, a152
    v_accvgpr_read_b32 v77, a153
    v_accvgpr_read_b32 v78, a154
    v_accvgpr_read_b32 v79, a155
    v_mul_f32 v76, v76, v7
    v_mul_f32 v77, v77, v7
    v_mul_f32 v78, v78, v7
    v_mul_f32 v79, v79, v7
    v_cvt_pk_bf16_f32 v80, v76, v77
    v_cvt_pk_bf16_f32 v81, v78, v79
    ds_write_b64 v1, v[80:81] offset:6464
    v_accvgpr_read_b32 v82, a156
    v_accvgpr_read_b32 v83, a157
    v_accvgpr_read_b32 v84, a158
    v_accvgpr_read_b32 v85, a159
    v_mul_f32 v82, v82, v7
    v_mul_f32 v83, v83, v7
    v_mul_f32 v84, v84, v7
    v_mul_f32 v85, v85, v7
    v_cvt_pk_bf16_f32 v86, v82, v83
    v_cvt_pk_bf16_f32 v87, v84, v85
    ds_write_b64 v1, v[86:87] offset:6496
    v_accvgpr_read_b32 v64, a160
    v_accvgpr_read_b32 v65, a161
    v_accvgpr_read_b32 v66, a162
    v_accvgpr_read_b32 v67, a163
    v_mul_f32 v64, v64, v7
    v_mul_f32 v65, v65, v7
    v_mul_f32 v66, v66, v7
    v_mul_f32 v67, v67, v7
    v_cvt_pk_bf16_f32 v68, v64, v65
    v_cvt_pk_bf16_f32 v69, v66, v67
    ds_write_b64 v1, v[68:69] offset:6528
    v_accvgpr_read_b32 v70, a164
    v_accvgpr_read_b32 v71, a165
    v_accvgpr_read_b32 v72, a166
    v_accvgpr_read_b32 v73, a167
    v_mul_f32 v70, v70, v7
    v_mul_f32 v71, v71, v7
    v_mul_f32 v72, v72, v7
    v_mul_f32 v73, v73, v7
    v_cvt_pk_bf16_f32 v74, v70, v71
    v_cvt_pk_bf16_f32 v75, v72, v73
    ds_write_b64 v1, v[74:75] offset:6560
    v_accvgpr_read_b32 v76, a168
    v_accvgpr_read_b32 v77, a169
    v_accvgpr_read_b32 v78, a170
    v_accvgpr_read_b32 v79, a171
    v_mul_f32 v76, v76, v7
    v_mul_f32 v77, v77, v7
    v_mul_f32 v78, v78, v7
    v_mul_f32 v79, v79, v7
    v_cvt_pk_bf16_f32 v80, v76, v77
    v_cvt_pk_bf16_f32 v81, v78, v79
    ds_write_b64 v1, v[80:81] offset:6592
    v_accvgpr_read_b32 v82, a172
    v_accvgpr_read_b32 v83, a173
    v_accvgpr_read_b32 v84, a174
    v_accvgpr_read_b32 v85, a175
    v_mul_f32 v82, v82, v7
    v_mul_f32 v83, v83, v7
    v_mul_f32 v84, v84, v7
    v_mul_f32 v85, v85, v7
    v_cvt_pk_bf16_f32 v86, v82, v83
    v_cvt_pk_bf16_f32 v87, v84, v85
    ds_write_b64 v1, v[86:87] offset:6624
    v_accvgpr_read_b32 v64, a176
    v_accvgpr_read_b32 v65, a177
    v_accvgpr_read_b32 v66, a178
    v_accvgpr_read_b32 v67, a179
    v_mul_f32 v64, v64, v7
    v_mul_f32 v65, v65, v7
    v_mul_f32 v66, v66, v7
    v_mul_f32 v67, v67, v7
    v_cvt_pk_bf16_f32 v68, v64, v65
    v_cvt_pk_bf16_f32 v69, v66, v67
    ds_write_b64 v1, v[68:69] offset:6656
    v_accvgpr_read_b32 v70, a180
    v_accvgpr_read_b32 v71, a181
    v_accvgpr_read_b32 v72, a182
    v_accvgpr_read_b32 v73, a183
    v_mul_f32 v70, v70, v7
    v_mul_f32 v71, v71, v7
    v_mul_f32 v72, v72, v7
    v_mul_f32 v73, v73, v7
    v_cvt_pk_bf16_f32 v74, v70, v71
    v_cvt_pk_bf16_f32 v75, v72, v73
    ds_write_b64 v1, v[74:75] offset:6688
    v_accvgpr_read_b32 v76, a184
    v_accvgpr_read_b32 v77, a185
    v_accvgpr_read_b32 v78, a186
    v_accvgpr_read_b32 v79, a187
    v_mul_f32 v76, v76, v7
    v_mul_f32 v77, v77, v7
    v_mul_f32 v78, v78, v7
    v_mul_f32 v79, v79, v7
    v_cvt_pk_bf16_f32 v80, v76, v77
    v_cvt_pk_bf16_f32 v81, v78, v79
    ds_write_b64 v1, v[80:81] offset:6720
    v_accvgpr_read_b32 v82, a188
    v_accvgpr_read_b32 v83, a189
    v_accvgpr_read_b32 v84, a190
    v_accvgpr_read_b32 v85, a191
    v_mul_f32 v82, v82, v7
    v_mul_f32 v83, v83, v7
    v_mul_f32 v84, v84, v7
    v_mul_f32 v85, v85, v7
    v_cvt_pk_bf16_f32 v86, v82, v83
    v_cvt_pk_bf16_f32 v87, v84, v85
    ds_write_b64 v1, v[86:87] offset:6752
    s_waitcnt lgkmcnt(0)
    ds_read_b128 v[128:131], v3 offset:6400
    ds_read_b128 v[132:135], v253 offset:6400
    ds_read_b128 v[136:139], v254 offset:6400
    ds_read_b128 v[140:143], v3 offset:9600
    ds_read_b128 v[240:243], v253 offset:9600
    ds_read_b128 v[244:247], v254 offset:9600
    s_waitcnt lgkmcnt(5)
    s_mov_b32 s41, 18432
    buffer_store_dwordx4 v[128:131], v2, s[16:19], s41 offen offset:0
    s_waitcnt lgkmcnt(4)
    s_mov_b32 s41, 18432
    buffer_store_dwordx4 v[132:135], v2, s[16:19], s41 offen offset:1024
    s_waitcnt lgkmcnt(3)
    s_mov_b32 s41, 18432
    buffer_store_dwordx4 v[136:139], v2, s[16:19], s41 offen offset:2048
    s_waitcnt lgkmcnt(2)
    s_mov_b32 s41, 21504
    buffer_store_dwordx4 v[140:143], v2, s[16:19], s41 offen offset:0
    s_waitcnt lgkmcnt(1)
    s_mov_b32 s41, 21504
    buffer_store_dwordx4 v[240:243], v2, s[16:19], s41 offen offset:1024
    s_waitcnt lgkmcnt(0)
    s_mov_b32 s41, 21504
    buffer_store_dwordx4 v[244:247], v2, s[16:19], s41 offen offset:2048
Z_end:
    s_endpgm
Z_call0:
    s_mov_b32 s37, 0
    s_branch Z_fb0
Z_call1:
    s_mov_b32 s37, 1
    s_branch Z_fb1
Z_call2:
    s_mov_b32 s37, 2
    s_branch Z_fb0
Z_call3:
    s_mov_b32 s37, 3
    s_branch Z_fb1
Z_callL:
    s_branch Z_fbL
Z_fb0:
    s_nop 7
    s_nop 7
    v_max3_f32 v29, v32, v33, v34
    v_max3_f32 v29, v29, v35, v48
    v_max3_f32 v29, v29, v49, v50
    v_max_f32 v29, v29, v51
    v_mov_b32 v30, v29
    s_nop 1
    v_permlane16_swap_b32 v29, v30
    s_nop 1
    v_max_f32 v29, v29, v30
    v_mov_b32 v30, v29
    s_nop 1
    v_permlane32_swap_b32 v29, v30
    s_nop 1
    v_max_f32 v29, v29, v30
    v_max_f32 v29, 0, v29
    v_sub_f32 v128, v128, v29
    v_sub_f32 v32, v32, v29
    v_sub_f32 v48, v48, v29
    v_sub_f32 v64, v64, v29
    v_sub_f32 v80, v80, v29
    v_sub_f32 v129, v129, v29
    v_sub_f32 v33, v33, v29
    v_sub_f32 v49, v49, v29
    v_sub_f32 v65, v65, v29
    v_sub_f32 v81, v81, v29
    v_sub_f32 v130, v130, v29
    v_sub_f32 v34, v34, v29
    v_sub_f32 v50, v50, v29
    v_sub_f32 v66, v66, v29
    v_sub_f32 v82, v82, v29
    v_sub_f32 v131, v131, v29
    v_sub_f32 v35, v35, v29
    v_sub_f32 v51, v51, v29
    v_sub_f32 v67, v67, v29
    v_sub_f32 v83, v83, v29
    v_sub_f32 v30, 0, v29
    v_exp_f32 v30, v30
    s_nop 0
    v_mul_f32 v4, v4, v30
    v_accvgpr_read_b32 v31, a0
    v_mul_f32 v31, v31, v30
    v_accvgpr_write_b32 a0, v31
    v_accvgpr_read_b32 v31, a1
    v_mul_f32 v31, v31, v30
    v_accvgpr_write_b32 a1, v31
    v_accvgpr_read_b32 v31, a2
    v_mul_f32 v31, v31, v30
    v_accvgpr_write_b32 a2, v31
    v_accvgpr_read_b32 v31, a3
    v_mul_f32 v31, v31, v30
    v_accvgpr_write_b32 a3, v31
    v_accvgpr_read_b32 v31, a4
    v_mul_f32 v31, v31, v30
    v_accvgpr_write_b32 a4, v31
    v_accvgpr_read_b32 v31, a5
    v_mul_f32 v31, v31, v30
    v_accvgpr_write_b32 a5, v31
    v_accvgpr_read_b32 v31, a6
    v_mul_f32 v31, v31, v30
    v_accvgpr_write_b32 a6, v31
    v_accvgpr_read_b32 v31, a7
    v_mul_f32 v31, v31, v30
    v_accvgpr_write_b32 a7, v31
    v_accvgpr_read_b32 v31, a8
    v_mul_f32 v31, v31, v30
    v_accvgpr_write_b32 a8, v31
    v_accvgpr_read_b32 v31, a9
    v_mul_f32 v31, v31, v30
    v_accvgpr_write_b32 a9, v31
    v_accvgpr_read_b32 v31, a10
    v_mul_f32 v31, v31, v30
    v_accvgpr_write_b32 a10, v31
    v_accvgpr_read_b32 v31, a11
    v_mul_f32 v31, v31, v30
    v_accvgpr_write_b32 a11, v31
    v_accvgpr_read_b32 v31, a12
    v_mul_f32 v31, v31, v30
    v_accvgpr_write_b32 a12, v31
    v_accvgpr_read_b32 v31, a13
    v_mul_f32 v31, v31, v30
    v_accvgpr_write_b32 a13, v31
    v_accvgpr_read_b32 v31, a14
    v_mul_f32 v31, v31, v30
    v_accvgpr_write_b32 a14, v31
    v_accvgpr_read_b32 v31, a15
    v_mul_f32 v31, v31, v30
    v_accvgpr_write_b32 a15, v31
    v_accvgpr_read_b32 v31, a16
    v_mul_f32 v31, v31, v30
    v_accvgpr_write_b32 a16, v31
    v_accvgpr_read_b32 v31, a17
    v_mul_f32 v31, v31, v30
    v_accvgpr_write_b32 a17, v31
    v_accvgpr_read_b32 v31, a18
    v_mul_f32 v31, v31, v30
    v_accvgpr_write_b32 a18, v31
    v_accvgpr_read_b32 v31, a19
    v_mul_f32 v31, v31, v30
    v_accvgpr_write_b32 a19, v31
    v_accvgpr_read_b32 v31, a20
    v_mul_f32 v31, v31, v30
    v_accvgpr_write_b32 a20, v31
    v_accvgpr_read_b32 v31, a21
    v_mul_f32 v31, v31, v30
    v_accvgpr_write_b32 a21, v31
    v_accvgpr_read_b32 v31, a22
    v_mul_f32 v31, v31, v30
    v_accvgpr_write_b32 a22, v31
    v_accvgpr_read_b32 v31, a23
    v_mul_f32 v31, v31, v30
    v_accvgpr_write_b32 a23, v31
    v_accvgpr_read_b32 v31, a24
    v_mul_f32 v31, v31, v30
    v_accvgpr_write_b32 a24, v31
    v_accvgpr_read_b32 v31, a25
    v_mul_f32 v31, v31, v30
    v_accvgpr_write_b32 a25, v31
    v_accvgpr_read_b32 v31, a26
    v_mul_f32 v31, v31, v30
    v_accvgpr_write_b32 a26, v31
    v_accvgpr_read_b32 v31, a27
    v_mul_f32 v31, v31, v30
    v_accvgpr_write_b32 a27, v31
    v_accvgpr_read_b32 v31, a28
    v_mul_f32 v31, v31, v30
    v_accvgpr_write_b32 a28, v31
    v_accvgpr_read_b32 v31, a29
    v_mul_f32 v31, v31, v30
    v_accvgpr_write_b32 a29, v31
    v_accvgpr_read_b32 v31, a30
    v_mul_f32 v31, v31, v30
    v_accvgpr_write_b32 a30, v31
    v_accvgpr_read_b32 v31, a31
    v_mul_f32 v31, v31, v30
    v_accvgpr_write_b32 a31, v31
    v_accvgpr_read_b32 v31, a32
    v_mul_f32 v31, v31, v30
    v_accvgpr_write_b32 a32, v31
    v_accvgpr_read_b32 v31, a33
    v_mul_f32 v31, v31, v30
    v_accvgpr_write_b32 a33, v31
    v_accvgpr_read_b32 v31, a34
    v_mul_f32 v31, v31, v30
    v_accvgpr_write_b32 a34, v31
    v_accvgpr_read_b32 v31, a35
    v_mul_f32 v31, v31, v30
    v_accvgpr_write_b32 a35, v31
    v_accvgpr_read_b32 v31, a36
    v_mul_f32 v31, v31, v30
    v_accvgpr_write_b32 a36, v31
    v_accvgpr_read_b32 v31, a37
    v_mul_f32 v31, v31, v30
    v_accvgpr_write_b32 a37, v31
    v_accvgpr_read_b32 v31, a38
    v_mul_f32 v31, v31, v30
    v_accvgpr_write_b32 a38, v31
    v_accvgpr_read_b32 v31, a39
    v_mul_f32 v31, v31, v30
    v_accvgpr_write_b32 a39, v31
    v_accvgpr_read_b32 v31, a40
    v_mul_f32 v31, v31, v30
    v_accvgpr_write_b32 a40, v31
    v_accvgpr_read_b32 v31, a41
    v_mul_f32 v31, v31, v30
    v_accvgpr_write_b32 a41, v31
    v_accvgpr_read_b32 v31, a42
    v_mul_f32 v31, v31, v30
    v_accvgpr_write_b32 a42, v31
    v_accvgpr_read_b32 v31, a43
    v_mul_f32 v31, v31, v30
    v_accvgpr_write_b32 a43, v31
    v_accvgpr_read_b32 v31, a44
    v_mul_f32 v31, v31, v30
    v_accvgpr_write_b32 a44, v31
    v_accvgpr_read_b32 v31, a45
    v_mul_f32 v31, v31, v30
    v_accvgpr_write_b32 a45, v31
    v_accvgpr_read_b32 v31, a46
    v_mul_f32 v31, v31, v30
    v_accvgpr_write_b32 a46, v31
    v_accvgpr_read_b32 v31, a47
    v_mul_f32 v31, v31, v30
    v_accvgpr_write_b32 a47, v31
    v_exp_f32 v12, v32
    v_exp_f32 v13, v33
    v_exp_f32 v14, v34
    v_exp_f32 v15, v35
    v_exp_f32 v16, v48
    v_exp_f32 v17, v49
    v_exp_f32 v18, v50
    v_exp_f32 v19, v51
    s_nop 0
    v_add_f32 v8, v12, v13
    v_add_f32 v8, v8, v14
    v_add_f32 v8, v8, v15
    v_add_f32 v8, v8, v16
    v_add_f32 v8, v8, v17
    v_add_f32 v8, v8, v18
    v_add_f32 v8, v8, v19
    v_cvt_pk_bf16_f32 v96, v12, v13
    v_cvt_pk_bf16_f32 v97, v14, v15
    v_cvt_pk_bf16_f32 v98, v16, v17
    v_cvt_pk_bf16_f32 v99, v18, v19
    v_max3_f32 v29, v36, v37, v38
    v_max3_f32 v29, v29, v39, v52
    v_max3_f32 v29, v29, v53, v54
    v_max_f32 v29, v29, v55
    v_mov_b32 v30, v29
    s_nop 1
    v_permlane16_swap_b32 v29, v30
    s_nop 1
    v_max_f32 v29, v29, v30
    v_mov_b32 v30, v29
    s_nop 1
    v_permlane32_swap_b32 v29, v30
    s_nop 1
    v_max_f32 v29, v29, v30
    v_max_f32 v29, 0, v29
    v_sub_f32 v132, v132, v29
    v_sub_f32 v36, v36, v29
    v_sub_f32 v52, v52, v29
    v_sub_f32 v68, v68, v29
    v_sub_f32 v84, v84, v29
    v_sub_f32 v133, v133, v29
    v_sub_f32 v37, v37, v29
    v_sub_f32 v53, v53, v29
    v_sub_f32 v69, v69, v29
    v_sub_f32 v85, v85, v29
    v_sub_f32 v134, v134, v29
    v_sub_f32 v38, v38, v29
    v_sub_f32 v54, v54, v29
    v_sub_f32 v70, v70, v29
    v_sub_f32 v86, v86, v29
    v_sub_f32 v135, v135, v29
    v_sub_f32 v39, v39, v29
    v_sub_f32 v55, v55, v29
    v_sub_f32 v71, v71, v29
    v_sub_f32 v87, v87, v29
    v_sub_f32 v30, 0, v29
    v_exp_f32 v30, v30
    s_nop 0
    v_mul_f32 v5, v5, v30
    v_accvgpr_read_b32 v31, a48
    v_mul_f32 v31, v31, v30
    v_accvgpr_write_b32 a48, v31
    v_accvgpr_read_b32 v31, a49
    v_mul_f32 v31, v31, v30
    v_accvgpr_write_b32 a49, v31
    v_accvgpr_read_b32 v31, a50
    v_mul_f32 v31, v31, v30
    v_accvgpr_write_b32 a50, v31
    v_accvgpr_read_b32 v31, a51
    v_mul_f32 v31, v31, v30
    v_accvgpr_write_b32 a51, v31
    v_accvgpr_read_b32 v31, a52
    v_mul_f32 v31, v31, v30
    v_accvgpr_write_b32 a52, v31
    v_accvgpr_read_b32 v31, a53
    v_mul_f32 v31, v31, v30
    v_accvgpr_write_b32 a53, v31
    v_accvgpr_read_b32 v31, a54
    v_mul_f32 v31, v31, v30
    v_accvgpr_write_b32 a54, v31
    v_accvgpr_read_b32 v31, a55
    v_mul_f32 v31, v31, v30
    v_accvgpr_write_b32 a55, v31
    v_accvgpr_read_b32 v31, a56
    v_mul_f32 v31, v31, v30
    v_accvgpr_write_b32 a56, v31
    v_accvgpr_read_b32 v31, a57
    v_mul_f32 v31, v31, v30
    v_accvgpr_write_b32 a57, v31
    v_accvgpr_read_b32 v31, a58
    v_mul_f32 v31, v31, v30
    v_accvgpr_write_b32 a58, v31
    v_accvgpr_read_b32 v31, a59
    v_mul_f32 v31, v31, v30
    v_accvgpr_write_b32 a59, v31
    v_accvgpr_read_b32 v31, a60
    v_mul_f32 v31, v31, v30
    v_accvgpr_write_b32 a60, v31
    v_accvgpr_read_b32 v31, a61
    v_mul_f32 v31, v31, v30
    v_accvgpr_write_b32 a61, v31
    v_accvgpr_read_b32 v31, a62
    v_mul_f32 v31, v31, v30
    v_accvgpr_write_b32 a62, v31
    v_accvgpr_read_b32 v31, a63
    v_mul_f32 v31, v31, v30
    v_accvgpr_write_b32 a63, v31
    v_accvgpr_read_b32 v31, a64
    v_mul_f32 v31, v31, v30
    v_accvgpr_write_b32 a64, v31
    v_accvgpr_read_b32 v31, a65
    v_mul_f32 v31, v31, v30
    v_accvgpr_write_b32 a65, v31
    v_accvgpr_read_b32 v31, a66
    v_mul_f32 v31, v31, v30
    v_accvgpr_write_b32 a66, v31
    v_accvgpr_read_b32 v31, a67
    v_mul_f32 v31, v31, v30
    v_accvgpr_write_b32 a67, v31
    v_accvgpr_read_b32 v31, a68
    v_mul_f32 v31, v31, v30
    v_accvgpr_write_b32 a68, v31
    v_accvgpr_read_b32 v31, a69
    v_mul_f32 v31, v31, v30
    v_accvgpr_write_b32 a69, v31
    v_accvgpr_read_b32 v31, a70
    v_mul_f32 v31, v31, v30
    v_accvgpr_write_b32 a70, v31
    v_accvgpr_read_b32 v31, a71
    v_mul_f32 v31, v31, v30
    v_accvgpr_write_b32 a71, v31
    v_accvgpr_read_b32 v31, a72
    v_mul_f32 v31, v31, v30
    v_accvgpr_write_b32 a72, v31
    v_accvgpr_read_b32 v31, a73
    v_mul_f32 v31, v31, v30
    v_accvgpr_write_b32 a73, v31
    v_accvgpr_read_b32 v31, a74
    v_mul_f32 v31, v31, v30
    v_accvgpr_write_b32 a74, v31
    v_accvgpr_read_b32 v31, a75
    v_mul_f32 v31, v31, v30
    v_accvgpr_write_b32 a75, v31
    v_accvgpr_read_b32 v31, a76
    v_mul_f32 v31, v31, v30
    v_accvgpr_write_b32 a76, v31
    v_accvgpr_read_b32 v31, a77
    v_mul_f32 v31, v31, v30
    v_accvgpr_write_b32 a77, v31
    v_accvgpr_read_b32 v31, a78
    v_mul_f32 v31, v31, v30
    v_accvgpr_write_b32 a78, v31
    v_accvgpr_read_b32 v31, a79
    v_mul_f32 v31, v31, v30
    v_accvgpr_write_b32 a79, v31
    v_accvgpr_read_b32 v31, a80
    v_mul_f32 v31, v31, v30
    v_accvgpr_write_b32 a80, v31
    v_accvgpr_read_b32 v31, a81
    v_mul_f32 v31, v31, v30
    v_accvgpr_write_b32 a81, v31
    v_accvgpr_read_b32 v31, a82
    v_mul_f32 v31, v31, v30
    v_accvgpr_write_b32 a82, v31
    v_accvgpr_read_b32 v31, a83
    v_mul_f32 v31, v31, v30
    v_accvgpr_write_b32 a83, v31
    v_accvgpr_read_b32 v31, a84
    v_mul_f32 v31, v31, v30
    v_accvgpr_write_b32 a84, v31
    v_accvgpr_read_b32 v31, a85
    v_mul_f32 v31, v31, v30
    v_accvgpr_write_b32 a85, v31
    v_accvgpr_read_b32 v31, a86
    v_mul_f32 v31, v31, v30
    v_accvgpr_write_b32 a86, v31
    v_accvgpr_read_b32 v31, a87
    v_mul_f32 v31, v31, v30
    v_accvgpr_write_b32 a87, v31
    v_accvgpr_read_b32 v31, a88
    v_mul_f32 v31, v31, v30
    v_accvgpr_write_b32 a88, v31
    v_accvgpr_read_b32 v31, a89
    v_mul_f32 v31, v31, v30
    v_accvgpr_write_b32 a89, v31
    v_accvgpr_read_b32 v31, a90
    v_mul_f32 v31, v31, v30
    v_accvgpr_write_b32 a90, v31
    v_accvgpr_read_b32 v31, a91
    v_mul_f32 v31, v31, v30
    v_accvgpr_write_b32 a91, v31
    v_accvgpr_read_b32 v31, a92
    v_mul_f32 v31, v31, v30
    v_accvgpr_write_b32 a92, v31
    v_accvgpr_read_b32 v31, a93
    v_mul_f32 v31, v31, v30
    v_accvgpr_write_b32 a93, v31
    v_accvgpr_read_b32 v31, a94
    v_mul_f32 v31, v31, v30
    v_accvgpr_write_b32 a94, v31
    v_accvgpr_read_b32 v31, a95
    v_mul_f32 v31, v31, v30
    v_accvgpr_write_b32 a95, v31
    v_exp_f32 v12, v36
    v_exp_f32 v13, v37
    v_exp_f32 v14, v38
    v_exp_f32 v15, v39
    v_exp_f32 v16, v52
    v_exp_f32 v17, v53
    v_exp_f32 v18, v54
    v_exp_f32 v19, v55
    s_nop 0
    v_add_f32 v9, v12, v13
    v_add_f32 v9, v9, v14
    v_add_f32 v9, v9, v15
    v_add_f32 v9, v9, v16
    v_add_f32 v9, v9, v17
    v_add_f32 v9, v9, v18
    v_add_f32 v9, v9, v19
    v_cvt_pk_bf16_f32 v100, v12, v13
    v_cvt_pk_bf16_f32 v101, v14, v15
    v_cvt_pk_bf16_f32 v102, v16, v17
    v_cvt_pk_bf16_f32 v103, v18, v19
    v_max3_f32 v29, v40, v41, v42
    v_max3_f32 v29, v29, v43, v56
    v_max3_f32 v29, v29, v57, v58
    v_max_f32 v29, v29, v59
    v_mov_b32 v30, v29
    s_nop 1
    v_permlane16_swap_b32 v29, v30
    s_nop 1
    v_max_f32 v29, v29, v30
    v_mov_b32 v30, v29
    s_nop 1
    v_permlane32_swap_b32 v29, v30
    s_nop 1
    v_max_f32 v29, v29, v30
    v_max_f32 v29, 0, v29
    v_sub_f32 v136, v136, v29
    v_sub_f32 v40, v40, v29
    v_sub_f32 v56, v56, v29
    v_sub_f32 v72, v72, v29
    v_sub_f32 v88, v88, v29
    v_sub_f32 v137, v137, v29
    v_sub_f32 v41, v41, v29
    v_sub_f32 v57, v57, v29
    v_sub_f32 v73, v73, v29
    v_sub_f32 v89, v89, v29
    v_sub_f32 v138, v138, v29
    v_sub_f32 v42, v42, v29
    v_sub_f32 v58, v58, v29
    v_sub_f32 v74, v74, v29
    v_sub_f32 v90, v90, v29
    v_sub_f32 v139, v139, v29
    v_sub_f32 v43, v43, v29
    v_sub_f32 v59, v59, v29
    v_sub_f32 v75, v75, v29
    v_sub_f32 v91, v91, v29
    v_sub_f32 v30, 0, v29
    v_exp_f32 v30, v30
    s_nop 0
    v_mul_f32 v6, v6, v30
    v_accvgpr_read_b32 v31, a96
    v_mul_f32 v31, v31, v30
    v_accvgpr_write_b32 a96, v31
    v_accvgpr_read_b32 v31, a97
    v_mul_f32 v31, v31, v30
    v_accvgpr_write_b32 a97, v31
    v_accvgpr_read_b32 v31, a98
    v_mul_f32 v31, v31, v30
    v_accvgpr_write_b32 a98, v31
    v_accvgpr_read_b32 v31, a99
    v_mul_f32 v31, v31, v30
    v_accvgpr_write_b32 a99, v31
    v_accvgpr_read_b32 v31, a100
    v_mul_f32 v31, v31, v30
    v_accvgpr_write_b32 a100, v31
    v_accvgpr_read_b32 v31, a101
    v_mul_f32 v31, v31, v30
    v_accvgpr_write_b32 a101, v31
    v_accvgpr_read_b32 v31, a102
    v_mul_f32 v31, v31, v30
    v_accvgpr_write_b32 a102, v31
    v_accvgpr_read_b32 v31, a103
    v_mul_f32 v31, v31, v30
    v_accvgpr_write_b32 a103, v31
    v_accvgpr_read_b32 v31, a104
    v_mul_f32 v31, v31, v30
    v_accvgpr_write_b32 a104, v31
    v_accvgpr_read_b32 v31, a105
    v_mul_f32 v31, v31, v30
    v_accvgpr_write_b32 a105, v31
    v_accvgpr_read_b32 v31, a106
    v_mul_f32 v31, v31, v30
    v_accvgpr_write_b32 a106, v31
    v_accvgpr_read_b32 v31, a107
    v_mul_f32 v31, v31, v30
    v_accvgpr_write_b32 a107, v31
    v_accvgpr_read_b32 v31, a108
    v_mul_f32 v31, v31, v30
    v_accvgpr_write_b32 a108, v31
    v_accvgpr_read_b32 v31, a109
    v_mul_f32 v31, v31, v30
    v_accvgpr_write_b32 a109, v31
    v_accvgpr_read_b32 v31, a110
    v_mul_f32 v31, v31, v30
    v_accvgpr_write_b32 a110, v31
    v_accvgpr_read_b32 v31, a111
    v_mul_f32 v31, v31, v30
    v_accvgpr_write_b32 a111, v31
    v_accvgpr_read_b32 v31, a112
    v_mul_f32 v31, v31, v30
    v_accvgpr_write_b32 a112, v31
    v_accvgpr_read_b32 v31, a113
    v_mul_f32 v31, v31, v30
    v_accvgpr_write_b32 a113, v31
    v_accvgpr_read_b32 v31, a114
    v_mul_f32 v31, v31, v30
    v_accvgpr_write_b32 a114, v31
    v_accvgpr_read_b32 v31, a115
    v_mul_f32 v31, v31, v30
    v_accvgpr_write_b32 a115, v31
    v_accvgpr_read_b32 v31, a116
    v_mul_f32 v31, v31, v30
    v_accvgpr_write_b32 a116, v31
    v_accvgpr_read_b32 v31, a117
    v_mul_f32 v31, v31, v30
    v_accvgpr_write_b32 a117, v31
    v_accvgpr_read_b32 v31, a118
    v_mul_f32 v31, v31, v30
    v_accvgpr_write_b32 a118, v31
    v_accvgpr_read_b32 v31, a119
    v_mul_f32 v31, v31, v30
    v_accvgpr_write_b32 a119, v31
    v_accvgpr_read_b32 v31, a120
    v_mul_f32 v31, v31, v30
    v_accvgpr_write_b32 a120, v31
    v_accvgpr_read_b32 v31, a121
    v_mul_f32 v31, v31, v30
    v_accvgpr_write_b32 a121, v31
    v_accvgpr_read_b32 v31, a122
    v_mul_f32 v31, v31, v30
    v_accvgpr_write_b32 a122, v31
    v_accvgpr_read_b32 v31, a123
    v_mul_f32 v31, v31, v30
    v_accvgpr_write_b32 a123, v31
    v_accvgpr_read_b32 v31, a124
    v_mul_f32 v31, v31, v30
    v_accvgpr_write_b32 a124, v31
    v_accvgpr_read_b32 v31, a125
    v_mul_f32 v31, v31, v30
    v_accvgpr_write_b32 a125, v31
    v_accvgpr_read_b32 v31, a126
    v_mul_f32 v31, v31, v30
    v_accvgpr_write_b32 a126, v31
    v_accvgpr_read_b32 v31, a127
    v_mul_f32 v31, v31, v30
    v_accvgpr_write_b32 a127, v31
    v_accvgpr_read_b32 v31, a128
    v_mul_f32 v31, v31, v30
    v_accvgpr_write_b32 a128, v31
    v_accvgpr_read_b32 v31, a129
    v_mul_f32 v31, v31, v30
    v_accvgpr_write_b32 a129, v31
    v_accvgpr_read_b32 v31, a130
    v_mul_f32 v31, v31, v30
    v_accvgpr_write_b32 a130, v31
    v_accvgpr_read_b32 v31, a131
    v_mul_f32 v31, v31, v30
    v_accvgpr_write_b32 a131, v31
    v_accvgpr_read_b32 v31, a132
    v_mul_f32 v31, v31, v30
    v_accvgpr_write_b32 a132, v31
    v_accvgpr_read_b32 v31, a133
    v_mul_f32 v31, v31, v30
    v_accvgpr_write_b32 a133, v31
    v_accvgpr_read_b32 v31, a134
    v_mul_f32 v31, v31, v30
    v_accvgpr_write_b32 a134, v31
    v_accvgpr_read_b32 v31, a135
    v_mul_f32 v31, v31, v30
    v_accvgpr_write_b32 a135, v31
    v_accvgpr_read_b32 v31, a136
    v_mul_f32 v31, v31, v30
    v_accvgpr_write_b32 a136, v31
    v_accvgpr_read_b32 v31, a137
    v_mul_f32 v31, v31, v30
    v_accvgpr_write_b32 a137, v31
    v_accvgpr_read_b32 v31, a138
    v_mul_f32 v31, v31, v30
    v_accvgpr_write_b32 a138, v31
    v_accvgpr_read_b32 v31, a139
    v_mul_f32 v31, v31, v30
    v_accvgpr_write_b32 a139, v31
    v_accvgpr_read_b32 v31, a140
    v_mul_f32 v31, v31, v30
    v_accvgpr_write_b32 a140, v31
    v_accvgpr_read_b32 v31, a141
    v_mul_f32 v31, v31, v30
    v_accvgpr_write_b32 a141, v31
    v_accvgpr_read_b32 v31, a142
    v_mul_f32 v31, v31, v30
    v_accvgpr_write_b32 a142, v31
    v_accvgpr_read_b32 v31, a143
    v_mul_f32 v31, v31, v30
    v_accvgpr_write_b32 a143, v31
    v_exp_f32 v12, v40
    v_exp_f32 v13, v41
    v_exp_f32 v14, v42
    v_exp_f32 v15, v43
    v_exp_f32 v16, v56
    v_exp_f32 v17, v57
    v_exp_f32 v18, v58
    v_exp_f32 v19, v59
    s_nop 0
    v_add_f32 v10, v12, v13
    v_add_f32 v10, v10, v14
    v_add_f32 v10, v10, v15
    v_add_f32 v10, v10, v16
    v_add_f32 v10, v10, v17
    v_add_f32 v10, v10, v18
    v_add_f32 v10, v10, v19
    v_cvt_pk_bf16_f32 v104, v12, v13
    v_cvt_pk_bf16_f32 v105, v14, v15
    v_cvt_pk_bf16_f32 v106, v16, v17
    v_cvt_pk_bf16_f32 v107, v18, v19
    v_max3_f32 v29, v44, v45, v46
    v_max3_f32 v29, v29, v47, v60
    v_max3_f32 v29, v29, v61, v62
    v_max_f32 v29, v29, v63
    v_mov_b32 v30, v29
    s_nop 1
    v_permlane16_swap_b32 v29, v30
    s_nop 1
    v_max_f32 v29, v29, v30
    v_mov_b32 v30, v29
    s_nop 1
    v_permlane32_swap_b32 v29, v30
    s_nop 1
    v_max_f32 v29, v29, v30
    v_max_f32 v29, 0, v29
    v_sub_f32 v140, v140, v29
    v_sub_f32 v44, v44, v29
    v_sub_f32 v60, v60, v29
    v_sub_f32 v76, v76, v29
    v_sub_f32 v92, v92, v29
    v_sub_f32 v141, v141, v29
    v_sub_f32 v45, v45, v29
    v_sub_f32 v61, v61, v29
    v_sub_f32 v77, v77, v29
    v_sub_f32 v93, v93, v29
    v_sub_f32 v142, v142, v29
    v_sub_f32 v46, v46, v29
    v_sub_f32 v62, v62, v29
    v_sub_f32 v78, v78, v29
    v_sub_f32 v94, v94, v29
    v_sub_f32 v143, v143, v29
    v_sub_f32 v47, v47, v29
    v_sub_f32 v63, v63, v29
    v_sub_f32 v79, v79, v29
    v_sub_f32 v95, v95, v29
    v_sub_f32 v30, 0, v29
    v_exp_f32 v30, v30
    s_nop 0
    v_mul_f32 v7, v7, v30
    v_accvgpr_read_b32 v31, a144
    v_mul_f32 v31, v31, v30
    v_accvgpr_write_b32 a144, v31
    v_accvgpr_read_b32 v31, a145
    v_mul_f32 v31, v31, v30
    v_accvgpr_write_b32 a145, v31
    v_accvgpr_read_b32 v31, a146
    v_mul_f32 v31, v31, v30
    v_accvgpr_write_b32 a146, v31
    v_accvgpr_read_b32 v31, a147
    v_mul_f32 v31, v31, v30
    v_accvgpr_write_b32 a147, v31
    v_accvgpr_read_b32 v31, a148
    v_mul_f32 v31, v31, v30
    v_accvgpr_write_b32 a148, v31
    v_accvgpr_read_b32 v31, a149
    v_mul_f32 v31, v31, v30
    v_accvgpr_write_b32 a149, v31
    v_accvgpr_read_b32 v31, a150
    v_mul_f32 v31, v31, v30
    v_accvgpr_write_b32 a150, v31
    v_accvgpr_read_b32 v31, a151
    v_mul_f32 v31, v31, v30
    v_accvgpr_write_b32 a151, v31
    v_accvgpr_read_b32 v31, a152
    v_mul_f32 v31, v31, v30
    v_accvgpr_write_b32 a152, v31
    v_accvgpr_read_b32 v31, a153
    v_mul_f32 v31, v31, v30
    v_accvgpr_write_b32 a153, v31
    v_accvgpr_read_b32 v31, a154
    v_mul_f32 v31, v31, v30
    v_accvgpr_write_b32 a154, v31
    v_accvgpr_read_b32 v31, a155
    v_mul_f32 v31, v31, v30
    v_accvgpr_write_b32 a155, v31
    v_accvgpr_read_b32 v31, a156
    v_mul_f32 v31, v31, v30
    v_accvgpr_write_b32 a156, v31
    v_accvgpr_read_b32 v31, a157
    v_mul_f32 v31, v31, v30
    v_accvgpr_write_b32 a157, v31
    v_accvgpr_read_b32 v31, a158
    v_mul_f32 v31, v31, v30
    v_accvgpr_write_b32 a158, v31
    v_accvgpr_read_b32 v31, a159
    v_mul_f32 v31, v31, v30
    v_accvgpr_write_b32 a159, v31
    v_accvgpr_read_b32 v31, a160
    v_mul_f32 v31, v31, v30
    v_accvgpr_write_b32 a160, v31
    v_accvgpr_read_b32 v31, a161
    v_mul_f32 v31, v31, v30
    v_accvgpr_write_b32 a161, v31
    v_accvgpr_read_b32 v31, a162
    v_mul_f32 v31, v31, v30
    v_accvgpr_write_b32 a162, v31
    v_accvgpr_read_b32 v31, a163
    v_mul_f32 v31, v31, v30
    v_accvgpr_write_b32 a163, v31
    v_accvgpr_read_b32 v31, a164
    v_mul_f32 v31, v31, v30
    v_accvgpr_write_b32 a164, v31
    v_accvgpr_read_b32 v31, a165
    v_mul_f32 v31, v31, v30
    v_accvgpr_write_b32 a165, v31
    v_accvgpr_read_b32 v31, a166
    v_mul_f32 v31, v31, v30
    v_accvgpr_write_b32 a166, v31
    v_accvgpr_read_b32 v31, a167
    v_mul_f32 v31, v31, v30
    v_accvgpr_write_b32 a167, v31
    v_accvgpr_read_b32 v31, a168
    v_mul_f32 v31, v31, v30
    v_accvgpr_write_b32 a168, v31
    v_accvgpr_read_b32 v31, a169
    v_mul_f32 v31, v31, v30
    v_accvgpr_write_b32 a169, v31
    v_accvgpr_read_b32 v31, a170
    v_mul_f32 v31, v31, v30
    v_accvgpr_write_b32 a170, v31
    v_accvgpr_read_b32 v31, a171
    v_mul_f32 v31, v31, v30
    v_accvgpr_write_b32 a171, v31
    v_accvgpr_read_b32 v31, a172
    v_mul_f32 v31, v31, v30
    v_accvgpr_write_b32 a172, v31
    v_accvgpr_read_b32 v31, a173
    v_mul_f32 v31, v31, v30
    v_accvgpr_write_b32 a173, v31
    v_accvgpr_read_b32 v31, a174
    v_mul_f32 v31, v31, v30
    v_accvgpr_write_b32 a174, v31
    v_accvgpr_read_b32 v31, a175
    v_mul_f32 v31, v31, v30
    v_accvgpr_write_b32 a175, v31
    v_accvgpr_read_b32 v31, a176
    v_mul_f32 v31, v31, v30
    v_accvgpr_write_b32 a176, v31
    v_accvgpr_read_b32 v31, a177
    v_mul_f32 v31, v31, v30
    v_accvgpr_write_b32 a177, v31
    v_accvgpr_read_b32 v31, a178
    v_mul_f32 v31, v31, v30
    v_accvgpr_write_b32 a178, v31
    v_accvgpr_read_b32 v31, a179
    v_mul_f32 v31, v31, v30
    v_accvgpr_write_b32 a179, v31
    v_accvgpr_read_b32 v31, a180
    v_mul_f32 v31, v31, v30
    v_accvgpr_write_b32 a180, v31
    v_accvgpr_read_b32 v31, a181
    v_mul_f32 v31, v31, v30
    v_accvgpr_write_b32 a181, v31
    v_accvgpr_read_b32 v31, a182
    v_mul_f32 v31, v31, v30
    v_accvgpr_write_b32 a182, v31
    v_accvgpr_read_b32 v31, a183
    v_mul_f32 v31, v31, v30
    v_accvgpr_write_b32 a183, v31
    v_accvgpr_read_b32 v31, a184
    v_mul_f32 v31, v31, v30
    v_accvgpr_write_b32 a184, v31
    v_accvgpr_read_b32 v31, a185
    v_mul_f32 v31, v31, v30
    v_accvgpr_write_b32 a185, v31
    v_accvgpr_read_b32 v31, a186
    v_mul_f32 v31, v31, v30
    v_accvgpr_write_b32 a186, v31
    v_accvgpr_read_b32 v31, a187
    v_mul_f32 v31, v31, v30
    v_accvgpr_write_b32 a187, v31
    v_accvgpr_read_b32 v31, a188
    v_mul_f32 v31, v31, v30
    v_accvgpr_write_b32 a188, v31
    v_accvgpr_read_b32 v31, a189
    v_mul_f32 v31, v31, v30
    v_accvgpr_write_b32 a189, v31
    v_accvgpr_read_b32 v31, a190
    v_mul_f32 v31, v31, v30
    v_accvgpr_write_b32 a190, v31
    v_accvgpr_read_b32 v31, a191
    v_mul_f32 v31, v31, v30
    v_accvgpr_write_b32 a191, v31
    v_exp_f32 v12, v44
    v_exp_f32 v13, v45
    v_exp_f32 v14, v46
    v_exp_f32 v15, v47
    v_exp_f32 v16, v60
    v_exp_f32 v17, v61
    v_exp_f32 v18, v62
    v_exp_f32 v19, v63
    s_nop 0
    v_add_f32 v11, v12, v13
    v_add_f32 v11, v11, v14
    v_add_f32 v11, v11, v15
    v_add_f32 v11, v11, v16
    v_add_f32 v11, v11, v17
    v_add_f32 v11, v11, v18
    v_add_f32 v11, v11, v19
    v_cvt_pk_bf16_f32 v108, v12, v13
    v_cvt_pk_bf16_f32 v109, v14, v15
    v_cvt_pk_bf16_f32 v110, v16, v17
    v_cvt_pk_bf16_f32 v111, v18, v19
    s_nop 3
    s_cmp_eq_u32 s37, 0
    s_cbranch_scc1 Z_retx0
    s_branch Z_retx2
Z_fb1:
    s_nop 7
    s_nop 7
    v_max3_f32 v29, v64, v65, v66
    v_max3_f32 v29, v29, v67, v80
    v_max3_f32 v29, v29, v81, v82
    v_max_f32 v29, v29, v83
    v_mov_b32 v30, v29
    s_nop 1
    v_permlane16_swap_b32 v29, v30
    s_nop 1
    v_max_f32 v29, v29, v30
    v_mov_b32 v30, v29
    s_nop 1
    v_permlane32_swap_b32 v29, v30
    s_nop 1
    v_max_f32 v29, v29, v30
    v_max_f32 v29, 0, v29
    v_sub_f32 v128, v128, v29
    v_sub_f32 v64, v64, v29
    v_sub_f32 v80, v80, v29
    v_sub_f32 v32, v32, v29
    v_sub_f32 v48, v48, v29
    v_sub_f32 v129, v129, v29
    v_sub_f32 v65, v65, v29
    v_sub_f32 v81, v81, v29
    v_sub_f32 v33, v33, v29
    v_sub_f32 v49, v49, v29
    v_sub_f32 v130, v130, v29
    v_sub_f32 v66, v66, v29
    v_sub_f32 v82, v82, v29
    v_sub_f32 v34, v34, v29
    v_sub_f32 v50, v50, v29
    v_sub_f32 v131, v131, v29
    v_sub_f32 v67, v67, v29
    v_sub_f32 v83, v83, v29
    v_sub_f32 v35, v35, v29
    v_sub_f32 v51, v51, v29
    v_sub_f32 v30, 0, v29
    v_exp_f32 v30, v30
    s_nop 0
    v_mul_f32 v4, v4, v30
    v_accvgpr_read_b32 v31, a0
    v_mul_f32 v31, v31, v30
    v_accvgpr_write_b32 a0, v31
    v_accvgpr_read_b32 v31, a1
    v_mul_f32 v31, v31, v30
    v_accvgpr_write_b32 a1, v31
    v_accvgpr_read_b32 v31, a2
    v_mul_f32 v31, v31, v30
    v_accvgpr_write_b32 a2, v31
    v_accvgpr_read_b32 v31, a3
    v_mul_f32 v31, v31, v30
    v_accvgpr_write_b32 a3, v31
    v_accvgpr_read_b32 v31, a4
    v_mul_f32 v31, v31, v30
    v_accvgpr_write_b32 a4, v31
    v_accvgpr_read_b32 v31, a5
    v_mul_f32 v31, v31, v30
    v_accvgpr_write_b32 a5, v31
    v_accvgpr_read_b32 v31, a6
    v_mul_f32 v31, v31, v30
    v_accvgpr_write_b32 a6, v31
    v_accvgpr_read_b32 v31, a7
    v_mul_f32 v31, v31, v30
    v_accvgpr_write_b32 a7, v31
    v_accvgpr_read_b32 v31, a8
    v_mul_f32 v31, v31, v30
    v_accvgpr_write_b32 a8, v31
    v_accvgpr_read_b32 v31, a9
    v_mul_f32 v31, v31, v30
    v_accvgpr_write_b32 a9, v31
    v_accvgpr_read_b32 v31, a10
    v_mul_f32 v31, v31, v30
    v_accvgpr_write_b32 a10, v31
    v_accvgpr_read_b32 v31, a11
    v_mul_f32 v31, v31, v30
    v_accvgpr_write_b32 a11, v31
    v_accvgpr_read_b32 v31, a12
    v_mul_f32 v31, v31, v30
    v_accvgpr_write_b32 a12, v31
    v_accvgpr_read_b32 v31, a13
    v_mul_f32 v31, v31, v30
    v_accvgpr_write_b32 a13, v31
    v_accvgpr_read_b32 v31, a14
    v_mul_f32 v31, v31, v30
    v_accvgpr_write_b32 a14, v31
    v_accvgpr_read_b32 v31, a15
    v_mul_f32 v31, v31, v30
    v_accvgpr_write_b32 a15, v31
    v_accvgpr_read_b32 v31, a16
    v_mul_f32 v31, v31, v30
    v_accvgpr_write_b32 a16, v31
    v_accvgpr_read_b32 v31, a17
    v_mul_f32 v31, v31, v30
    v_accvgpr_write_b32 a17, v31
    v_accvgpr_read_b32 v31, a18
    v_mul_f32 v31, v31, v30
    v_accvgpr_write_b32 a18, v31
    v_accvgpr_read_b32 v31, a19
    v_mul_f32 v31, v31, v30
    v_accvgpr_write_b32 a19, v31
    v_accvgpr_read_b32 v31, a20
    v_mul_f32 v31, v31, v30
    v_accvgpr_write_b32 a20, v31
    v_accvgpr_read_b32 v31, a21
    v_mul_f32 v31, v31, v30
    v_accvgpr_write_b32 a21, v31
    v_accvgpr_read_b32 v31, a22
    v_mul_f32 v31, v31, v30
    v_accvgpr_write_b32 a22, v31
    v_accvgpr_read_b32 v31, a23
    v_mul_f32 v31, v31, v30
    v_accvgpr_write_b32 a23, v31
    v_accvgpr_read_b32 v31, a24
    v_mul_f32 v31, v31, v30
    v_accvgpr_write_b32 a24, v31
    v_accvgpr_read_b32 v31, a25
    v_mul_f32 v31, v31, v30
    v_accvgpr_write_b32 a25, v31
    v_accvgpr_read_b32 v31, a26
    v_mul_f32 v31, v31, v30
    v_accvgpr_write_b32 a26, v31
    v_accvgpr_read_b32 v31, a27
    v_mul_f32 v31, v31, v30
    v_accvgpr_write_b32 a27, v31
    v_accvgpr_read_b32 v31, a28
    v_mul_f32 v31, v31, v30
    v_accvgpr_write_b32 a28, v31
    v_accvgpr_read_b32 v31, a29
    v_mul_f32 v31, v31, v30
    v_accvgpr_write_b32 a29, v31
    v_accvgpr_read_b32 v31, a30
    v_mul_f32 v31, v31, v30
    v_accvgpr_write_b32 a30, v31
    v_accvgpr_read_b32 v31, a31
    v_mul_f32 v31, v31, v30
    v_accvgpr_write_b32 a31, v31
    v_accvgpr_read_b32 v31, a32
    v_mul_f32 v31, v31, v30
    v_accvgpr_write_b32 a32, v31
    v_accvgpr_read_b32 v31, a33
    v_mul_f32 v31, v31, v30
    v_accvgpr_write_b32 a33, v31
    v_accvgpr_read_b32 v31, a34
    v_mul_f32 v31, v31, v30
    v_accvgpr_write_b32 a34, v31
    v_accvgpr_read_b32 v31, a35
    v_mul_f32 v31, v31, v30
    v_accvgpr_write_b32 a35, v31
    v_accvgpr_read_b32 v31, a36
    v_mul_f32 v31, v31, v30
    v_accvgpr_write_b32 a36, v31
    v_accvgpr_read_b32 v31, a37
    v_mul_f32 v31, v31, v30
    v_accvgpr_write_b32 a37, v31
    v_accvgpr_read_b32 v31, a38
    v_mul_f32 v31, v31, v30
    v_accvgpr_write_b32 a38, v31
    v_accvgpr_read_b32 v31, a39
    v_mul_f32 v31, v31, v30
    v_accvgpr_write_b32 a39, v31
    v_accvgpr_read_b32 v31, a40
    v_mul_f32 v31, v31, v30
    v_accvgpr_write_b32 a40, v31
    v_accvgpr_read_b32 v31, a41
    v_mul_f32 v31, v31, v30
    v_accvgpr_write_b32 a41, v31
    v_accvgpr_read_b32 v31, a42
    v_mul_f32 v31, v31, v30
    v_accvgpr_write_b32 a42, v31
    v_accvgpr_read_b32 v31, a43
    v_mul_f32 v31, v31, v30
    v_accvgpr_write_b32 a43, v31
    v_accvgpr_read_b32 v31, a44
    v_mul_f32 v31, v31, v30
    v_accvgpr_write_b32 a44, v31
    v_accvgpr_read_b32 v31, a45
    v_mul_f32 v31, v31, v30
    v_accvgpr_write_b32 a45, v31
    v_accvgpr_read_b32 v31, a46
    v_mul_f32 v31, v31, v30
    v_accvgpr_write_b32 a46, v31
    v_accvgpr_read_b32 v31, a47
    v_mul_f32 v31, v31, v30
    v_accvgpr_write_b32 a47, v31
    v_exp_f32 v12, v64
    v_exp_f32 v13, v65
    v_exp_f32 v14, v66
    v_exp_f32 v15, v67
    v_exp_f32 v16, v80
    v_exp_f32 v17, v81
    v_exp_f32 v18, v82
    v_exp_f32 v19, v83
    s_nop 0
    v_add_f32 v8, v12, v13
    v_add_f32 v8, v8, v14
    v_add_f32 v8, v8, v15
    v_add_f32 v8, v8, v16
    v_add_f32 v8, v8, v17
    v_add_f32 v8, v8, v18
    v_add_f32 v8, v8, v19
    v_cvt_pk_bf16_f32 v112, v12, v13
    v_cvt_pk_bf16_f32 v113, v14, v15
    v_cvt_pk_bf16_f32 v114, v16, v17
    v_cvt_pk_bf16_f32 v115, v18, v19
    v_max3_f32 v29, v68, v69, v70
    v_max3_f32 v29, v29, v71, v84
    v_max3_f32 v29, v29, v85, v86
    v_max_f32 v29, v29, v87
    v_mov_b32 v30, v29
    s_nop 1
    v_permlane16_swap_b32 v29, v30
    s_nop 1
    v_max_f32 v29, v29, v30
    v_mov_b32 v30, v29
    s_nop 1
    v_permlane32_swap_b32 v29, v30
    s_nop 1
    v_max_f32 v29, v29, v30
    v_max_f32 v29, 0, v29
    v_sub_f32 v132, v132, v29
    v_sub_f32 v68, v68, v29
    v_sub_f32 v84, v84, v29
    v_sub_f32 v36, v36, v29
    v_sub_f32 v52, v52, v29
    v_sub_f32 v133, v133, v29
    v_sub_f32 v69, v69, v29
    v_sub_f32 v85, v85, v29
    v_sub_f32 v37, v37, v29
    v_sub_f32 v53, v53, v29
    v_sub_f32 v134, v134, v29
    v_sub_f32 v70, v70, v29
    v_sub_f32 v86, v86, v29
    v_sub_f32 v38, v38, v29
    v_sub_f32 v54, v54, v29
    v_sub_f32 v135, v135, v29
    v_sub_f32 v71, v71, v29
    v_sub_f32 v87, v87, v29
    v_sub_f32 v39, v39, v29
    v_sub_f32 v55, v55, v29
    v_sub_f32 v30, 0, v29
    v_exp_f32 v30, v30
    s_nop 0
    v_mul_f32 v5, v5, v30
    v_accvgpr_read_b32 v31, a48
    v_mul_f32 v31, v31, v30
    v_accvgpr_write_b32 a48, v31
    v_accvgpr_read_b32 v31, a49
    v_mul_f32 v31, v31, v30
    v_accvgpr_write_b32 a49, v31
    v_accvgpr_read_b32 v31, a50
    v_mul_f32 v31, v31, v30
    v_accvgpr_write_b32 a50, v31
    v_accvgpr_read_b32 v31, a51
    v_mul_f32 v31, v31, v30
    v_accvgpr_write_b32 a51, v31
    v_accvgpr_read_b32 v31, a52
    v_mul_f32 v31, v31, v30
    v_accvgpr_write_b32 a52, v31
    v_accvgpr_read_b32 v31, a53
    v_mul_f32 v31, v31, v30
    v_accvgpr_write_b32 a53, v31
    v_accvgpr_read_b32 v31, a54
    v_mul_f32 v31, v31, v30
    v_accvgpr_write_b32 a54, v31
    v_accvgpr_read_b32 v31, a55
    v_mul_f32 v31, v31, v30
    v_accvgpr_write_b32 a55, v31
    v_accvgpr_read_b32 v31, a56
    v_mul_f32 v31, v31, v30
    v_accvgpr_write_b32 a56, v31
    v_accvgpr_read_b32 v31, a57
    v_mul_f32 v31, v31, v30
    v_accvgpr_write_b32 a57, v31
    v_accvgpr_read_b32 v31, a58
    v_mul_f32 v31, v31, v30
    v_accvgpr_write_b32 a58, v31
    v_accvgpr_read_b32 v31, a59
    v_mul_f32 v31, v31, v30
    v_accvgpr_write_b32 a59, v31
    v_accvgpr_read_b32 v31, a60
    v_mul_f32 v31, v31, v30
    v_accvgpr_write_b32 a60, v31
    v_accvgpr_read_b32 v31, a61
    v_mul_f32 v31, v31, v30
    v_accvgpr_write_b32 a61, v31
    v_accvgpr_read_b32 v31, a62
    v_mul_f32 v31, v31, v30
    v_accvgpr_write_b32 a62, v31
    v_accvgpr_read_b32 v31, a63
    v_mul_f32 v31, v31, v30
    v_accvgpr_write_b32 a63, v31
    v_accvgpr_read_b32 v31, a64
    v_mul_f32 v31, v31, v30
    v_accvgpr_write_b32 a64, v31
    v_accvgpr_read_b32 v31, a65
    v_mul_f32 v31, v31, v30
    v_accvgpr_write_b32 a65, v31
    v_accvgpr_read_b32 v31, a66
    v_mul_f32 v31, v31, v30
    v_accvgpr_write_b32 a66, v31
    v_accvgpr_read_b32 v31, a67
    v_mul_f32 v31, v31, v30
    v_accvgpr_write_b32 a67, v31
    v_accvgpr_read_b32 v31, a68
    v_mul_f32 v31, v31, v30
    v_accvgpr_write_b32 a68, v31
    v_accvgpr_read_b32 v31, a69
    v_mul_f32 v31, v31, v30
    v_accvgpr_write_b32 a69, v31
    v_accvgpr_read_b32 v31, a70
    v_mul_f32 v31, v31, v30
    v_accvgpr_write_b32 a70, v31
    v_accvgpr_read_b32 v31, a71
    v_mul_f32 v31, v31, v30
    v_accvgpr_write_b32 a71, v31
    v_accvgpr_read_b32 v31, a72
    v_mul_f32 v31, v31, v30
    v_accvgpr_write_b32 a72, v31
    v_accvgpr_read_b32 v31, a73
    v_mul_f32 v31, v31, v30
    v_accvgpr_write_b32 a73, v31
    v_accvgpr_read_b32 v31, a74
    v_mul_f32 v31, v31, v30
    v_accvgpr_write_b32 a74, v31
    v_accvgpr_read_b32 v31, a75
    v_mul_f32 v31, v31, v30
    v_accvgpr_write_b32 a75, v31
    v_accvgpr_read_b32 v31, a76
    v_mul_f32 v31, v31, v30
    v_accvgpr_write_b32 a76, v31
    v_accvgpr_read_b32 v31, a77
    v_mul_f32 v31, v31, v30
    v_accvgpr_write_b32 a77, v31
    v_accvgpr_read_b32 v31, a78
    v_mul_f32 v31, v31, v30
    v_accvgpr_write_b32 a78, v31
    v_accvgpr_read_b32 v31, a79
    v_mul_f32 v31, v31, v30
    v_accvgpr_write_b32 a79, v31
    v_accvgpr_read_b32 v31, a80
    v_mul_f32 v31, v31, v30
    v_accvgpr_write_b32 a80, v31
    v_accvgpr_read_b32 v31, a81
    v_mul_f32 v31, v31, v30
    v_accvgpr_write_b32 a81, v31
    v_accvgpr_read_b32 v31, a82
    v_mul_f32 v31, v31, v30
    v_accvgpr_write_b32 a82, v31
    v_accvgpr_read_b32 v31, a83
    v_mul_f32 v31, v31, v30
    v_accvgpr_write_b32 a83, v31
    v_accvgpr_read_b32 v31, a84
    v_mul_f32 v31, v31, v30
    v_accvgpr_write_b32 a84, v31
    v_accvgpr_read_b32 v31, a85
    v_mul_f32 v31, v31, v30
    v_accvgpr_write_b32 a85, v31
    v_accvgpr_read_b32 v31, a86
    v_mul_f32 v31, v31, v30
    v_accvgpr_write_b32 a86, v31
    v_accvgpr_read_b32 v31, a87
    v_mul_f32 v31, v31, v30
    v_accvgpr_write_b32 a87, v31
    v_accvgpr_read_b32 v31, a88
    v_mul_f32 v31, v31, v30
    v_accvgpr_write_b32 a88, v31
    v_accvgpr_read_b32 v31, a89
    v_mul_f32 v31, v31, v30
    v_accvgpr_write_b32 a89, v31
    v_accvgpr_read_b32 v31, a90
    v_mul_f32 v31, v31, v30
    v_accvgpr_write_b32 a90, v31
    v_accvgpr_read_b32 v31, a91
    v_mul_f32 v31, v31, v30
    v_accvgpr_write_b32 a91, v31
    v_accvgpr_read_b32 v31, a92
    v_mul_f32 v31, v31, v30
    v_accvgpr_write_b32 a92, v31
    v_accvgpr_read_b32 v31, a93
    v_mul_f32 v31, v31, v30
    v_accvgpr_write_b32 a93, v31
    v_accvgpr_read_b32 v31, a94
    v_mul_f32 v31, v31, v30
    v_accvgpr_write_b32 a94, v31
    v_accvgpr_read_b32 v31, a95
    v_mul_f32 v31, v31, v30
    v_accvgpr_write_b32 a95, v31
    v_exp_f32 v12, v68
    v_exp_f32 v13, v69
    v_exp_f32 v14, v70
    v_exp_f32 v15, v71
    v_exp_f32 v16, v84
    v_exp_f32 v17, v85
    v_exp_f32 v18, v86
    v_exp_f32 v19, v87
    s_nop 0
    v_add_f32 v9, v12, v13
    v_add_f32 v9, v9, v14
    v_add_f32 v9, v9, v15
    v_add_f32 v9, v9, v16
    v_add_f32 v9, v9, v17
    v_add_f32 v9, v9, v18
    v_add_f32 v9, v9, v19
    v_cvt_pk_bf16_f32 v116, v12, v13
    v_cvt_pk_bf16_f32 v117, v14, v15
    v_cvt_pk_bf16_f32 v118, v16, v17
    v_cvt_pk_bf16_f32 v119, v18, v19
    v_max3_f32 v29, v72, v73, v74
    v_max3_f32 v29, v29, v75, v88
    v_max3_f32 v29, v29, v89, v90
    v_max_f32 v29, v29, v91
    v_mov_b32 v30, v29
    s_nop 1
    v_permlane16_swap_b32 v29, v30
    s_nop 1
    v_max_f32 v29, v29, v30
    v_mov_b32 v30, v29
    s_nop 1
    v_permlane32_swap_b32 v29, v30
    s_nop 1
    v_max_f32 v29, v29, v30
    v_max_f32 v29, 0, v29
    v_sub_f32 v136, v136, v29
    v_sub_f32 v72, v72, v29
    v_sub_f32 v88, v88, v29
    v_sub_f32 v40, v40, v29
    v_sub_f32 v56, v56, v29
    v_sub_f32 v137, v137, v29
    v_sub_f32 v73, v73, v29
    v_sub_f32 v89, v89, v29
    v_sub_f32 v41, v41, v29
    v_sub_f32 v57, v57, v29
    v_sub_f32 v138, v138, v29
    v_sub_f32 v74, v74, v29
    v_sub_f32 v90, v90, v29
    v_sub_f32 v42, v42, v29
    v_sub_f32 v58, v58, v29
    v_sub_f32 v139, v139, v29
    v_sub_f32 v75, v75, v29
    v_sub_f32 v91, v91, v29
    v_sub_f32 v43, v43, v29
    v_sub_f32 v59, v59, v29
    v_sub_f32 v30, 0, v29
    v_exp_f32 v30, v30
    s_nop 0
    v_mul_f32 v6, v6, v30
    v_accvgpr_read_b32 v31, a96
    v_mul_f32 v31, v31, v30
    v_accvgpr_write_b32 a96, v31
    v_accvgpr_read_b32 v31, a97
    v_mul_f32 v31, v31, v30
    v_accvgpr_write_b32 a97, v31
    v_accvgpr_read_b32 v31, a98
    v_mul_f32 v31, v31, v30
    v_accvgpr_write_b32 a98, v31
    v_accvgpr_read_b32 v31, a99
    v_mul_f32 v31, v31, v30
    v_accvgpr_write_b32 a99, v31
    v_accvgpr_read_b32 v31, a100
    v_mul_f32 v31, v31, v30
    v_accvgpr_write_b32 a100, v31
    v_accvgpr_read_b32 v31, a101
    v_mul_f32 v31, v31, v30
    v_accvgpr_write_b32 a101, v31
    v_accvgpr_read_b32 v31, a102
    v_mul_f32 v31, v31, v30
    v_accvgpr_write_b32 a102, v31
    v_accvgpr_read_b32 v31, a103
    v_mul_f32 v31, v31, v30
    v_accvgpr_write_b32 a103, v31
    v_accvgpr_read_b32 v31, a104
    v_mul_f32 v31, v31, v30
    v_accvgpr_write_b32 a104, v31
    v_accvgpr_read_b32 v31, a105
    v_mul_f32 v31, v31, v30
    v_accvgpr_write_b32 a105, v31
    v_accvgpr_read_b32 v31, a106
    v_mul_f32 v31, v31, v30
    v_accvgpr_write_b32 a106, v31
    v_accvgpr_read_b32 v31, a107
    v_mul_f32 v31, v31, v30
    v_accvgpr_write_b32 a107, v31
    v_accvgpr_read_b32 v31, a108
    v_mul_f32 v31, v31, v30
    v_accvgpr_write_b32 a108, v31
    v_accvgpr_read_b32 v31, a109
    v_mul_f32 v31, v31, v30
    v_accvgpr_write_b32 a109, v31
    v_accvgpr_read_b32 v31, a110
    v_mul_f32 v31, v31, v30
    v_accvgpr_write_b32 a110, v31
    v_accvgpr_read_b32 v31, a111
    v_mul_f32 v31, v31, v30
    v_accvgpr_write_b32 a111, v31
    v_accvgpr_read_b32 v31, a112
    v_mul_f32 v31, v31, v30
    v_accvgpr_write_b32 a112, v31
    v_accvgpr_read_b32 v31, a113
    v_mul_f32 v31, v31, v30
    v_accvgpr_write_b32 a113, v31
    v_accvgpr_read_b32 v31, a114
    v_mul_f32 v31, v31, v30
    v_accvgpr_write_b32 a114, v31
    v_accvgpr_read_b32 v31, a115
    v_mul_f32 v31, v31, v30
    v_accvgpr_write_b32 a115, v31
    v_accvgpr_read_b32 v31, a116
    v_mul_f32 v31, v31, v30
    v_accvgpr_write_b32 a116, v31
    v_accvgpr_read_b32 v31, a117
    v_mul_f32 v31, v31, v30
    v_accvgpr_write_b32 a117, v31
    v_accvgpr_read_b32 v31, a118
    v_mul_f32 v31, v31, v30
    v_accvgpr_write_b32 a118, v31
    v_accvgpr_read_b32 v31, a119
    v_mul_f32 v31, v31, v30
    v_accvgpr_write_b32 a119, v31
    v_accvgpr_read_b32 v31, a120
    v_mul_f32 v31, v31, v30
    v_accvgpr_write_b32 a120, v31
    v_accvgpr_read_b32 v31, a121
    v_mul_f32 v31, v31, v30
    v_accvgpr_write_b32 a121, v31
    v_accvgpr_read_b32 v31, a122
    v_mul_f32 v31, v31, v30
    v_accvgpr_write_b32 a122, v31
    v_accvgpr_read_b32 v31, a123
    v_mul_f32 v31, v31, v30
    v_accvgpr_write_b32 a123, v31
    v_accvgpr_read_b32 v31, a124
    v_mul_f32 v31, v31, v30
    v_accvgpr_write_b32 a124, v31
    v_accvgpr_read_b32 v31, a125
    v_mul_f32 v31, v31, v30
    v_accvgpr_write_b32 a125, v31
    v_accvgpr_read_b32 v31, a126
    v_mul_f32 v31, v31, v30
    v_accvgpr_write_b32 a126, v31
    v_accvgpr_read_b32 v31, a127
    v_mul_f32 v31, v31, v30
    v_accvgpr_write_b32 a127, v31
    v_accvgpr_read_b32 v31, a128
    v_mul_f32 v31, v31, v30
    v_accvgpr_write_b32 a128, v31
    v_accvgpr_read_b32 v31, a129
    v_mul_f32 v31, v31, v30
    v_accvgpr_write_b32 a129, v31
    v_accvgpr_read_b32 v31, a130
    v_mul_f32 v31, v31, v30
    v_accvgpr_write_b32 a130, v31
    v_accvgpr_read_b32 v31, a131
    v_mul_f32 v31, v31, v30
    v_accvgpr_write_b32 a131, v31
    v_accvgpr_read_b32 v31, a132
    v_mul_f32 v31, v31, v30
    v_accvgpr_write_b32 a132, v31
    v_accvgpr_read_b32 v31, a133
    v_mul_f32 v31, v31, v30
    v_accvgpr_write_b32 a133, v31
    v_accvgpr_read_b32 v31, a134
    v_mul_f32 v31, v31, v30
    v_accvgpr_write_b32 a134, v31
    v_accvgpr_read_b32 v31, a135
    v_mul_f32 v31, v31, v30
    v_accvgpr_write_b32 a135, v31
    v_accvgpr_read_b32 v31, a136
    v_mul_f32 v31, v31, v30
    v_accvgpr_write_b32 a136, v31
    v_accvgpr_read_b32 v31, a137
    v_mul_f32 v31, v31, v30
    v_accvgpr_write_b32 a137, v31
    v_accvgpr_read_b32 v31, a138
    v_mul_f32 v31, v31, v30
    v_accvgpr_write_b32 a138, v31
    v_accvgpr_read_b32 v31, a139
    v_mul_f32 v31, v31, v30
    v_accvgpr_write_b32 a139, v31
    v_accvgpr_read_b32 v31, a140
    v_mul_f32 v31, v31, v30
    v_accvgpr_write_b32 a140, v31
    v_accvgpr_read_b32 v31, a141
    v_mul_f32 v31, v31, v30
    v_accvgpr_write_b32 a141, v31
    v_accvgpr_read_b32 v31, a142
    v_mul_f32 v31, v31, v30
    v_accvgpr_write_b32 a142, v31
    v_accvgpr_read_b32 v31, a143
    v_mul_f32 v31, v31, v30
    v_accvgpr_write_b32 a143, v31
    v_exp_f32 v12, v72
    v_exp_f32 v13, v73
    v_exp_f32 v14, v74
    v_exp_f32 v15, v75
    v_exp_f32 v16, v88
    v_exp_f32 v17, v89
    v_exp_f32 v18, v90
    v_exp_f32 v19, v91
    s_nop 0
    v_add_f32 v10, v12, v13
    v_add_f32 v10, v10, v14
    v_add_f32 v10, v10, v15
    v_add_f32 v10, v10, v16
    v_add_f32 v10, v10, v17
    v_add_f32 v10, v10, v18
    v_add_f32 v10, v10, v19
    v_cvt_pk_bf16_f32 v120, v12, v13
    v_cvt_pk_bf16_f32 v121, v14, v15
    v_cvt_pk_bf16_f32 v122, v16, v17
    v_cvt_pk_bf16_f32 v123, v18, v19
    v_max3_f32 v29, v76, v77, v78
    v_max3_f32 v29, v29, v79, v92
    v_max3_f32 v29, v29, v93, v94
    v_max_f32 v29, v29, v95
    v_mov_b32 v30, v29
    s_nop 1
    v_permlane16_swap_b32 v29, v30
    s_nop 1
    v_max_f32 v29, v29, v30
    v_mov_b32 v30, v29
    s_nop 1
    v_permlane32_swap_b32 v29, v30
    s_nop 1
    v_max_f32 v29, v29, v30
    v_max_f32 v29, 0, v29
    v_sub_f32 v140, v140, v29
    v_sub_f32 v76, v76, v29
    v_sub_f32 v92, v92, v29
    v_sub_f32 v44, v44, v29
    v_sub_f32 v60, v60, v29
    v_sub_f32 v141, v141, v29
    v_sub_f32 v77, v77, v29
    v_sub_f32 v93, v93, v29
    v_sub_f32 v45, v45, v29
    v_sub_f32 v61, v61, v29
    v_sub_f32 v142, v142, v29
    v_sub_f32 v78, v78, v29
    v_sub_f32 v94, v94, v29
    v_sub_f32 v46, v46, v29
    v_sub_f32 v62, v62, v29
    v_sub_f32 v143, v143, v29
    v_sub_f32 v79, v79, v29
    v_sub_f32 v95, v95, v29
    v_sub_f32 v47, v47, v29
    v_sub_f32 v63, v63, v29
    v_sub_f32 v30, 0, v29
    v_exp_f32 v30, v30
    s_nop 0
    v_mul_f32 v7, v7, v30
    v_accvgpr_read_b32 v31, a144
    v_mul_f32 v31, v31, v30
    v_accvgpr_write_b32 a144, v31
    v_accvgpr_read_b32 v31, a145
    v_mul_f32 v31, v31, v30
    v_accvgpr_write_b32 a145, v31
    v_accvgpr_read_b32 v31, a146
    v_mul_f32 v31, v31, v30
    v_accvgpr_write_b32 a146, v31
    v_accvgpr_read_b32 v31, a147
    v_mul_f32 v31, v31, v30
    v_accvgpr_write_b32 a147, v31
    v_accvgpr_read_b32 v31, a148
    v_mul_f32 v31, v31, v30
    v_accvgpr_write_b32 a148, v31
    v_accvgpr_read_b32 v31, a149
    v_mul_f32 v31, v31, v30
    v_accvgpr_write_b32 a149, v31
    v_accvgpr_read_b32 v31, a150
    v_mul_f32 v31, v31, v30
    v_accvgpr_write_b32 a150, v31
    v_accvgpr_read_b32 v31, a151
    v_mul_f32 v31, v31, v30
    v_accvgpr_write_b32 a151, v31
    v_accvgpr_read_b32 v31, a152
    v_mul_f32 v31, v31, v30
    v_accvgpr_write_b32 a152, v31
    v_accvgpr_read_b32 v31, a153
    v_mul_f32 v31, v31, v30
    v_accvgpr_write_b32 a153, v31
    v_accvgpr_read_b32 v31, a154
    v_mul_f32 v31, v31, v30
    v_accvgpr_write_b32 a154, v31
    v_accvgpr_read_b32 v31, a155
    v_mul_f32 v31, v31, v30
    v_accvgpr_write_b32 a155, v31
    v_accvgpr_read_b32 v31, a156
    v_mul_f32 v31, v31, v30
    v_accvgpr_write_b32 a156, v31
    v_accvgpr_read_b32 v31, a157
    v_mul_f32 v31, v31, v30
    v_accvgpr_write_b32 a157, v31
    v_accvgpr_read_b32 v31, a158
    v_mul_f32 v31, v31, v30
    v_accvgpr_write_b32 a158, v31
    v_accvgpr_read_b32 v31, a159
    v_mul_f32 v31, v31, v30
    v_accvgpr_write_b32 a159, v31
    v_accvgpr_read_b32 v31, a160
    v_mul_f32 v31, v31, v30
    v_accvgpr_write_b32 a160, v31
    v_accvgpr_read_b32 v31, a161
    v_mul_f32 v31, v31, v30
    v_accvgpr_write_b32 a161, v31
    v_accvgpr_read_b32 v31, a162
    v_mul_f32 v31, v31, v30
    v_accvgpr_write_b32 a162, v31
    v_accvgpr_read_b32 v31, a163
    v_mul_f32 v31, v31, v30
    v_accvgpr_write_b32 a163, v31
    v_accvgpr_read_b32 v31, a164
    v_mul_f32 v31, v31, v30
    v_accvgpr_write_b32 a164, v31
    v_accvgpr_read_b32 v31, a165
    v_mul_f32 v31, v31, v30
    v_accvgpr_write_b32 a165, v31
    v_accvgpr_read_b32 v31, a166
    v_mul_f32 v31, v31, v30
    v_accvgpr_write_b32 a166, v31
    v_accvgpr_read_b32 v31, a167
    v_mul_f32 v31, v31, v30
    v_accvgpr_write_b32 a167, v31
    v_accvgpr_read_b32 v31, a168
    v_mul_f32 v31, v31, v30
    v_accvgpr_write_b32 a168, v31
    v_accvgpr_read_b32 v31, a169
    v_mul_f32 v31, v31, v30
    v_accvgpr_write_b32 a169, v31
    v_accvgpr_read_b32 v31, a170
    v_mul_f32 v31, v31, v30
    v_accvgpr_write_b32 a170, v31
    v_accvgpr_read_b32 v31, a171
    v_mul_f32 v31, v31, v30
    v_accvgpr_write_b32 a171, v31
    v_accvgpr_read_b32 v31, a172
    v_mul_f32 v31, v31, v30
    v_accvgpr_write_b32 a172, v31
    v_accvgpr_read_b32 v31, a173
    v_mul_f32 v31, v31, v30
    v_accvgpr_write_b32 a173, v31
    v_accvgpr_read_b32 v31, a174
    v_mul_f32 v31, v31, v30
    v_accvgpr_write_b32 a174, v31
    v_accvgpr_read_b32 v31, a175
    v_mul_f32 v31, v31, v30
    v_accvgpr_write_b32 a175, v31
    v_accvgpr_read_b32 v31, a176
    v_mul_f32 v31, v31, v30
    v_accvgpr_write_b32 a176, v31
    v_accvgpr_read_b32 v31, a177
    v_mul_f32 v31, v31, v30
    v_accvgpr_write_b32 a177, v31
    v_accvgpr_read_b32 v31, a178
    v_mul_f32 v31, v31, v30
    v_accvgpr_write_b32 a178, v31
    v_accvgpr_read_b32 v31, a179
    v_mul_f32 v31, v31, v30
    v_accvgpr_write_b32 a179, v31
    v_accvgpr_read_b32 v31, a180
    v_mul_f32 v31, v31, v30
    v_accvgpr_write_b32 a180, v31
    v_accvgpr_read_b32 v31, a181
    v_mul_f32 v31, v31, v30
    v_accvgpr_write_b32 a181, v31
    v_accvgpr_read_b32 v31, a182
    v_mul_f32 v31, v31, v30
    v_accvgpr_write_b32 a182, v31
    v_accvgpr_read_b32 v31, a183
    v_mul_f32 v31, v31, v30
    v_accvgpr_write_b32 a183, v31
    v_accvgpr_read_b32 v31, a184
    v_mul_f32 v31, v31, v30
    v_accvgpr_write_b32 a184, v31
    v_accvgpr_read_b32 v31, a185
    v_mul_f32 v31, v31, v30
    v_accvgpr_write_b32 a185, v31
    v_accvgpr_read_b32 v31, a186
    v_mul_f32 v31, v31, v30
    v_accvgpr_write_b32 a186, v31
    v_accvgpr_read_b32 v31, a187
    v_mul_f32 v31, v31, v30
    v_accvgpr_write_b32 a187, v31
    v_accvgpr_read_b32 v31, a188
    v_mul_f32 v31, v31, v30
    v_accvgpr_write_b32 a188, v31
    v_accvgpr_read_b32 v31, a189
    v_mul_f32 v31, v31, v30
    v_accvgpr_write_b32 a189, v31
    v_accvgpr_read_b32 v31, a190
    v_mul_f32 v31, v31, v30
    v_accvgpr_write_b32 a190, v31
    v_accvgpr_read_b32 v31, a191
    v_mul_f32 v31, v31, v30
    v_accvgpr_write_b32 a191, v31
    v_exp_f32 v12, v76
    v_exp_f32 v13, v77
    v_exp_f32 v14, v78
    v_exp_f32 v15, v79
    v_exp_f32 v16, v92
    v_exp_f32 v17, v93
    v_exp_f32 v18, v94
    v_exp_f32 v19, v95
    s_nop 0
    v_add_f32 v11, v12, v13
    v_add_f32 v11, v11, v14
    v_add_f32 v11, v11, v15
    v_add_f32 v11, v11, v16
    v_add_f32 v11, v11, v17
    v_add_f32 v11, v11, v18
    v_add_f32 v11, v11, v19
    v_cvt_pk_bf16_f32 v124, v12, v13
    v_cvt_pk_bf16_f32 v125, v14, v15
    v_cvt_pk_bf16_f32 v126, v16, v17
    v_cvt_pk_bf16_f32 v127, v18, v19
    s_nop 3
    s_cmp_eq_u32 s37, 1
    s_cbranch_scc1 Z_retx1
    s_branch Z_retx3
Z_retx0:
    s_branch Z_ret0
Z_retx1:
    s_branch Z_ret1
Z_retx2:
    s_cmp_ge_u32 s31, 64
    s_branch Z_ret2
Z_retx3:
    s_branch Z_ret3
Z_fbL:
    s_nop 7
    s_nop 7
    v_max3_f32 v29, v64, v65, v66
    v_max3_f32 v29, v29, v67, v80
    v_max3_f32 v29, v29, v81, v82
    v_max_f32 v29, v29, v83
    v_mov_b32 v30, v29
    s_nop 1
    v_permlane16_swap_b32 v29, v30
    s_nop 1
    v_max_f32 v29, v29, v30
    v_mov_b32 v30, v29
    s_nop 1
    v_permlane32_swap_b32 v29, v30
    s_nop 1
    v_max_f32 v29, v29, v30
    v_max_f32 v29, 0, v29
    v_sub_f32 v128, v128, v29
    v_sub_f32 v64, v64, v29
    v_sub_f32 v80, v80, v29
    v_sub_f32 v129, v129, v29
    v_sub_f32 v65, v65, v29
    v_sub_f32 v81, v81, v29
    v_sub_f32 v130, v130, v29
    v_sub_f32 v66, v66, v29
    v_sub_f32 v82, v82, v29
    v_sub_f32 v131, v131, v29
    v_sub_f32 v67, v67, v29
    v_sub_f32 v83, v83, v29
    v_sub_f32 v30, 0, v29
    v_exp_f32 v30, v30
    s_nop 0
    v_mul_f32 v4, v4, v30
    v_accvgpr_read_b32 v31, a0
    v_mul_f32 v31, v31, v30
    v_accvgpr_write_b32 a0, v31
    v_accvgpr_read_b32 v31, a1
    v_mul_f32 v31, v31, v30
    v_accvgpr_write_b32 a1, v31
    v_accvgpr_read_b32 v31, a2
    v_mul_f32 v31, v31, v30
    v_accvgpr_write_b32 a2, v31
    v_accvgpr_read_b32 v31, a3
    v_mul_f32 v31, v31, v30
    v_accvgpr_write_b32 a3, v31
    v_accvgpr_read_b32 v31, a4
    v_mul_f32 v31, v31, v30
    v_accvgpr_write_b32 a4, v31
    v_accvgpr_read_b32 v31, a5
    v_mul_f32 v31, v31, v30
    v_accvgpr_write_b32 a5, v31
    v_accvgpr_read_b32 v31, a6
    v_mul_f32 v31, v31, v30
    v_accvgpr_write_b32 a6, v31
    v_accvgpr_read_b32 v31, a7
    v_mul_f32 v31, v31, v30
    v_accvgpr_write_b32 a7, v31
    v_accvgpr_read_b32 v31, a8
    v_mul_f32 v31, v31, v30
    v_accvgpr_write_b32 a8, v31
    v_accvgpr_read_b32 v31, a9
    v_mul_f32 v31, v31, v30
    v_accvgpr_write_b32 a9, v31
    v_accvgpr_read_b32 v31, a10
    v_mul_f32 v31, v31, v30
    v_accvgpr_write_b32 a10, v31
    v_accvgpr_read_b32 v31, a11
    v_mul_f32 v31, v31, v30
    v_accvgpr_write_b32 a11, v31
    v_accvgpr_read_b32 v31, a12
    v_mul_f32 v31, v31, v30
    v_accvgpr_write_b32 a12, v31
    v_accvgpr_read_b32 v31, a13
    v_mul_f32 v31, v31, v30
    v_accvgpr_write_b32 a13, v31
    v_accvgpr_read_b32 v31, a14
    v_mul_f32 v31, v31, v30
    v_accvgpr_write_b32 a14, v31
    v_accvgpr_read_b32 v31, a15
    v_mul_f32 v31, v31, v30
    v_accvgpr_write_b32 a15, v31
    v_accvgpr_read_b32 v31, a16
    v_mul_f32 v31, v31, v30
    v_accvgpr_write_b32 a16, v31
    v_accvgpr_read_b32 v31, a17
    v_mul_f32 v31, v31, v30
    v_accvgpr_write_b32 a17, v31
    v_accvgpr_read_b32 v31, a18
    v_mul_f32 v31, v31, v30
    v_accvgpr_write_b32 a18, v31
    v_accvgpr_read_b32 v31, a19
    v_mul_f32 v31, v31, v30
    v_accvgpr_write_b32 a19, v31
    v_accvgpr_read_b32 v31, a20
    v_mul_f32 v31, v31, v30
    v_accvgpr_write_b32 a20, v31
    v_accvgpr_read_b32 v31, a21
    v_mul_f32 v31, v31, v30
    v_accvgpr_write_b32 a21, v31
    v_accvgpr_read_b32 v31, a22
    v_mul_f32 v31, v31, v30
    v_accvgpr_write_b32 a22, v31
    v_accvgpr_read_b32 v31, a23
    v_mul_f32 v31, v31, v30
    v_accvgpr_write_b32 a23, v31
    v_accvgpr_read_b32 v31, a24
    v_mul_f32 v31, v31, v30
    v_accvgpr_write_b32 a24, v31
    v_accvgpr_read_b32 v31, a25
    v_mul_f32 v31, v31, v30
    v_accvgpr_write_b32 a25, v31
    v_accvgpr_read_b32 v31, a26
    v_mul_f32 v31, v31, v30
    v_accvgpr_write_b32 a26, v31
    v_accvgpr_read_b32 v31, a27
    v_mul_f32 v31, v31, v30
    v_accvgpr_write_b32 a27, v31
    v_accvgpr_read_b32 v31, a28
    v_mul_f32 v31, v31, v30
    v_accvgpr_write_b32 a28, v31
    v_accvgpr_read_b32 v31, a29
    v_mul_f32 v31, v31, v30
    v_accvgpr_write_b32 a29, v31
    v_accvgpr_read_b32 v31, a30
    v_mul_f32 v31, v31, v30
    v_accvgpr_write_b32 a30, v31
    v_accvgpr_read_b32 v31, a31
    v_mul_f32 v31, v31, v30
    v_accvgpr_write_b32 a31, v31
    v_accvgpr_read_b32 v31, a32
    v_mul_f32 v31, v31, v30
    v_accvgpr_write_b32 a32, v31
    v_accvgpr_read_b32 v31, a33
    v_mul_f32 v31, v31, v30
    v_accvgpr_write_b32 a33, v31
    v_accvgpr_read_b32 v31, a34
    v_mul_f32 v31, v31, v30
    v_accvgpr_write_b32 a34, v31
    v_accvgpr_read_b32 v31, a35
    v_mul_f32 v31, v31, v30
    v_accvgpr_write_b32 a35, v31
    v_accvgpr_read_b32 v31, a36
    v_mul_f32 v31, v31, v30
    v_accvgpr_write_b32 a36, v31
    v_accvgpr_read_b32 v31, a37
    v_mul_f32 v31, v31, v30
    v_accvgpr_write_b32 a37, v31
    v_accvgpr_read_b32 v31, a38
    v_mul_f32 v31, v31, v30
    v_accvgpr_write_b32 a38, v31
    v_accvgpr_read_b32 v31, a39
    v_mul_f32 v31, v31, v30
    v_accvgpr_write_b32 a39, v31
    v_accvgpr_read_b32 v31, a40
    v_mul_f32 v31, v31, v30
    v_accvgpr_write_b32 a40, v31
    v_accvgpr_read_b32 v31, a41
    v_mul_f32 v31, v31, v30
    v_accvgpr_write_b32 a41, v31
    v_accvgpr_read_b32 v31, a42
    v_mul_f32 v31, v31, v30
    v_accvgpr_write_b32 a42, v31
    v_accvgpr_read_b32 v31, a43
    v_mul_f32 v31, v31, v30
    v_accvgpr_write_b32 a43, v31
    v_accvgpr_read_b32 v31, a44
    v_mul_f32 v31, v31, v30
    v_accvgpr_write_b32 a44, v31
    v_accvgpr_read_b32 v31, a45
    v_mul_f32 v31, v31, v30
    v_accvgpr_write_b32 a45, v31
    v_accvgpr_read_b32 v31, a46
    v_mul_f32 v31, v31, v30
    v_accvgpr_write_b32 a46, v31
    v_accvgpr_read_b32 v31, a47
    v_mul_f32 v31, v31, v30
    v_accvgpr_write_b32 a47, v31
    v_exp_f32 v12, v64
    v_exp_f32 v13, v65
    v_exp_f32 v14, v66
    v_exp_f32 v15, v67
    v_exp_f32 v16, v80
    v_exp_f32 v17, v81
    v_exp_f32 v18, v82
    v_exp_f32 v19, v83
    s_nop 0
    v_add_f32 v8, v12, v13
    v_add_f32 v8, v8, v14
    v_add_f32 v8, v8, v15
    v_add_f32 v8, v8, v16
    v_add_f32 v8, v8, v17
    v_add_f32 v8, v8, v18
    v_add_f32 v8, v8, v19
    v_cvt_pk_bf16_f32 v112, v12, v13
    v_cvt_pk_bf16_f32 v113, v14, v15
    v_cvt_pk_bf16_f32 v114, v16, v17
    v_cvt_pk_bf16_f32 v115, v18, v19
    v_max3_f32 v29, v68, v69, v70
    v_max3_f32 v29, v29, v71, v84
    v_max3_f32 v29, v29, v85, v86
    v_max_f32 v29, v29, v87
    v_mov_b32 v30, v29
    s_nop 1
    v_permlane16_swap_b32 v29, v30
    s_nop 1
    v_max_f32 v29, v29, v30
    v_mov_b32 v30, v29
    s_nop 1
    v_permlane32_swap_b32 v29, v30
    s_nop 1
    v_max_f32 v29, v29, v30
    v_max_f32 v29, 0, v29
    v_sub_f32 v132, v132, v29
    v_sub_f32 v68, v68, v29
    v_sub_f32 v84, v84, v29
    v_sub_f32 v133, v133, v29
    v_sub_f32 v69, v69, v29
    v_sub_f32 v85, v85, v29
    v_sub_f32 v134, v134, v29
    v_sub_f32 v70, v70, v29
    v_sub_f32 v86, v86, v29
    v_sub_f32 v135, v135, v29
    v_sub_f32 v71, v71, v29
    v_sub_f32 v87, v87, v29
    v_sub_f32 v30, 0, v29
    v_exp_f32 v30, v30
    s_nop 0
    v_mul_f32 v5, v5, v30
    v_accvgpr_read_b32 v31, a48
    v_mul_f32 v31, v31, v30
    v_accvgpr_write_b32 a48, v31
    v_accvgpr_read_b32 v31, a49
    v_mul_f32 v31, v31, v30
    v_accvgpr_write_b32 a49, v31
    v_accvgpr_read_b32 v31, a50
    v_mul_f32 v31, v31, v30
    v_accvgpr_write_b32 a50, v31
    v_accvgpr_read_b32 v31, a51
    v_mul_f32 v31, v31, v30
    v_accvgpr_write_b32 a51, v31
    v_accvgpr_read_b32 v31, a52
    v_mul_f32 v31, v31, v30
    v_accvgpr_write_b32 a52, v31
    v_accvgpr_read_b32 v31, a53
    v_mul_f32 v31, v31, v30
    v_accvgpr_write_b32 a53, v31
    v_accvgpr_read_b32 v31, a54
    v_mul_f32 v31, v31, v30
    v_accvgpr_write_b32 a54, v31
    v_accvgpr_read_b32 v31, a55
    v_mul_f32 v31, v31, v30
    v_accvgpr_write_b32 a55, v31
    v_accvgpr_read_b32 v31, a56
    v_mul_f32 v31, v31, v30
    v_accvgpr_write_b32 a56, v31
    v_accvgpr_read_b32 v31, a57
    v_mul_f32 v31, v31, v30
    v_accvgpr_write_b32 a57, v31
    v_accvgpr_read_b32 v31, a58
    v_mul_f32 v31, v31, v30
    v_accvgpr_write_b32 a58, v31
    v_accvgpr_read_b32 v31, a59
    v_mul_f32 v31, v31, v30
    v_accvgpr_write_b32 a59, v31
    v_accvgpr_read_b32 v31, a60
    v_mul_f32 v31, v31, v30
    v_accvgpr_write_b32 a60, v31
    v_accvgpr_read_b32 v31, a61
    v_mul_f32 v31, v31, v30
    v_accvgpr_write_b32 a61, v31
    v_accvgpr_read_b32 v31, a62
    v_mul_f32 v31, v31, v30
    v_accvgpr_write_b32 a62, v31
    v_accvgpr_read_b32 v31, a63
    v_mul_f32 v31, v31, v30
    v_accvgpr_write_b32 a63, v31
    v_accvgpr_read_b32 v31, a64
    v_mul_f32 v31, v31, v30
    v_accvgpr_write_b32 a64, v31
    v_accvgpr_read_b32 v31, a65
    v_mul_f32 v31, v31, v30
    v_accvgpr_write_b32 a65, v31
    v_accvgpr_read_b32 v31, a66
    v_mul_f32 v31, v31, v30
    v_accvgpr_write_b32 a66, v31
    v_accvgpr_read_b32 v31, a67
    v_mul_f32 v31, v31, v30
    v_accvgpr_write_b32 a67, v31
    v_accvgpr_read_b32 v31, a68
    v_mul_f32 v31, v31, v30
    v_accvgpr_write_b32 a68, v31
    v_accvgpr_read_b32 v31, a69
    v_mul_f32 v31, v31, v30
    v_accvgpr_write_b32 a69, v31
    v_accvgpr_read_b32 v31, a70
    v_mul_f32 v31, v31, v30
    v_accvgpr_write_b32 a70, v31
    v_accvgpr_read_b32 v31, a71
    v_mul_f32 v31, v31, v30
    v_accvgpr_write_b32 a71, v31
    v_accvgpr_read_b32 v31, a72
    v_mul_f32 v31, v31, v30
    v_accvgpr_write_b32 a72, v31
    v_accvgpr_read_b32 v31, a73
    v_mul_f32 v31, v31, v30
    v_accvgpr_write_b32 a73, v31
    v_accvgpr_read_b32 v31, a74
    v_mul_f32 v31, v31, v30
    v_accvgpr_write_b32 a74, v31
    v_accvgpr_read_b32 v31, a75
    v_mul_f32 v31, v31, v30
    v_accvgpr_write_b32 a75, v31
    v_accvgpr_read_b32 v31, a76
    v_mul_f32 v31, v31, v30
    v_accvgpr_write_b32 a76, v31
    v_accvgpr_read_b32 v31, a77
    v_mul_f32 v31, v31, v30
    v_accvgpr_write_b32 a77, v31
    v_accvgpr_read_b32 v31, a78
    v_mul_f32 v31, v31, v30
    v_accvgpr_write_b32 a78, v31
    v_accvgpr_read_b32 v31, a79
    v_mul_f32 v31, v31, v30
    v_accvgpr_write_b32 a79, v31
    v_accvgpr_read_b32 v31, a80
    v_mul_f32 v31, v31, v30
    v_accvgpr_write_b32 a80, v31
    v_accvgpr_read_b32 v31, a81
    v_mul_f32 v31, v31, v30
    v_accvgpr_write_b32 a81, v31
    v_accvgpr_read_b32 v31, a82
    v_mul_f32 v31, v31, v30
    v_accvgpr_write_b32 a82, v31
    v_accvgpr_read_b32 v31, a83
    v_mul_f32 v31, v31, v30
    v_accvgpr_write_b32 a83, v31
    v_accvgpr_read_b32 v31, a84
    v_mul_f32 v31, v31, v30
    v_accvgpr_write_b32 a84, v31
    v_accvgpr_read_b32 v31, a85
    v_mul_f32 v31, v31, v30
    v_accvgpr_write_b32 a85, v31
    v_accvgpr_read_b32 v31, a86
    v_mul_f32 v31, v31, v30
    v_accvgpr_write_b32 a86, v31
    v_accvgpr_read_b32 v31, a87
    v_mul_f32 v31, v31, v30
    v_accvgpr_write_b32 a87, v31
    v_accvgpr_read_b32 v31, a88
    v_mul_f32 v31, v31, v30
    v_accvgpr_write_b32 a88, v31
    v_accvgpr_read_b32 v31, a89
    v_mul_f32 v31, v31, v30
    v_accvgpr_write_b32 a89, v31
    v_accvgpr_read_b32 v31, a90
    v_mul_f32 v31, v31, v30
    v_accvgpr_write_b32 a90, v31
    v_accvgpr_read_b32 v31, a91
    v_mul_f32 v31, v31, v30
    v_accvgpr_write_b32 a91, v31
    v_accvgpr_read_b32 v31, a92
    v_mul_f32 v31, v31, v30
    v_accvgpr_write_b32 a92, v31
    v_accvgpr_read_b32 v31, a93
    v_mul_f32 v31, v31, v30
    v_accvgpr_write_b32 a93, v31
    v_accvgpr_read_b32 v31, a94
    v_mul_f32 v31, v31, v30
    v_accvgpr_write_b32 a94, v31
    v_accvgpr_read_b32 v31, a95
    v_mul_f32 v31, v31, v30
    v_accvgpr_write_b32 a95, v31
    v_exp_f32 v12, v68
    v_exp_f32 v13, v69
    v_exp_f32 v14, v70
    v_exp_f32 v15, v71
    v_exp_f32 v16, v84
    v_exp_f32 v17, v85
    v_exp_f32 v18, v86
    v_exp_f32 v19, v87
    s_nop 0
    v_add_f32 v9, v12, v13
    v_add_f32 v9, v9, v14
    v_add_f32 v9, v9, v15
    v_add_f32 v9, v9, v16
    v_add_f32 v9, v9, v17
    v_add_f32 v9, v9, v18
    v_add_f32 v9, v9, v19
    v_cvt_pk_bf16_f32 v116, v12, v13
    v_cvt_pk_bf16_f32 v117, v14, v15
    v_cvt_pk_bf16_f32 v118, v16, v17
    v_cvt_pk_bf16_f32 v119, v18, v19
    v_max3_f32 v29, v72, v73, v74
    v_max3_f32 v29, v29, v75, v88
    v_max3_f32 v29, v29, v89, v90
    v_max_f32 v29, v29, v91
    v_mov_b32 v30, v29
    s_nop 1
    v_permlane16_swap_b32 v29, v30
    s_nop 1
    v_max_f32 v29, v29, v30
    v_mov_b32 v30, v29
    s_nop 1
    v_permlane32_swap_b32 v29, v30
    s_nop 1
    v_max_f32 v29, v29, v30
    v_max_f32 v29, 0, v29
    v_sub_f32 v136, v136, v29
    v_sub_f32 v72, v72, v29
    v_sub_f32 v88, v88, v29
    v_sub_f32 v137, v137, v29
    v_sub_f32 v73, v73, v29
    v_sub_f32 v89, v89, v29
    v_sub_f32 v138, v138, v29
    v_sub_f32 v74, v74, v29
    v_sub_f32 v90, v90, v29
    v_sub_f32 v139, v139, v29
    v_sub_f32 v75, v75, v29
    v_sub_f32 v91, v91, v29
    v_sub_f32 v30, 0, v29
    v_exp_f32 v30, v30
    s_nop 0
    v_mul_f32 v6, v6, v30
    v_accvgpr_read_b32 v31, a96
    v_mul_f32 v31, v31, v30
    v_accvgpr_write_b32 a96, v31
    v_accvgpr_read_b32 v31, a97
    v_mul_f32 v31, v31, v30
    v_accvgpr_write_b32 a97, v31
    v_accvgpr_read_b32 v31, a98
    v_mul_f32 v31, v31, v30
    v_accvgpr_write_b32 a98, v31
    v_accvgpr_read_b32 v31, a99
    v_mul_f32 v31, v31, v30
    v_accvgpr_write_b32 a99, v31
    v_accvgpr_read_b32 v31, a100
    v_mul_f32 v31, v31, v30
    v_accvgpr_write_b32 a100, v31
    v_accvgpr_read_b32 v31, a101
    v_mul_f32 v31, v31, v30
    v_accvgpr_write_b32 a101, v31
    v_accvgpr_read_b32 v31, a102
    v_mul_f32 v31, v31, v30
    v_accvgpr_write_b32 a102, v31
    v_accvgpr_read_b32 v31, a103
    v_mul_f32 v31, v31, v30
    v_accvgpr_write_b32 a103, v31
    v_accvgpr_read_b32 v31, a104
    v_mul_f32 v31, v31, v30
    v_accvgpr_write_b32 a104, v31
    v_accvgpr_read_b32 v31, a105
    v_mul_f32 v31, v31, v30
    v_accvgpr_write_b32 a105, v31
    v_accvgpr_read_b32 v31, a106
    v_mul_f32 v31, v31, v30
    v_accvgpr_write_b32 a106, v31
    v_accvgpr_read_b32 v31, a107
    v_mul_f32 v31, v31, v30
    v_accvgpr_write_b32 a107, v31
    v_accvgpr_read_b32 v31, a108
    v_mul_f32 v31, v31, v30
    v_accvgpr_write_b32 a108, v31
    v_accvgpr_read_b32 v31, a109
    v_mul_f32 v31, v31, v30
    v_accvgpr_write_b32 a109, v31
    v_accvgpr_read_b32 v31, a110
    v_mul_f32 v31, v31, v30
    v_accvgpr_write_b32 a110, v31
    v_accvgpr_read_b32 v31, a111
    v_mul_f32 v31, v31, v30
    v_accvgpr_write_b32 a111, v31
    v_accvgpr_read_b32 v31, a112
    v_mul_f32 v31, v31, v30
    v_accvgpr_write_b32 a112, v31
    v_accvgpr_read_b32 v31, a113
    v_mul_f32 v31, v31, v30
    v_accvgpr_write_b32 a113, v31
    v_accvgpr_read_b32 v31, a114
    v_mul_f32 v31, v31, v30
    v_accvgpr_write_b32 a114, v31
    v_accvgpr_read_b32 v31, a115
    v_mul_f32 v31, v31, v30
    v_accvgpr_write_b32 a115, v31
    v_accvgpr_read_b32 v31, a116
    v_mul_f32 v31, v31, v30
    v_accvgpr_write_b32 a116, v31
    v_accvgpr_read_b32 v31, a117
    v_mul_f32 v31, v31, v30
    v_accvgpr_write_b32 a117, v31
    v_accvgpr_read_b32 v31, a118
    v_mul_f32 v31, v31, v30
    v_accvgpr_write_b32 a118, v31
    v_accvgpr_read_b32 v31, a119
    v_mul_f32 v31, v31, v30
    v_accvgpr_write_b32 a119, v31
    v_accvgpr_read_b32 v31, a120
    v_mul_f32 v31, v31, v30
    v_accvgpr_write_b32 a120, v31
    v_accvgpr_read_b32 v31, a121
    v_mul_f32 v31, v31, v30
    v_accvgpr_write_b32 a121, v31
    v_accvgpr_read_b32 v31, a122
    v_mul_f32 v31, v31, v30
    v_accvgpr_write_b32 a122, v31
    v_accvgpr_read_b32 v31, a123
    v_mul_f32 v31, v31, v30
    v_accvgpr_write_b32 a123, v31
    v_accvgpr_read_b32 v31, a124
    v_mul_f32 v31, v31, v30
    v_accvgpr_write_b32 a124, v31
    v_accvgpr_read_b32 v31, a125
    v_mul_f32 v31, v31, v30
    v_accvgpr_write_b32 a125, v31
    v_accvgpr_read_b32 v31, a126
    v_mul_f32 v31, v31, v30
    v_accvgpr_write_b32 a126, v31
    v_accvgpr_read_b32 v31, a127
    v_mul_f32 v31, v31, v30
    v_accvgpr_write_b32 a127, v31
    v_accvgpr_read_b32 v31, a128
    v_mul_f32 v31, v31, v30
    v_accvgpr_write_b32 a128, v31
    v_accvgpr_read_b32 v31, a129
    v_mul_f32 v31, v31, v30
    v_accvgpr_write_b32 a129, v31
    v_accvgpr_read_b32 v31, a130
    v_mul_f32 v31, v31, v30
    v_accvgpr_write_b32 a130, v31
    v_accvgpr_read_b32 v31, a131
    v_mul_f32 v31, v31, v30
    v_accvgpr_write_b32 a131, v31
    v_accvgpr_read_b32 v31, a132
    v_mul_f32 v31, v31, v30
    v_accvgpr_write_b32 a132, v31
    v_accvgpr_read_b32 v31, a133
    v_mul_f32 v31, v31, v30
    v_accvgpr_write_b32 a133, v31
    v_accvgpr_read_b32 v31, a134
    v_mul_f32 v31, v31, v30
    v_accvgpr_write_b32 a134, v31
    v_accvgpr_read_b32 v31, a135
    v_mul_f32 v31, v31, v30
    v_accvgpr_write_b32 a135, v31
    v_accvgpr_read_b32 v31, a136
    v_mul_f32 v31, v31, v30
    v_accvgpr_write_b32 a136, v31
    v_accvgpr_read_b32 v31, a137
    v_mul_f32 v31, v31, v30
    v_accvgpr_write_b32 a137, v31
    v_accvgpr_read_b32 v31, a138
    v_mul_f32 v31, v31, v30
    v_accvgpr_write_b32 a138, v31
    v_accvgpr_read_b32 v31, a139
    v_mul_f32 v31, v31, v30
    v_accvgpr_write_b32 a139, v31
    v_accvgpr_read_b32 v31, a140
    v_mul_f32 v31, v31, v30
    v_accvgpr_write_b32 a140, v31
    v_accvgpr_read_b32 v31, a141
    v_mul_f32 v31, v31, v30
    v_accvgpr_write_b32 a141, v31
    v_accvgpr_read_b32 v31, a142
    v_mul_f32 v31, v31, v30
    v_accvgpr_write_b32 a142, v31
    v_accvgpr_read_b32 v31, a143
    v_mul_f32 v31, v31, v30
    v_accvgpr_write_b32 a143, v31
    v_exp_f32 v12, v72
    v_exp_f32 v13, v73
    v_exp_f32 v14, v74
    v_exp_f32 v15, v75
    v_exp_f32 v16, v88
    v_exp_f32 v17, v89
    v_exp_f32 v18, v90
    v_exp_f32 v19, v91
    s_nop 0
    v_add_f32 v10, v12, v13
    v_add_f32 v10, v10, v14
    v_add_f32 v10, v10, v15
    v_add_f32 v10, v10, v16
    v_add_f32 v10, v10, v17
    v_add_f32 v10, v10, v18
    v_add_f32 v10, v10, v19
    v_cvt_pk_bf16_f32 v120, v12, v13
    v_cvt_pk_bf16_f32 v121, v14, v15
    v_cvt_pk_bf16_f32 v122, v16, v17
    v_cvt_pk_bf16_f32 v123, v18, v19
    v_max3_f32 v29, v76, v77, v78
    v_max3_f32 v29, v29, v79, v92
    v_max3_f32 v29, v29, v93, v94
    v_max_f32 v29, v29, v95
    v_mov_b32 v30, v29
    s_nop 1
    v_permlane16_swap_b32 v29, v30
    s_nop 1
    v_max_f32 v29, v29, v30
    v_mov_b32 v30, v29
    s_nop 1
    v_permlane32_swap_b32 v29, v30
    s_nop 1
    v_max_f32 v29, v29, v30
    v_max_f32 v29, 0, v29
    v_sub_f32 v140, v140, v29
    v_sub_f32 v76, v76, v29
    v_sub_f32 v92, v92, v29
    v_sub_f32 v141, v141, v29
    v_sub_f32 v77, v77, v29
    v_sub_f32 v93, v93, v29
    v_sub_f32 v142, v142, v29
    v_sub_f32 v78, v78, v29
    v_sub_f32 v94, v94, v29
    v_sub_f32 v143, v143, v29
    v_sub_f32 v79, v79, v29
    v_sub_f32 v95, v95, v29
    v_sub_f32 v30, 0, v29
    v_exp_f32 v30, v30
    s_nop 0
    v_mul_f32 v7, v7, v30
    v_accvgpr_read_b32 v31, a144
    v_mul_f32 v31, v31, v30
    v_accvgpr_write_b32 a144, v31
    v_accvgpr_read_b32 v31, a145
    v_mul_f32 v31, v31, v30
    v_accvgpr_write_b32 a145, v31
    v_accvgpr_read_b32 v31, a146
    v_mul_f32 v31, v31, v30
    v_accvgpr_write_b32 a146, v31
    v_accvgpr_read_b32 v31, a147
    v_mul_f32 v31, v31, v30
    v_accvgpr_write_b32 a147, v31
    v_accvgpr_read_b32 v31, a148
    v_mul_f32 v31, v31, v30
    v_accvgpr_write_b32 a148, v31
    v_accvgpr_read_b32 v31, a149
    v_mul_f32 v31, v31, v30
    v_accvgpr_write_b32 a149, v31
    v_accvgpr_read_b32 v31, a150
    v_mul_f32 v31, v31, v30
    v_accvgpr_write_b32 a150, v31
    v_accvgpr_read_b32 v31, a151
    v_mul_f32 v31, v31, v30
    v_accvgpr_write_b32 a151, v31
    v_accvgpr_read_b32 v31, a152
    v_mul_f32 v31, v31, v30
    v_accvgpr_write_b32 a152, v31
    v_accvgpr_read_b32 v31, a153
    v_mul_f32 v31, v31, v30
    v_accvgpr_write_b32 a153, v31
    v_accvgpr_read_b32 v31, a154
    v_mul_f32 v31, v31, v30
    v_accvgpr_write_b32 a154, v31
    v_accvgpr_read_b32 v31, a155
    v_mul_f32 v31, v31, v30
    v_accvgpr_write_b32 a155, v31
    v_accvgpr_read_b32 v31, a156
    v_mul_f32 v31, v31, v30
    v_accvgpr_write_b32 a156, v31
    v_accvgpr_read_b32 v31, a157
    v_mul_f32 v31, v31, v30
    v_accvgpr_write_b32 a157, v31
    v_accvgpr_read_b32 v31, a158
    v_mul_f32 v31, v31, v30
    v_accvgpr_write_b32 a158, v31
    v_accvgpr_read_b32 v31, a159
    v_mul_f32 v31, v31, v30
    v_accvgpr_write_b32 a159, v31
    v_accvgpr_read_b32 v31, a160
    v_mul_f32 v31, v31, v30
    v_accvgpr_write_b32 a160, v31
    v_accvgpr_read_b32 v31, a161
    v_mul_f32 v31, v31, v30
    v_accvgpr_write_b32 a161, v31
    v_accvgpr_read_b32 v31, a162
    v_mul_f32 v31, v31, v30
    v_accvgpr_write_b32 a162, v31
    v_accvgpr_read_b32 v31, a163
    v_mul_f32 v31, v31, v30
    v_accvgpr_write_b32 a163, v31
    v_accvgpr_read_b32 v31, a164
    v_mul_f32 v31, v31, v30
    v_accvgpr_write_b32 a164, v31
    v_accvgpr_read_b32 v31, a165
    v_mul_f32 v31, v31, v30
    v_accvgpr_write_b32 a165, v31
    v_accvgpr_read_b32 v31, a166
    v_mul_f32 v31, v31, v30
    v_accvgpr_write_b32 a166, v31
    v_accvgpr_read_b32 v31, a167
    v_mul_f32 v31, v31, v30
    v_accvgpr_write_b32 a167, v31
    v_accvgpr_read_b32 v31, a168
    v_mul_f32 v31, v31, v30
    v_accvgpr_write_b32 a168, v31
    v_accvgpr_read_b32 v31, a169
    v_mul_f32 v31, v31, v30
    v_accvgpr_write_b32 a169, v31
    v_accvgpr_read_b32 v31, a170
    v_mul_f32 v31, v31, v30
    v_accvgpr_write_b32 a170, v31
    v_accvgpr_read_b32 v31, a171
    v_mul_f32 v31, v31, v30
    v_accvgpr_write_b32 a171, v31
    v_accvgpr_read_b32 v31, a172
    v_mul_f32 v31, v31, v30
    v_accvgpr_write_b32 a172, v31
    v_accvgpr_read_b32 v31, a173
    v_mul_f32 v31, v31, v30
    v_accvgpr_write_b32 a173, v31
    v_accvgpr_read_b32 v31, a174
    v_mul_f32 v31, v31, v30
    v_accvgpr_write_b32 a174, v31
    v_accvgpr_read_b32 v31, a175
    v_mul_f32 v31, v31, v30
    v_accvgpr_write_b32 a175, v31
    v_accvgpr_read_b32 v31, a176
    v_mul_f32 v31, v31, v30
    v_accvgpr_write_b32 a176, v31
    v_accvgpr_read_b32 v31, a177
    v_mul_f32 v31, v31, v30
    v_accvgpr_write_b32 a177, v31
    v_accvgpr_read_b32 v31, a178
    v_mul_f32 v31, v31, v30
    v_accvgpr_write_b32 a178, v31
    v_accvgpr_read_b32 v31, a179
    v_mul_f32 v31, v31, v30
    v_accvgpr_write_b32 a179, v31
    v_accvgpr_read_b32 v31, a180
    v_mul_f32 v31, v31, v30
    v_accvgpr_write_b32 a180, v31
    v_accvgpr_read_b32 v31, a181
    v_mul_f32 v31, v31, v30
    v_accvgpr_write_b32 a181, v31
    v_accvgpr_read_b32 v31, a182
    v_mul_f32 v31, v31, v30
    v_accvgpr_write_b32 a182, v31
    v_accvgpr_read_b32 v31, a183
    v_mul_f32 v31, v31, v30
    v_accvgpr_write_b32 a183, v31
    v_accvgpr_read_b32 v31, a184
    v_mul_f32 v31, v31, v30
    v_accvgpr_write_b32 a184, v31
    v_accvgpr_read_b32 v31, a185
    v_mul_f32 v31, v31, v30
    v_accvgpr_write_b32 a185, v31
    v_accvgpr_read_b32 v31, a186
    v_mul_f32 v31, v31, v30
    v_accvgpr_write_b32 a186, v31
    v_accvgpr_read_b32 v31, a187
    v_mul_f32 v31, v31, v30
    v_accvgpr_write_b32 a187, v31
    v_accvgpr_read_b32 v31, a188
    v_mul_f32 v31, v31, v30
    v_accvgpr_write_b32 a188, v31
    v_accvgpr_read_b32 v31, a189
    v_mul_f32 v31, v31, v30
    v_accvgpr_write_b32 a189, v31
    v_accvgpr_read_b32 v31, a190
    v_mul_f32 v31, v31, v30
    v_accvgpr_write_b32 a190, v31
    v_accvgpr_read_b32 v31, a191
    v_mul_f32 v31, v31, v30
    v_accvgpr_write_b32 a191, v31
    v_exp_f32 v12, v76
    v_exp_f32 v13, v77
    v_exp_f32 v14, v78
    v_exp_f32 v15, v79
    v_exp_f32 v16, v92
    v_exp_f32 v17, v93
    v_exp_f32 v18, v94
    v_exp_f32 v19, v95
    s_nop 0
    v_add_f32 v11, v12, v13
    v_add_f32 v11, v11, v14
    v_add_f32 v11, v11, v15
    v_add_f32 v11, v11, v16
    v_add_f32 v11, v11, v17
    v_add_f32 v11, v11, v18
    v_add_f32 v11, v11, v19
    v_cvt_pk_bf16_f32 v124, v12, v13
    v_cvt_pk_bf16_f32 v125, v14, v15
    v_cvt_pk_bf16_f32 v126, v16, v17
    v_cvt_pk_bf16_f32 v127, v18, v19
    s_nop 3
    s_branch Z_retL
.section .rodata,"a"
.p2align 6
.amdhsa_kernel standalone__gqa_softmax__prompt_kernel
  .amdhsa_next_free_vgpr 512
  .amdhsa_next_free_sgpr 96
  .amdhsa_accum_offset 256
  .amdhsa_group_segment_fixed_size 0
  .amdhsa_kernarg_size 48
  .amdhsa_user_sgpr_count 2
  .amdhsa_user_sgpr_kernarg_segment_ptr 1
  .amdhsa_system_sgpr_workgroup_id_x 1
.end_amdhsa_kernel
```
